```python
import torch

def _softmax(x, axis=-1):
    return torch.softmax(x, dim=axis)
def _gelu(x):
    return torch.nn.functional.gelu(x, approximate="tanh")
def _silu(x):
    return torch.nn.functional.silu(x)
def _sigmoid(x):
    return torch.sigmoid(x)
def _layernorm(x, axis=-1, eps=1e-5):
    m = x.mean(dim=axis, keepdim=True)
    v = x.var(dim=axis, keepdim=True, unbiased=False)
    return (x - m) / torch.sqrt(v + eps)
def _scatter_add(tgt, idx, src, axis=0):
    return tgt.clone().index_add_(axis, idx, src)
def _segment_sum(src, seg, n):
    out = torch.zeros((n,) + src.shape[1:], dtype=src.dtype)
    return out.index_add_(0, seg, src)
def _pad(x, pw):
    flat = tuple(v for pair in reversed(pw) for v in pair)
    return torch.nn.functional.pad(x, flat)

kernel_name = 'gated_mix__linear_kernel_hedgehog__sliding_local_dilated__prompt'

def setup_inputs():

    _w = (lambda a: (lambda t: t.to(torch.bfloat16) if t.is_floating_point() else t)(torch.as_tensor(a)))
    def _A_setup():
        B, S, D, H = 1, 2048, 640, 32
        Dh = D // H
        return {
            "x": _w((lambda *s: torch.randn(*s, dtype=torch.bfloat16) * 0.05)(B, S, D)),
            "wqkv": _w((lambda *s: torch.randn(*s, dtype=torch.bfloat16) * 1.6)(D, 3 * D)),
            "w_phi": _w((lambda *s: torch.randn(*s, dtype=torch.bfloat16) * 1.6)(H, Dh, Dh) * (Dh ** -0.5)),
            "wo": _w((lambda *s: torch.randn(*s, dtype=torch.bfloat16) * 0.1)(D, D)),
        }
    _A_in = _A_setup()

    def _B_setup():
        B, S, D = 1, 2048, 640
        return {
            "x": _w((lambda *s: torch.randn(*s, dtype=torch.bfloat16) * 0.05)(B, S, D)),
            "wqkv": _w((lambda *s: torch.randn(*s, dtype=torch.bfloat16) * 0.8)(D, 3 * D)),
            "wo": _w((lambda *s: torch.randn(*s, dtype=torch.bfloat16) * 0.05)(D, D)),
        }
    _B_in = _B_setup()

    return {
        "A_x": _A_in["x"],
        "A_wqkv": _A_in["wqkv"],
        "A_w_phi": _A_in["w_phi"],
        "A_wo": _A_in["wo"],
        "B_x": _B_in["x"],
        "B_wqkv": _B_in["wqkv"],
        "B_wo": _B_in["wo"],
        "gate_w": _w((lambda *s: torch.randn(*s, dtype=torch.bfloat16) * 0.05)(640) * 16.0),
    }

def reference(A_x, A_wqkv, A_w_phi, A_wo, B_x, B_wqkv, B_wo, gate_w):
    def _A_ref(x, wqkv, w_phi, wo):
        B, S, D = x.shape
        H = 32; Dh = D // H
        qkv = (lambda x, *d: x.permute(*d))((x @ wqkv).reshape(B, S, 3, H, Dh), 2, 0, 3, 1, 4)
        q, k, v = qkv[0], qkv[1], qkv[2]
        pq = torch.einsum("bhsd,hdf->bhsf", q, w_phi)
        pk = torch.einsum("bhsd,hdf->bhsf", k, w_phi)
        phi_q = torch.concatenate([_softmax(pq, axis=-1), _softmax(-pq, axis=-1)], axis=-1)
        phi_k = torch.concatenate([_softmax(pk, axis=-1), _softmax(-pk, axis=-1)], axis=-1)
        kv = torch.einsum("bhsf,bhsd->bhfd", phi_k, v)
        z  = torch.einsum("bhsf->bhf", phi_k)
        num = torch.einsum("bhqf,bhfd->bhqd", phi_q, kv)
        den = torch.einsum("bhqf,bhf->bhq", phi_q, z)[..., None] + 1e-6
        o = num / den
        return (lambda x, *d: x.permute(*d))(o, 0, 2, 1, 3).reshape(B, S, D) @ wo

    def _B_ref(x, wqkv, wo):
        B, S, D = x.shape
        H = 32; Dh = D // H
        W, dil = 8, 2
        qkv = (lambda x, *d: x.permute(*d))((x @ wqkv).reshape(B, S, 3, H, Dh), 2, 0, 3, 1, 4)
        q, k, v = qkv[0], qkv[1], qkv[2]
        scale = Dh ** -0.5
        pos = torch.arange(S)
        off = torch.arange(W) * dil
        idx = pos[:, None] - off[None, :]
        mask = idx >= 0
        idx_c = torch.where(mask, idx, 0).reshape(-1)
        kg = k[:, :, idx_c, :].reshape(B, H, S, W, Dh)
        vg = v[:, :, idx_c, :].reshape(B, H, S, W, Dh)
        logits = torch.einsum("bhsd,bhswd->bhsw", q, kg) * scale
        logits = torch.where(mask[None, None, :, :], logits, -1e9)
        attn = _softmax(logits, axis=-1)
        o = torch.einsum("bhsw,bhswd->bhsd", attn, vg)
        return (lambda x, *d: x.permute(*d))(o, 0, 2, 1, 3).reshape(B, S, D) @ wo

    x = A_x
    g = _sigmoid((x * gate_w).sum(-1, keepdims=True))
    a = _A_ref(x, A_wqkv, A_w_phi, A_wo)
    b = _B_ref(x, B_wqkv, B_wo)
    return g * a + (1 - g) * b
```

```asm
; @launch grid=(256,1,1) block=(512,1,1) lds=163840
.amdgcn_target "amdgcn-amd-amdhsa--gfx950"
.text
.globl gated_mix__linear_kernel_hedgehog__sliding_local_dilated__prompt_kernel
.p2align 8
.type gated_mix__linear_kernel_hedgehog__sliding_local_dilated__prompt_kernel,@function
gated_mix__linear_kernel_hedgehog__sliding_local_dilated__prompt_kernel:
    s_cmp_ge_u32 s2, 256
    s_cbranch_scc1 K1_done
    s_load_dwordx4 s[44:47], s[0:1], 0
    s_load_dwordx2 s[50:51], s[0:1], 40
    s_load_dwordx2 s[48:49], s[0:1], 16
    s_load_dwordx2 s[52:53], s[0:1], 56
    s_load_dwordx2 s[54:55], s[0:1], 80
    v_lshrrev_b32 v2, 6, v0
    v_and_b32 v1, 63, v0
    s_and_b32 s26, s2, 7
    v_readfirstlane_b32 s23, v2
    s_lshr_b32 s27, s2, 3
    s_and_b32 s20, s26, 1
    s_lshl_b32 s20, s20, 3
    s_and_b32 s28, s27, 7
    s_add_u32 s20, s20, s28
    s_lshr_b32 s21, s26, 1
    s_lshl_b32 s21, s21, 1
    s_lshr_b32 s28, s27, 3
    s_and_b32 s28, s28, 1
    s_add_u32 s21, s21, s28
    s_lshr_b32 s22, s27, 4
    s_mul_i32 s38, s27, 3
    s_mul_i32 s28, s38, 6554
    s_lshr_b32 s28, s28, 16
    s_mul_i32 s28, s28, 10
    s_sub_u32 s38, s38, s28
    s_mul_i32 s28, s23, 384
    s_mul_i32 s29, s21, 160
    s_mov_b32 s30, 2185
    s_lshl_b32 s31, s20, 7
    s_sub_u32 s31, s31, 256
    s_mul_i32 s32, s23, 48
    s_add_u32 s31, s31, s32
    s_mov_b32 s32, 1280
    s_waitcnt lgkmcnt(0)
    s_mov_b32 s4, s44
    s_and_b32 s5, s45, 0xffff
    s_mov_b32 s6, 2621440
    s_mov_b32 s7, 0x00020000
    s_cmp_eq_u32 s22, 0
    s_cselect_b32 s8, s46, s50
    s_cselect_b32 s9, s47, s51
    s_and_b32 s9, s9, 0xffff
    s_mov_b32 s10, 2457600
    s_mov_b32 s11, 0x00020000
    s_cmp_ge_u32 s23, 5
    s_cselect_b32 s40, s4, s8
    s_cselect_b32 s41, s5, s9
    s_cselect_b32 s42, s6, s10
    s_mov_b32 s43, 0x00020000
    s_mov_b32 s33, 245760
    s_cselect_b32 s35, 128, s33
    s_cbranch_scc1 K1_xoff
    v_add_u32 v2, s28, v1
    v_mul_u32_u24 v3, s30, v2
    v_lshrrev_b32 v3, 16, v3
    v_mul_u32_u24 v4, 30, v3
    v_sub_u32 v4, v2, v4
    v_and_b32 v5, 0x23, v3
    v_bfe_u32 v6, v3, 2, 2
    v_lshl_add_u32 v5, v6, 3, v5
    v_bfe_u32 v6, v3, 4, 1
    v_lshl_add_u32 v5, v6, 2, v5
    v_mul_u32_u24 v5, 3840, v5
    v_mul_u32_u24 v6, 26, v4
    v_lshrrev_b32 v6, 8, v6
    v_mul_u32_u24 v7, 1120, v6
    v_add_u32 v5, v5, v7
    v_lshl_add_u32 v5, v4, 4, v5
    v_add_u32 v20, s29, v5
    s_mul_i32 s26, s23, 6144
    s_add_u32 m0, s26, 0
    s_add_u32 s34, s38, 0
    s_sub_u32 s27, s34, 10
    s_cmp_ge_u32 s34, 10
    s_cselect_b32 s34, s27, s34
    s_mul_i32 s34, s35, s34
    buffer_load_dwordx4 v20, s[40:43], s34 offen lds
    v_add_u32 v2, s28, v1
    v_add_u32 v2, 64, v2
    v_mul_u32_u24 v3, s30, v2
    v_lshrrev_b32 v3, 16, v3
    v_mul_u32_u24 v4, 30, v3
    v_sub_u32 v4, v2, v4
    v_and_b32 v5, 0x23, v3
    v_bfe_u32 v6, v3, 2, 2
    v_lshl_add_u32 v5, v6, 3, v5
    v_bfe_u32 v6, v3, 4, 1
    v_lshl_add_u32 v5, v6, 2, v5
    v_mul_u32_u24 v5, 3840, v5
    v_mul_u32_u24 v6, 26, v4
    v_lshrrev_b32 v6, 8, v6
    v_mul_u32_u24 v7, 1120, v6
    v_add_u32 v5, v5, v7
    v_lshl_add_u32 v5, v4, 4, v5
    v_add_u32 v21, s29, v5
    s_mul_i32 s26, s23, 6144
    s_add_u32 m0, s26, 1024
    s_add_u32 s34, s38, 0
    s_sub_u32 s27, s34, 10
    s_cmp_ge_u32 s34, 10
    s_cselect_b32 s34, s27, s34
    s_mul_i32 s34, s35, s34
    buffer_load_dwordx4 v21, s[40:43], s34 offen lds
    v_add_u32 v2, s28, v1
    v_add_u32 v2, 128, v2
    v_mul_u32_u24 v3, s30, v2
    v_lshrrev_b32 v3, 16, v3
    v_mul_u32_u24 v4, 30, v3
    v_sub_u32 v4, v2, v4
    v_and_b32 v5, 0x23, v3
    v_bfe_u32 v6, v3, 2, 2
    v_lshl_add_u32 v5, v6, 3, v5
    v_bfe_u32 v6, v3, 4, 1
    v_lshl_add_u32 v5, v6, 2, v5
    v_mul_u32_u24 v5, 3840, v5
    v_mul_u32_u24 v6, 26, v4
    v_lshrrev_b32 v6, 8, v6
    v_mul_u32_u24 v7, 1120, v6
    v_add_u32 v5, v5, v7
    v_lshl_add_u32 v5, v4, 4, v5
    v_add_u32 v22, s29, v5
    s_mul_i32 s26, s23, 6144
    s_add_u32 m0, s26, 2048
    s_add_u32 s34, s38, 0
    s_sub_u32 s27, s34, 10
    s_cmp_ge_u32 s34, 10
    s_cselect_b32 s34, s27, s34
    s_mul_i32 s34, s35, s34
    buffer_load_dwordx4 v22, s[40:43], s34 offen lds
    v_add_u32 v2, s28, v1
    v_add_u32 v2, 192, v2
    v_mul_u32_u24 v3, s30, v2
    v_lshrrev_b32 v3, 16, v3
    v_mul_u32_u24 v4, 30, v3
    v_sub_u32 v4, v2, v4
    v_and_b32 v5, 0x23, v3
    v_bfe_u32 v6, v3, 2, 2
    v_lshl_add_u32 v5, v6, 3, v5
    v_bfe_u32 v6, v3, 4, 1
    v_lshl_add_u32 v5, v6, 2, v5
    v_mul_u32_u24 v5, 3840, v5
    v_mul_u32_u24 v6, 26, v4
    v_lshrrev_b32 v6, 8, v6
    v_mul_u32_u24 v7, 1120, v6
    v_add_u32 v5, v5, v7
    v_lshl_add_u32 v5, v4, 4, v5
    v_add_u32 v23, s29, v5
    s_mul_i32 s26, s23, 6144
    s_add_u32 m0, s26, 3072
    s_add_u32 s34, s38, 0
    s_sub_u32 s27, s34, 10
    s_cmp_ge_u32 s34, 10
    s_cselect_b32 s34, s27, s34
    s_mul_i32 s34, s35, s34
    buffer_load_dwordx4 v23, s[40:43], s34 offen lds
    v_add_u32 v2, s28, v1
    v_add_u32 v2, 256, v2
    v_mul_u32_u24 v3, s30, v2
    v_lshrrev_b32 v3, 16, v3
    v_mul_u32_u24 v4, 30, v3
    v_sub_u32 v4, v2, v4
    v_and_b32 v5, 0x23, v3
    v_bfe_u32 v6, v3, 2, 2
    v_lshl_add_u32 v5, v6, 3, v5
    v_bfe_u32 v6, v3, 4, 1
    v_lshl_add_u32 v5, v6, 2, v5
    v_mul_u32_u24 v5, 3840, v5
    v_mul_u32_u24 v6, 26, v4
    v_lshrrev_b32 v6, 8, v6
    v_mul_u32_u24 v7, 1120, v6
    v_add_u32 v5, v5, v7
    v_lshl_add_u32 v5, v4, 4, v5
    v_add_u32 v24, s29, v5
    s_mul_i32 s26, s23, 6144
    s_add_u32 m0, s26, 4096
    s_add_u32 s34, s38, 0
    s_sub_u32 s27, s34, 10
    s_cmp_ge_u32 s34, 10
    s_cselect_b32 s34, s27, s34
    s_mul_i32 s34, s35, s34
    buffer_load_dwordx4 v24, s[40:43], s34 offen lds
    v_add_u32 v2, s28, v1
    v_add_u32 v2, 320, v2
    v_mul_u32_u24 v3, s30, v2
    v_lshrrev_b32 v3, 16, v3
    v_mul_u32_u24 v4, 30, v3
    v_sub_u32 v4, v2, v4
    v_and_b32 v5, 0x23, v3
    v_bfe_u32 v6, v3, 2, 2
    v_lshl_add_u32 v5, v6, 3, v5
    v_bfe_u32 v6, v3, 4, 1
    v_lshl_add_u32 v5, v6, 2, v5
    v_mul_u32_u24 v5, 3840, v5
    v_mul_u32_u24 v6, 26, v4
    v_lshrrev_b32 v6, 8, v6
    v_mul_u32_u24 v7, 1120, v6
    v_add_u32 v5, v5, v7
    v_lshl_add_u32 v5, v4, 4, v5
    v_add_u32 v25, s29, v5
    s_mul_i32 s26, s23, 6144
    s_add_u32 m0, s26, 5120
    s_add_u32 s34, s38, 0
    s_sub_u32 s27, s34, 10
    s_cmp_ge_u32 s34, 10
    s_cselect_b32 s34, s27, s34
    s_mul_i32 s34, s35, s34
    buffer_load_dwordx4 v25, s[40:43], s34 offen lds
    s_branch K1_offdone
K1_xoff:
    v_lshrrev_b32 v2, 3, v1
    v_and_b32 v3, 7, v1
    v_xor_b32 v3, v3, v2
    v_lshlrev_b32 v3, 4, v3
    v_add_u32 v4, s31, v2
    v_mul_lo_u32 v4, v4, s32
    v_add_u32 v20, v4, v3
    s_mul_i32 s26, s23, 6144
    s_add_u32 m0, s26, 0
    s_add_u32 s34, s38, 0
    s_sub_u32 s27, s34, 10
    s_cmp_ge_u32 s34, 10
    s_cselect_b32 s34, s27, s34
    s_mul_i32 s34, s35, s34
    buffer_load_dwordx4 v20, s[40:43], s34 offen lds
    v_add_u32 v4, s31, v2
    v_add_u32 v4, 8, v4
    v_mul_lo_u32 v4, v4, s32
    v_add_u32 v21, v4, v3
    s_mul_i32 s26, s23, 6144
    s_add_u32 m0, s26, 1024
    s_add_u32 s34, s38, 0
    s_sub_u32 s27, s34, 10
    s_cmp_ge_u32 s34, 10
    s_cselect_b32 s34, s27, s34
    s_mul_i32 s34, s35, s34
    buffer_load_dwordx4 v21, s[40:43], s34 offen lds
    v_add_u32 v4, s31, v2
    v_add_u32 v4, 16, v4
    v_mul_lo_u32 v4, v4, s32
    v_add_u32 v22, v4, v3
    s_mul_i32 s26, s23, 6144
    s_add_u32 m0, s26, 2048
    s_add_u32 s34, s38, 0
    s_sub_u32 s27, s34, 10
    s_cmp_ge_u32 s34, 10
    s_cselect_b32 s34, s27, s34
    s_mul_i32 s34, s35, s34
    buffer_load_dwordx4 v22, s[40:43], s34 offen lds
    v_add_u32 v4, s31, v2
    v_add_u32 v4, 24, v4
    v_mul_lo_u32 v4, v4, s32
    v_add_u32 v23, v4, v3
    s_mul_i32 s26, s23, 6144
    s_add_u32 m0, s26, 3072
    s_add_u32 s34, s38, 0
    s_sub_u32 s27, s34, 10
    s_cmp_ge_u32 s34, 10
    s_cselect_b32 s34, s27, s34
    s_mul_i32 s34, s35, s34
    buffer_load_dwordx4 v23, s[40:43], s34 offen lds
    v_add_u32 v4, s31, v2
    v_add_u32 v4, 32, v4
    v_mul_lo_u32 v4, v4, s32
    v_add_u32 v24, v4, v3
    s_mul_i32 s26, s23, 6144
    s_add_u32 m0, s26, 4096
    s_add_u32 s34, s38, 0
    s_sub_u32 s27, s34, 10
    s_cmp_ge_u32 s34, 10
    s_cselect_b32 s34, s27, s34
    s_mul_i32 s34, s35, s34
    buffer_load_dwordx4 v24, s[40:43], s34 offen lds
    v_add_u32 v4, s31, v2
    v_add_u32 v4, 40, v4
    v_mul_lo_u32 v4, v4, s32
    v_add_u32 v25, v4, v3
    s_mul_i32 s26, s23, 6144
    s_add_u32 m0, s26, 5120
    s_add_u32 s34, s38, 0
    s_sub_u32 s27, s34, 10
    s_cmp_ge_u32 s34, 10
    s_cselect_b32 s34, s27, s34
    s_mul_i32 s34, s35, s34
    buffer_load_dwordx4 v25, s[40:43], s34 offen lds
K1_offdone:
    s_mul_i32 s26, s23, 6144
    s_add_u32 m0, s26, 49152
    s_add_u32 s34, s38, 1
    s_sub_u32 s27, s34, 10
    s_cmp_ge_u32 s34, 10
    s_cselect_b32 s34, s27, s34
    s_mul_i32 s34, s35, s34
    buffer_load_dwordx4 v20, s[40:43], s34 offen lds
    s_mul_i32 s26, s23, 6144
    s_add_u32 m0, s26, 50176
    s_add_u32 s34, s38, 1
    s_sub_u32 s27, s34, 10
    s_cmp_ge_u32 s34, 10
    s_cselect_b32 s34, s27, s34
    s_mul_i32 s34, s35, s34
    buffer_load_dwordx4 v21, s[40:43], s34 offen lds
    s_mul_i32 s26, s23, 6144
    s_add_u32 m0, s26, 51200
    s_add_u32 s34, s38, 1
    s_sub_u32 s27, s34, 10
    s_cmp_ge_u32 s34, 10
    s_cselect_b32 s34, s27, s34
    s_mul_i32 s34, s35, s34
    buffer_load_dwordx4 v22, s[40:43], s34 offen lds
    s_mul_i32 s26, s23, 6144
    s_add_u32 m0, s26, 52224
    s_add_u32 s34, s38, 1
    s_sub_u32 s27, s34, 10
    s_cmp_ge_u32 s34, 10
    s_cselect_b32 s34, s27, s34
    s_mul_i32 s34, s35, s34
    buffer_load_dwordx4 v23, s[40:43], s34 offen lds
    s_mul_i32 s26, s23, 6144
    s_add_u32 m0, s26, 53248
    s_add_u32 s34, s38, 1
    s_sub_u32 s27, s34, 10
    s_cmp_ge_u32 s34, 10
    s_cselect_b32 s34, s27, s34
    s_mul_i32 s34, s35, s34
    buffer_load_dwordx4 v24, s[40:43], s34 offen lds
    s_mul_i32 s26, s23, 6144
    s_add_u32 m0, s26, 54272
    s_add_u32 s34, s38, 1
    s_sub_u32 s27, s34, 10
    s_cmp_ge_u32 s34, 10
    s_cselect_b32 s34, s27, s34
    s_mul_i32 s34, s35, s34
    buffer_load_dwordx4 v25, s[40:43], s34 offen lds
    v_lshrrev_b32 v10, 4, v1
    s_mov_b32 s36, 0x3fb8aa3b
    s_mov_b32 s37, 0xbfb8aa3b
    s_and_b32 s24, s23, 3
    s_lshr_b32 s25, s23, 2
    s_mov_b32 s12, s54
    s_and_b32 s13, s55, 0xffff
    s_mov_b32 s14, 33554432
    s_mov_b32 s15, 0x00020000
    s_cmp_eq_u32 s22, 0
    s_cselect_b32 s28, s48, s52
    s_cselect_b32 s29, s49, s53
    s_mov_b32 s31, 1280
    s_cselect_b32 s30, 25600, s31
    s_mov_b32 s16, s28
    s_and_b32 s17, s29, 0xffff
    s_mov_b32 s18, s30
    s_mov_b32 s19, 0x00020000
    s_cmp_lg_u32 s23, 7
    s_cbranch_scc1 K1_fc
    s_lshl_b32 s26, s2, 2
    s_add_u32 s26, s26, 14680064
    v_mov_b32 v2, s26
    v_mov_b32 v3, 0
    s_mov_b64 exec, 1
    buffer_store_dword v3, v2, s[12:15], 0 offen sc1
    s_add_u32 s27, s20, 8
    s_cmp_eq_u32 s22, 0
    s_cselect_b32 s26, s21, s27
    s_cselect_b32 s27, s20, s21
    s_lshl_b32 s26, s26, 7
    s_lshl_b32 s27, s27, 2
    s_add_u32 s26, s26, s27
    s_add_u32 s26, s26, 14684160
    v_mov_b32 v2, s26
    buffer_store_dword v3, v2, s[12:15], 0 offen sc1
    s_mov_b64 exec, -1
K1_fc:
    s_cmp_eq_u32 s22, 0
    s_cbranch_scc0 K1_B
    v_lshlrev_b32 v148, 4, v0
    s_mul_i32 s26, s21, 3200
    v_cmp_gt_u32 vcc, 200, v0
    s_and_saveexec_b64 s[28:29], vcc
    s_cbranch_execz K1_wp0
    buffer_load_dwordx4 v[152:155], v148, s[16:19], s26 offen
K1_wp0:
    s_mov_b64 exec, s[28:29]
    s_mul_i32 s26, s2, 7
    s_add_u32 s26, s26, s23
    s_cmp_ge_u32 s23, 7
    s_cselect_b32 s26, 1600, s26
    s_mov_b32 s96, s26
    s_cmp_ge_u32 s26, 1600
    s_cbranch_scc1 K1_rlA
    s_load_dwordx2 s[92:93], s[0:1], 24
    s_load_dwordx2 s[94:95], s[0:1], 48
    s_mul_i32 s27, s26, 52429
    s_lshr_b32 s27, s27, 18
    s_mul_i32 s28, s27, 5
    s_sub_u32 s28, s26, s28
    s_mul_i32 s29, s27, 3277
    s_lshr_b32 s29, s29, 16
    s_mul_i32 s30, s29, 20
    s_sub_u32 s30, s27, s30
    s_and_b32 s31, s29, 7
    s_mul_i32 s31, s31, 160
    s_mul_i32 s30, s30, 40960
    s_add_u32 s31, s31, s30
    s_lshl_b32 s28, s28, 6
    v_add_u32 v172, s28, v1
    v_mul_u32_u24 v173, 6554, v172
    v_lshrrev_b32 v173, 16, v173
    v_mul_u32_u24 v174, 10, v173
    v_sub_u32 v174, v172, v174
    v_bfe_u32 v175, v173, 4, 1
    v_bfe_u32 v176, v173, 2, 2
    v_and_b32 v177, 3, v173
    v_lshl_add_u32 v177, v175, 2, v177
    v_lshl_add_u32 v177, v176, 3, v177
    v_mul_u32_u24 v177, 1280, v177
    v_lshl_add_u32 v177, v174, 4, v177
    v_add_u32 v177, s31, v177
    s_waitcnt lgkmcnt(0)
    s_cmp_lt_u32 s29, 8
    s_cselect_b32 s92, s92, s94
    s_cselect_b32 s93, s93, s95
    s_mov_b32 s84, s92
    s_and_b32 s85, s93, 0xffff
    s_mov_b32 s86, 819200
    s_mov_b32 s87, 0x00020000
    buffer_load_dwordx4 v[180:183], v177, s[84:87], 0 offen
K1_rlA:
    v_lshrrev_b32 v2, 2, v1
    v_mul_u32_u24 v2, 480, v2
    v_and_b32 v3, 3, v1
    v_mul_u32_u24 v3, 40, v3
    v_add_u32 v2, v2, v3
    s_mul_i32 s26, s25, 160
    v_add_u32 v11, s26, v2
    s_mul_i32 s26, s25, 24
    s_add_u32 s26, s26, 320
    v_add_u32 v12, s26, v2
    s_add_u32 s26, s23, 0
    s_cmp_ge_u32 s26, 10
    s_cselect_b32 s26, s23, s26
    s_add_u32 s26, s26, 5
    s_cmp_ge_u32 s26, 10
    s_mov_b32 s28, 120
    s_cselect_b32 s27, 240, s28
    s_lshl_b32 s26, s26, 3
    s_add_u32 s26, s26, s27
    v_add_u32 v17, s26, v2
    s_add_u32 s26, s23, 8
    s_cmp_ge_u32 s26, 10
    s_cselect_b32 s26, s23, s26
    s_add_u32 s26, s26, 5
    s_cmp_ge_u32 s26, 10
    s_mov_b32 s28, 120
    s_cselect_b32 s27, 240, s28
    s_lshl_b32 s26, s26, 3
    s_add_u32 s26, s26, s27
    v_add_u32 v18, s26, v2
    v_and_b32 v2, 15, v1
    v_and_b32 v3, 7, v1
    v_xor_b32 v3, v3, v10
    v_lshlrev_b32 v3, 4, v3
    v_lshl_add_u32 v3, v2, 7, v3
    v_add_u32 v15, 30720, v3
    v_xor_b32 v16, 64, v15
    s_lshl_b32 s26, s24, 12
    s_add_u32 s26, s26, 2048
    v_add_u32 v13, s26, v15
    v_add_u32 v14, s26, v16
    s_waitcnt vmcnt(6)
    s_barrier
    ds_read_b128 v[52:55], v13 offset:0
    ds_read_b128 v[56:59], v13 offset:2048
    ds_read_b64_tr_b16 v[28:29], v11 offset:0
    ds_read_b64_tr_b16 v[30:31], v11 offset:7680
    ds_read_b64_tr_b16 v[32:33], v11 offset:8
    ds_read_b64_tr_b16 v[34:35], v11 offset:7688
    ds_read_b64_tr_b16 v[36:37], v11 offset:16
    ds_read_b64_tr_b16 v[38:39], v11 offset:7696
    ds_read_b64_tr_b16 v[40:41], v11 offset:24
    ds_read_b64_tr_b16 v[42:43], v11 offset:7704
    ds_read_b64_tr_b16 v[44:45], v11 offset:32
    ds_read_b64_tr_b16 v[46:47], v11 offset:7712
    ds_read_b64_tr_b16 v[48:49], v12 offset:0
    ds_read_b64_tr_b16 v[50:51], v12 offset:7680
    s_waitcnt lgkmcnt(10)
    v_mfma_f32_16x16x32_bf16 v[76:79], v[28:31], v[52:55], 0
    v_mfma_f32_16x16x32_bf16 v[108:111], v[28:31], v[56:59], 0
    s_mul_i32 s26, s23, 6144
    s_add_u32 m0, s26, 98304
    s_add_u32 s34, s38, 2
    s_sub_u32 s27, s34, 10
    s_cmp_ge_u32 s34, 10
    s_cselect_b32 s34, s27, s34
    s_mul_i32 s34, s35, s34
    buffer_load_dwordx4 v20, s[40:43], s34 offen lds
    ds_read_b64_tr_b16 v[28:29], v12 offset:8
    ds_read_b64_tr_b16 v[30:31], v12 offset:7688
    s_waitcnt lgkmcnt(10)
    v_mfma_f32_16x16x32_bf16 v[80:83], v[32:35], v[52:55], 0
    v_mfma_f32_16x16x32_bf16 v[112:115], v[32:35], v[56:59], 0
    s_mul_i32 s26, s23, 6144
    s_add_u32 m0, s26, 99328
    s_add_u32 s34, s38, 2
    s_sub_u32 s27, s34, 10
    s_cmp_ge_u32 s34, 10
    s_cselect_b32 s34, s27, s34
    s_mul_i32 s34, s35, s34
    buffer_load_dwordx4 v21, s[40:43], s34 offen lds
    ds_read_b64_tr_b16 v[32:33], v12 offset:16
    ds_read_b64_tr_b16 v[34:35], v12 offset:7696
    s_waitcnt lgkmcnt(10)
    v_mfma_f32_16x16x32_bf16 v[84:87], v[36:39], v[52:55], 0
    v_mfma_f32_16x16x32_bf16 v[116:119], v[36:39], v[56:59], 0
    s_mul_i32 s26, s23, 6144
    s_add_u32 m0, s26, 100352
    s_add_u32 s34, s38, 2
    s_sub_u32 s27, s34, 10
    s_cmp_ge_u32 s34, 10
    s_cselect_b32 s34, s27, s34
    s_mul_i32 s34, s35, s34
    buffer_load_dwordx4 v22, s[40:43], s34 offen lds
    ds_read_b128 v[64:67], v14 offset:0
    ds_read_b128 v[68:71], v14 offset:2048
    ds_read_b64_tr_b16 v[36:37], v11 offset:15360
    ds_read_b64_tr_b16 v[38:39], v11 offset:23040
    s_waitcnt lgkmcnt(12)
    v_mfma_f32_16x16x32_bf16 v[88:91], v[40:43], v[52:55], 0
    v_mfma_f32_16x16x32_bf16 v[120:123], v[40:43], v[56:59], 0
    s_mul_i32 s26, s23, 6144
    s_add_u32 m0, s26, 101376
    s_add_u32 s34, s38, 2
    s_sub_u32 s27, s34, 10
    s_cmp_ge_u32 s34, 10
    s_cselect_b32 s34, s27, s34
    s_mul_i32 s34, s35, s34
    buffer_load_dwordx4 v23, s[40:43], s34 offen lds
    ds_read_b64_tr_b16 v[40:41], v11 offset:15368
    ds_read_b64_tr_b16 v[42:43], v11 offset:23048
    s_waitcnt lgkmcnt(12)
    v_mfma_f32_16x16x32_bf16 v[92:95], v[44:47], v[52:55], 0
    v_mfma_f32_16x16x32_bf16 v[124:127], v[44:47], v[56:59], 0
    s_mul_i32 s26, s23, 6144
    s_add_u32 m0, s26, 102400
    s_add_u32 s34, s38, 2
    s_sub_u32 s27, s34, 10
    s_cmp_ge_u32 s34, 10
    s_cselect_b32 s34, s27, s34
    s_mul_i32 s34, s35, s34
    buffer_load_dwordx4 v24, s[40:43], s34 offen lds
    ds_read_b64_tr_b16 v[44:45], v11 offset:15376
    ds_read_b64_tr_b16 v[46:47], v11 offset:23056
    s_waitcnt lgkmcnt(12)
    v_mfma_f32_16x16x32_bf16 v[96:99], v[48:51], v[52:55], 0
    v_mfma_f32_16x16x32_bf16 v[128:131], v[48:51], v[56:59], 0
    s_mul_i32 s26, s23, 6144
    s_add_u32 m0, s26, 103424
    s_add_u32 s34, s38, 2
    s_sub_u32 s27, s34, 10
    s_cmp_ge_u32 s34, 10
    s_cselect_b32 s34, s27, s34
    s_mul_i32 s34, s35, s34
    buffer_load_dwordx4 v25, s[40:43], s34 offen lds
    ds_read_b64_tr_b16 v[48:49], v11 offset:15384
    ds_read_b64_tr_b16 v[50:51], v11 offset:23064
    s_waitcnt lgkmcnt(12)
    v_mfma_f32_16x16x32_bf16 v[100:103], v[28:31], v[52:55], 0
    v_mfma_f32_16x16x32_bf16 v[132:135], v[28:31], v[56:59], 0
    ds_read_b64_tr_b16 v[28:29], v11 offset:15392
    ds_read_b64_tr_b16 v[30:31], v11 offset:23072
    s_waitcnt lgkmcnt(12)
    v_mfma_f32_16x16x32_bf16 v[104:107], v[32:35], v[52:55], 0
    v_mfma_f32_16x16x32_bf16 v[136:139], v[32:35], v[56:59], 0
    ds_read_b64_tr_b16 v[32:33], v12 offset:15360
    ds_read_b64_tr_b16 v[34:35], v12 offset:23040
    s_waitcnt lgkmcnt(10)
    v_mfma_f32_16x16x32_bf16 v[76:79], v[36:39], v[64:67], v[76:79]
    v_mfma_f32_16x16x32_bf16 v[108:111], v[36:39], v[68:71], v[108:111]
    ds_read_b64_tr_b16 v[36:37], v12 offset:15368
    ds_read_b64_tr_b16 v[38:39], v12 offset:23048
    s_waitcnt lgkmcnt(10)
    v_mfma_f32_16x16x32_bf16 v[80:83], v[40:43], v[64:67], v[80:83]
    v_mfma_f32_16x16x32_bf16 v[112:115], v[40:43], v[68:71], v[112:115]
    ds_read_b64_tr_b16 v[40:41], v12 offset:15376
    ds_read_b64_tr_b16 v[42:43], v12 offset:23056
    s_waitcnt lgkmcnt(10)
    v_mfma_f32_16x16x32_bf16 v[84:87], v[44:47], v[64:67], v[84:87]
    v_mfma_f32_16x16x32_bf16 v[116:119], v[44:47], v[68:71], v[116:119]
    s_waitcnt lgkmcnt(8)
    v_mfma_f32_16x16x32_bf16 v[88:91], v[48:51], v[64:67], v[88:91]
    v_mfma_f32_16x16x32_bf16 v[120:123], v[48:51], v[68:71], v[120:123]
    s_waitcnt lgkmcnt(6)
    v_mfma_f32_16x16x32_bf16 v[92:95], v[28:31], v[64:67], v[92:95]
    v_mfma_f32_16x16x32_bf16 v[124:127], v[28:31], v[68:71], v[124:127]
    s_waitcnt vmcnt(6) lgkmcnt(0)
    s_barrier
    v_add_u32 v11, 49152, v11
    v_add_u32 v12, 49152, v12
    v_add_u32 v13, 49152, v13
    v_add_u32 v14, 49152, v14
    ds_read_b128 v[52:55], v13 offset:0
    ds_read_b128 v[56:59], v13 offset:2048
    ds_read_b64_tr_b16 v[44:45], v11 offset:0
    ds_read_b64_tr_b16 v[46:47], v11 offset:7680
    ds_read_b64_tr_b16 v[48:49], v11 offset:8
    ds_read_b64_tr_b16 v[50:51], v11 offset:7688
    ds_read_b64_tr_b16 v[28:29], v11 offset:16
    ds_read_b64_tr_b16 v[30:31], v11 offset:7696
    v_mfma_f32_16x16x32_bf16 v[96:99], v[32:35], v[64:67], v[96:99]
    v_mfma_f32_16x16x32_bf16 v[128:131], v[32:35], v[68:71], v[128:131]
    s_mul_i32 s26, s23, 6144
    s_add_u32 m0, s26, 0
    s_add_u32 s34, s38, 3
    s_sub_u32 s27, s34, 10
    s_cmp_ge_u32 s34, 10
    s_cselect_b32 s34, s27, s34
    s_mul_i32 s34, s35, s34
    buffer_load_dwordx4 v20, s[40:43], s34 offen lds
    ds_read_b64_tr_b16 v[32:33], v11 offset:24
    ds_read_b64_tr_b16 v[34:35], v11 offset:7704
    v_mfma_f32_16x16x32_bf16 v[100:103], v[36:39], v[64:67], v[100:103]
    v_mfma_f32_16x16x32_bf16 v[132:135], v[36:39], v[68:71], v[132:135]
    s_mul_i32 s26, s23, 6144
    s_add_u32 m0, s26, 1024
    s_add_u32 s34, s38, 3
    s_sub_u32 s27, s34, 10
    s_cmp_ge_u32 s34, 10
    s_cselect_b32 s34, s27, s34
    s_mul_i32 s34, s35, s34
    buffer_load_dwordx4 v21, s[40:43], s34 offen lds
    ds_read_b64_tr_b16 v[36:37], v11 offset:32
    ds_read_b64_tr_b16 v[38:39], v11 offset:7712
    v_mfma_f32_16x16x32_bf16 v[104:107], v[40:43], v[64:67], v[104:107]
    v_mfma_f32_16x16x32_bf16 v[136:139], v[40:43], v[68:71], v[136:139]
    s_mul_i32 s26, s23, 6144
    s_add_u32 m0, s26, 2048
    s_add_u32 s34, s38, 3
    s_sub_u32 s27, s34, 10
    s_cmp_ge_u32 s34, 10
    s_cselect_b32 s34, s27, s34
    s_mul_i32 s34, s35, s34
    buffer_load_dwordx4 v22, s[40:43], s34 offen lds
    ds_read_b64_tr_b16 v[40:41], v12 offset:0
    ds_read_b64_tr_b16 v[42:43], v12 offset:7680
    s_waitcnt lgkmcnt(10)
    v_mfma_f32_16x16x32_bf16 v[76:79], v[44:47], v[52:55], v[76:79]
    v_mfma_f32_16x16x32_bf16 v[108:111], v[44:47], v[56:59], v[108:111]
    s_mul_i32 s26, s23, 6144
    s_add_u32 m0, s26, 3072
    s_add_u32 s34, s38, 3
    s_sub_u32 s27, s34, 10
    s_cmp_ge_u32 s34, 10
    s_cselect_b32 s34, s27, s34
    s_mul_i32 s34, s35, s34
    buffer_load_dwordx4 v23, s[40:43], s34 offen lds
    ds_read_b64_tr_b16 v[44:45], v12 offset:8
    ds_read_b64_tr_b16 v[46:47], v12 offset:7688
    s_waitcnt lgkmcnt(10)
    v_mfma_f32_16x16x32_bf16 v[80:83], v[48:51], v[52:55], v[80:83]
    v_mfma_f32_16x16x32_bf16 v[112:115], v[48:51], v[56:59], v[112:115]
    s_mul_i32 s26, s23, 6144
    s_add_u32 m0, s26, 4096
    s_add_u32 s34, s38, 3
    s_sub_u32 s27, s34, 10
    s_cmp_ge_u32 s34, 10
    s_cselect_b32 s34, s27, s34
    s_mul_i32 s34, s35, s34
    buffer_load_dwordx4 v24, s[40:43], s34 offen lds
    ds_read_b64_tr_b16 v[48:49], v12 offset:16
    ds_read_b64_tr_b16 v[50:51], v12 offset:7696
    s_waitcnt lgkmcnt(10)
    v_mfma_f32_16x16x32_bf16 v[84:87], v[28:31], v[52:55], v[84:87]
    v_mfma_f32_16x16x32_bf16 v[116:119], v[28:31], v[56:59], v[116:119]
    s_mul_i32 s26, s23, 6144
    s_add_u32 m0, s26, 5120
    s_add_u32 s34, s38, 3
    s_sub_u32 s27, s34, 10
    s_cmp_ge_u32 s34, 10
    s_cselect_b32 s34, s27, s34
    s_mul_i32 s34, s35, s34
    buffer_load_dwordx4 v25, s[40:43], s34 offen lds
    ds_read_b128 v[64:67], v14 offset:0
    ds_read_b128 v[68:71], v14 offset:2048
    ds_read_b64_tr_b16 v[28:29], v11 offset:15360
    ds_read_b64_tr_b16 v[30:31], v11 offset:23040
    s_waitcnt lgkmcnt(12)
    v_mfma_f32_16x16x32_bf16 v[88:91], v[32:35], v[52:55], v[88:91]
    v_mfma_f32_16x16x32_bf16 v[120:123], v[32:35], v[56:59], v[120:123]
    ds_read_b64_tr_b16 v[32:33], v11 offset:15368
    ds_read_b64_tr_b16 v[34:35], v11 offset:23048
    s_waitcnt lgkmcnt(12)
    v_mfma_f32_16x16x32_bf16 v[92:95], v[36:39], v[52:55], v[92:95]
    v_mfma_f32_16x16x32_bf16 v[124:127], v[36:39], v[56:59], v[124:127]
    ds_read_b64_tr_b16 v[36:37], v11 offset:15376
    ds_read_b64_tr_b16 v[38:39], v11 offset:23056
    s_waitcnt lgkmcnt(12)
    v_mfma_f32_16x16x32_bf16 v[96:99], v[40:43], v[52:55], v[96:99]
    v_mfma_f32_16x16x32_bf16 v[128:131], v[40:43], v[56:59], v[128:131]
    ds_read_b64_tr_b16 v[40:41], v11 offset:15384
    ds_read_b64_tr_b16 v[42:43], v11 offset:23064
    s_waitcnt lgkmcnt(12)
    v_mfma_f32_16x16x32_bf16 v[100:103], v[44:47], v[52:55], v[100:103]
    v_mfma_f32_16x16x32_bf16 v[132:135], v[44:47], v[56:59], v[132:135]
    ds_read_b64_tr_b16 v[44:45], v11 offset:15392
    ds_read_b64_tr_b16 v[46:47], v11 offset:23072
    s_waitcnt lgkmcnt(12)
    v_mfma_f32_16x16x32_bf16 v[104:107], v[48:51], v[52:55], v[104:107]
    v_mfma_f32_16x16x32_bf16 v[136:139], v[48:51], v[56:59], v[136:139]
    ds_read_b64_tr_b16 v[48:49], v12 offset:15360
    ds_read_b64_tr_b16 v[50:51], v12 offset:23040
    s_waitcnt lgkmcnt(10)
    v_mfma_f32_16x16x32_bf16 v[76:79], v[28:31], v[64:67], v[76:79]
    v_mfma_f32_16x16x32_bf16 v[108:111], v[28:31], v[68:71], v[108:111]
    ds_read_b64_tr_b16 v[28:29], v12 offset:15368
    ds_read_b64_tr_b16 v[30:31], v12 offset:23048
    s_waitcnt lgkmcnt(10)
    v_mfma_f32_16x16x32_bf16 v[80:83], v[32:35], v[64:67], v[80:83]
    v_mfma_f32_16x16x32_bf16 v[112:115], v[32:35], v[68:71], v[112:115]
    ds_read_b64_tr_b16 v[32:33], v12 offset:15376
    ds_read_b64_tr_b16 v[34:35], v12 offset:23056
    s_waitcnt lgkmcnt(10)
    v_mfma_f32_16x16x32_bf16 v[84:87], v[36:39], v[64:67], v[84:87]
    v_mfma_f32_16x16x32_bf16 v[116:119], v[36:39], v[68:71], v[116:119]
    s_waitcnt lgkmcnt(8)
    v_mfma_f32_16x16x32_bf16 v[88:91], v[40:43], v[64:67], v[88:91]
    v_mfma_f32_16x16x32_bf16 v[120:123], v[40:43], v[68:71], v[120:123]
    s_waitcnt lgkmcnt(6)
    v_mfma_f32_16x16x32_bf16 v[92:95], v[44:47], v[64:67], v[92:95]
    v_mfma_f32_16x16x32_bf16 v[124:127], v[44:47], v[68:71], v[124:127]
    s_waitcnt vmcnt(6) lgkmcnt(0)
    s_barrier
    s_cmp_ge_u32 s96, 1600
    s_cbranch_scc1 K1_rsA
    s_lshl_b32 s26, s96, 10
    s_add_u32 s26, s26, 29360128
    v_lshlrev_b32 v184, 4, v1
    buffer_store_dwordx4 v[180:183], v184, s[12:15], s26 offen sc1
K1_rsA:
    v_cmp_gt_u32 vcc, 200, v0
    s_and_saveexec_b64 s[28:29], vcc
    s_cbranch_execz K1_wp1
    v_add_u32 v149, 147456, v148
    ds_write_b128 v149, v[152:155]
K1_wp1:
    s_mov_b64 exec, s[28:29]
    v_cmp_gt_u32 vcc, 64, v0
    s_and_saveexec_b64 s[28:29], vcc
    s_cbranch_execz K1_wp2
    v_mov_b32 v156, 0
    v_mov_b32 v157, 0
    v_mov_b32 v158, 0
    v_mov_b32 v159, 0
    v_add_u32 v149, 150656, v148
    ds_write_b128 v149, v[156:159]
K1_wp2:
    s_mov_b64 exec, s[28:29]
    s_waitcnt lgkmcnt(0)
    v_add_u32 v11, 49152, v11
    v_add_u32 v12, 49152, v12
    v_add_u32 v13, 49152, v13
    v_add_u32 v14, 49152, v14
    ds_read_b128 v[52:55], v13 offset:0
    ds_read_b128 v[56:59], v13 offset:2048
    ds_read_b64_tr_b16 v[36:37], v11 offset:0
    ds_read_b64_tr_b16 v[38:39], v11 offset:7680
    ds_read_b64_tr_b16 v[40:41], v11 offset:8
    ds_read_b64_tr_b16 v[42:43], v11 offset:7688
    ds_read_b64_tr_b16 v[44:45], v11 offset:16
    ds_read_b64_tr_b16 v[46:47], v11 offset:7696
    v_mfma_f32_16x16x32_bf16 v[96:99], v[48:51], v[64:67], v[96:99]
    v_mfma_f32_16x16x32_bf16 v[128:131], v[48:51], v[68:71], v[128:131]
    s_mul_i32 s26, s23, 6144
    s_add_u32 m0, s26, 49152
    s_add_u32 s34, s38, 4
    s_sub_u32 s27, s34, 10
    s_cmp_ge_u32 s34, 10
    s_cselect_b32 s34, s27, s34
    s_mul_i32 s34, s35, s34
    buffer_load_dwordx4 v20, s[40:43], s34 offen lds
    ds_read_b64_tr_b16 v[48:49], v11 offset:24
    ds_read_b64_tr_b16 v[50:51], v11 offset:7704
    v_mfma_f32_16x16x32_bf16 v[100:103], v[28:31], v[64:67], v[100:103]
    v_mfma_f32_16x16x32_bf16 v[132:135], v[28:31], v[68:71], v[132:135]
    s_mul_i32 s26, s23, 6144
    s_add_u32 m0, s26, 50176
    s_add_u32 s34, s38, 4
    s_sub_u32 s27, s34, 10
    s_cmp_ge_u32 s34, 10
    s_cselect_b32 s34, s27, s34
    s_mul_i32 s34, s35, s34
    buffer_load_dwordx4 v21, s[40:43], s34 offen lds
    ds_read_b64_tr_b16 v[28:29], v11 offset:32
    ds_read_b64_tr_b16 v[30:31], v11 offset:7712
    v_mfma_f32_16x16x32_bf16 v[104:107], v[32:35], v[64:67], v[104:107]
    v_mfma_f32_16x16x32_bf16 v[136:139], v[32:35], v[68:71], v[136:139]
    s_mul_i32 s26, s23, 6144
    s_add_u32 m0, s26, 51200
    s_add_u32 s34, s38, 4
    s_sub_u32 s27, s34, 10
    s_cmp_ge_u32 s34, 10
    s_cselect_b32 s34, s27, s34
    s_mul_i32 s34, s35, s34
    buffer_load_dwordx4 v22, s[40:43], s34 offen lds
    ds_read_b64_tr_b16 v[32:33], v12 offset:0
    ds_read_b64_tr_b16 v[34:35], v12 offset:7680
    s_waitcnt lgkmcnt(10)
    v_mfma_f32_16x16x32_bf16 v[76:79], v[36:39], v[52:55], v[76:79]
    v_mfma_f32_16x16x32_bf16 v[108:111], v[36:39], v[56:59], v[108:111]
    s_mul_i32 s26, s23, 6144
    s_add_u32 m0, s26, 52224
    s_add_u32 s34, s38, 4
    s_sub_u32 s27, s34, 10
    s_cmp_ge_u32 s34, 10
    s_cselect_b32 s34, s27, s34
    s_mul_i32 s34, s35, s34
    buffer_load_dwordx4 v23, s[40:43], s34 offen lds
    ds_read_b64_tr_b16 v[36:37], v12 offset:8
    ds_read_b64_tr_b16 v[38:39], v12 offset:7688
    s_waitcnt lgkmcnt(10)
    v_mfma_f32_16x16x32_bf16 v[80:83], v[40:43], v[52:55], v[80:83]
    v_mfma_f32_16x16x32_bf16 v[112:115], v[40:43], v[56:59], v[112:115]
    s_mul_i32 s26, s23, 6144
    s_add_u32 m0, s26, 53248
    s_add_u32 s34, s38, 4
    s_sub_u32 s27, s34, 10
    s_cmp_ge_u32 s34, 10
    s_cselect_b32 s34, s27, s34
    s_mul_i32 s34, s35, s34
    buffer_load_dwordx4 v24, s[40:43], s34 offen lds
    ds_read_b64_tr_b16 v[40:41], v12 offset:16
    ds_read_b64_tr_b16 v[42:43], v12 offset:7696
    s_waitcnt lgkmcnt(10)
    v_mfma_f32_16x16x32_bf16 v[84:87], v[44:47], v[52:55], v[84:87]
    v_mfma_f32_16x16x32_bf16 v[116:119], v[44:47], v[56:59], v[116:119]
    s_mul_i32 s26, s23, 6144
    s_add_u32 m0, s26, 54272
    s_add_u32 s34, s38, 4
    s_sub_u32 s27, s34, 10
    s_cmp_ge_u32 s34, 10
    s_cselect_b32 s34, s27, s34
    s_mul_i32 s34, s35, s34
    buffer_load_dwordx4 v25, s[40:43], s34 offen lds
    ds_read_b128 v[64:67], v14 offset:0
    ds_read_b128 v[68:71], v14 offset:2048
    ds_read_b64_tr_b16 v[44:45], v11 offset:15360
    ds_read_b64_tr_b16 v[46:47], v11 offset:23040
    s_waitcnt lgkmcnt(12)
    v_mfma_f32_16x16x32_bf16 v[88:91], v[48:51], v[52:55], v[88:91]
    v_mfma_f32_16x16x32_bf16 v[120:123], v[48:51], v[56:59], v[120:123]
    ds_read_b64_tr_b16 v[48:49], v11 offset:15368
    ds_read_b64_tr_b16 v[50:51], v11 offset:23048
    s_waitcnt lgkmcnt(12)
    v_mfma_f32_16x16x32_bf16 v[92:95], v[28:31], v[52:55], v[92:95]
    v_mfma_f32_16x16x32_bf16 v[124:127], v[28:31], v[56:59], v[124:127]
    ds_read_b64_tr_b16 v[28:29], v11 offset:15376
    ds_read_b64_tr_b16 v[30:31], v11 offset:23056
    s_waitcnt lgkmcnt(12)
    v_mfma_f32_16x16x32_bf16 v[96:99], v[32:35], v[52:55], v[96:99]
    v_mfma_f32_16x16x32_bf16 v[128:131], v[32:35], v[56:59], v[128:131]
    ds_read_b64_tr_b16 v[32:33], v11 offset:15384
    ds_read_b64_tr_b16 v[34:35], v11 offset:23064
    s_waitcnt lgkmcnt(12)
    v_mfma_f32_16x16x32_bf16 v[100:103], v[36:39], v[52:55], v[100:103]
    v_mfma_f32_16x16x32_bf16 v[132:135], v[36:39], v[56:59], v[132:135]
    ds_read_b64_tr_b16 v[36:37], v11 offset:15392
    ds_read_b64_tr_b16 v[38:39], v11 offset:23072
    s_waitcnt lgkmcnt(12)
    v_mfma_f32_16x16x32_bf16 v[104:107], v[40:43], v[52:55], v[104:107]
    v_mfma_f32_16x16x32_bf16 v[136:139], v[40:43], v[56:59], v[136:139]
    ds_read_b64_tr_b16 v[40:41], v12 offset:15360
    ds_read_b64_tr_b16 v[42:43], v12 offset:23040
    s_waitcnt lgkmcnt(10)
    v_mfma_f32_16x16x32_bf16 v[76:79], v[44:47], v[64:67], v[76:79]
    v_mfma_f32_16x16x32_bf16 v[108:111], v[44:47], v[68:71], v[108:111]
    ds_read_b64_tr_b16 v[44:45], v12 offset:15368
    ds_read_b64_tr_b16 v[46:47], v12 offset:23048
    s_waitcnt lgkmcnt(10)
    v_mfma_f32_16x16x32_bf16 v[80:83], v[48:51], v[64:67], v[80:83]
    v_mfma_f32_16x16x32_bf16 v[112:115], v[48:51], v[68:71], v[112:115]
    ds_read_b64_tr_b16 v[48:49], v12 offset:15376
    ds_read_b64_tr_b16 v[50:51], v12 offset:23056
    s_waitcnt lgkmcnt(10)
    v_mfma_f32_16x16x32_bf16 v[84:87], v[28:31], v[64:67], v[84:87]
    v_mfma_f32_16x16x32_bf16 v[116:119], v[28:31], v[68:71], v[116:119]
    s_waitcnt lgkmcnt(8)
    v_mfma_f32_16x16x32_bf16 v[88:91], v[32:35], v[64:67], v[88:91]
    v_mfma_f32_16x16x32_bf16 v[120:123], v[32:35], v[68:71], v[120:123]
    s_waitcnt lgkmcnt(6)
    v_mfma_f32_16x16x32_bf16 v[92:95], v[36:39], v[64:67], v[92:95]
    v_mfma_f32_16x16x32_bf16 v[124:127], v[36:39], v[68:71], v[124:127]
    s_waitcnt vmcnt(6) lgkmcnt(0)
    s_barrier
    v_subrev_u32 v11, 98304, v11
    v_subrev_u32 v12, 98304, v12
    v_subrev_u32 v13, 98304, v13
    v_subrev_u32 v14, 98304, v14
    ds_read_b128 v[52:55], v13 offset:0
    ds_read_b128 v[56:59], v13 offset:2048
    ds_read_b64_tr_b16 v[28:29], v11 offset:0
    ds_read_b64_tr_b16 v[30:31], v11 offset:7680
    ds_read_b64_tr_b16 v[32:33], v11 offset:8
    ds_read_b64_tr_b16 v[34:35], v11 offset:7688
    ds_read_b64_tr_b16 v[36:37], v11 offset:16
    ds_read_b64_tr_b16 v[38:39], v11 offset:7696
    v_mfma_f32_16x16x32_bf16 v[96:99], v[40:43], v[64:67], v[96:99]
    v_mfma_f32_16x16x32_bf16 v[128:131], v[40:43], v[68:71], v[128:131]
    s_mul_i32 s26, s23, 6144
    s_add_u32 m0, s26, 98304
    s_add_u32 s34, s38, 5
    s_sub_u32 s27, s34, 10
    s_cmp_ge_u32 s34, 10
    s_cselect_b32 s34, s27, s34
    s_mul_i32 s34, s35, s34
    buffer_load_dwordx4 v20, s[40:43], s34 offen lds
    ds_read_b64_tr_b16 v[40:41], v11 offset:24
    ds_read_b64_tr_b16 v[42:43], v11 offset:7704
    v_mfma_f32_16x16x32_bf16 v[100:103], v[44:47], v[64:67], v[100:103]
    v_mfma_f32_16x16x32_bf16 v[132:135], v[44:47], v[68:71], v[132:135]
    s_mul_i32 s26, s23, 6144
    s_add_u32 m0, s26, 99328
    s_add_u32 s34, s38, 5
    s_sub_u32 s27, s34, 10
    s_cmp_ge_u32 s34, 10
    s_cselect_b32 s34, s27, s34
    s_mul_i32 s34, s35, s34
    buffer_load_dwordx4 v21, s[40:43], s34 offen lds
    ds_read_b64_tr_b16 v[44:45], v11 offset:32
    ds_read_b64_tr_b16 v[46:47], v11 offset:7712
    v_mfma_f32_16x16x32_bf16 v[104:107], v[48:51], v[64:67], v[104:107]
    v_mfma_f32_16x16x32_bf16 v[136:139], v[48:51], v[68:71], v[136:139]
    s_mul_i32 s26, s23, 6144
    s_add_u32 m0, s26, 100352
    s_add_u32 s34, s38, 5
    s_sub_u32 s27, s34, 10
    s_cmp_ge_u32 s34, 10
    s_cselect_b32 s34, s27, s34
    s_mul_i32 s34, s35, s34
    buffer_load_dwordx4 v22, s[40:43], s34 offen lds
    ds_read_b64_tr_b16 v[48:49], v12 offset:0
    ds_read_b64_tr_b16 v[50:51], v12 offset:7680
    s_waitcnt lgkmcnt(10)
    v_mfma_f32_16x16x32_bf16 v[76:79], v[28:31], v[52:55], v[76:79]
    v_mfma_f32_16x16x32_bf16 v[108:111], v[28:31], v[56:59], v[108:111]
    s_mul_i32 s26, s23, 6144
    s_add_u32 m0, s26, 101376
    s_add_u32 s34, s38, 5
    s_sub_u32 s27, s34, 10
    s_cmp_ge_u32 s34, 10
    s_cselect_b32 s34, s27, s34
    s_mul_i32 s34, s35, s34
    buffer_load_dwordx4 v23, s[40:43], s34 offen lds
    ds_read_b64_tr_b16 v[28:29], v12 offset:8
    ds_read_b64_tr_b16 v[30:31], v12 offset:7688
    s_waitcnt lgkmcnt(10)
    v_mfma_f32_16x16x32_bf16 v[80:83], v[32:35], v[52:55], v[80:83]
    v_mfma_f32_16x16x32_bf16 v[112:115], v[32:35], v[56:59], v[112:115]
    s_mul_i32 s26, s23, 6144
    s_add_u32 m0, s26, 102400
    s_add_u32 s34, s38, 5
    s_sub_u32 s27, s34, 10
    s_cmp_ge_u32 s34, 10
    s_cselect_b32 s34, s27, s34
    s_mul_i32 s34, s35, s34
    buffer_load_dwordx4 v24, s[40:43], s34 offen lds
    ds_read_b64_tr_b16 v[32:33], v12 offset:16
    ds_read_b64_tr_b16 v[34:35], v12 offset:7696
    s_waitcnt lgkmcnt(10)
    v_mfma_f32_16x16x32_bf16 v[84:87], v[36:39], v[52:55], v[84:87]
    v_mfma_f32_16x16x32_bf16 v[116:119], v[36:39], v[56:59], v[116:119]
    s_mul_i32 s26, s23, 6144
    s_add_u32 m0, s26, 103424
    s_add_u32 s34, s38, 5
    s_sub_u32 s27, s34, 10
    s_cmp_ge_u32 s34, 10
    s_cselect_b32 s34, s27, s34
    s_mul_i32 s34, s35, s34
    buffer_load_dwordx4 v25, s[40:43], s34 offen lds
    ds_read_b128 v[64:67], v14 offset:0
    ds_read_b128 v[68:71], v14 offset:2048
    ds_read_b64_tr_b16 v[36:37], v11 offset:15360
    ds_read_b64_tr_b16 v[38:39], v11 offset:23040
    s_waitcnt lgkmcnt(12)
    v_mfma_f32_16x16x32_bf16 v[88:91], v[40:43], v[52:55], v[88:91]
    v_mfma_f32_16x16x32_bf16 v[120:123], v[40:43], v[56:59], v[120:123]
    ds_read_b64_tr_b16 v[40:41], v11 offset:15368
    ds_read_b64_tr_b16 v[42:43], v11 offset:23048
    s_waitcnt lgkmcnt(12)
    v_mfma_f32_16x16x32_bf16 v[92:95], v[44:47], v[52:55], v[92:95]
    v_mfma_f32_16x16x32_bf16 v[124:127], v[44:47], v[56:59], v[124:127]
    ds_read_b64_tr_b16 v[44:45], v11 offset:15376
    ds_read_b64_tr_b16 v[46:47], v11 offset:23056
    s_waitcnt lgkmcnt(12)
    v_mfma_f32_16x16x32_bf16 v[96:99], v[48:51], v[52:55], v[96:99]
    v_mfma_f32_16x16x32_bf16 v[128:131], v[48:51], v[56:59], v[128:131]
    ds_read_b64_tr_b16 v[48:49], v11 offset:15384
    ds_read_b64_tr_b16 v[50:51], v11 offset:23064
    s_waitcnt lgkmcnt(12)
    v_mfma_f32_16x16x32_bf16 v[100:103], v[28:31], v[52:55], v[100:103]
    v_mfma_f32_16x16x32_bf16 v[132:135], v[28:31], v[56:59], v[132:135]
    ds_read_b64_tr_b16 v[28:29], v11 offset:15392
    ds_read_b64_tr_b16 v[30:31], v11 offset:23072
    s_waitcnt lgkmcnt(12)
    v_mfma_f32_16x16x32_bf16 v[104:107], v[32:35], v[52:55], v[104:107]
    v_mfma_f32_16x16x32_bf16 v[136:139], v[32:35], v[56:59], v[136:139]
    ds_read_b64_tr_b16 v[32:33], v12 offset:15360
    ds_read_b64_tr_b16 v[34:35], v12 offset:23040
    s_waitcnt lgkmcnt(10)
    v_mfma_f32_16x16x32_bf16 v[76:79], v[36:39], v[64:67], v[76:79]
    v_mfma_f32_16x16x32_bf16 v[108:111], v[36:39], v[68:71], v[108:111]
    ds_read_b64_tr_b16 v[36:37], v12 offset:15368
    ds_read_b64_tr_b16 v[38:39], v12 offset:23048
    s_waitcnt lgkmcnt(10)
    v_mfma_f32_16x16x32_bf16 v[80:83], v[40:43], v[64:67], v[80:83]
    v_mfma_f32_16x16x32_bf16 v[112:115], v[40:43], v[68:71], v[112:115]
    ds_read_b64_tr_b16 v[40:41], v12 offset:15376
    ds_read_b64_tr_b16 v[42:43], v12 offset:23056
    s_waitcnt lgkmcnt(10)
    v_mfma_f32_16x16x32_bf16 v[84:87], v[44:47], v[64:67], v[84:87]
    v_mfma_f32_16x16x32_bf16 v[116:119], v[44:47], v[68:71], v[116:119]
    s_waitcnt lgkmcnt(8)
    v_mfma_f32_16x16x32_bf16 v[88:91], v[48:51], v[64:67], v[88:91]
    v_mfma_f32_16x16x32_bf16 v[120:123], v[48:51], v[68:71], v[120:123]
    s_waitcnt lgkmcnt(6)
    v_mfma_f32_16x16x32_bf16 v[92:95], v[28:31], v[64:67], v[92:95]
    v_mfma_f32_16x16x32_bf16 v[124:127], v[28:31], v[68:71], v[124:127]
    s_waitcnt vmcnt(6) lgkmcnt(0)
    s_barrier
    s_cmp_lg_u32 s23, 7
    s_cbranch_scc1 K1_stA
    s_load_dwordx2 s[44:45], s[0:1], 72
    s_waitcnt lgkmcnt(0)
    s_mov_b32 s48, s44
    s_and_b32 s49, s45, 0xffff
    s_mov_b32 s50, 256
    s_mov_b32 s51, 0x00020000
    v_mov_b32 v2, 0
    v_mov_b32 v3, 1
    s_mov_b64 exec, 1
    buffer_atomic_add v3, v2, s[48:51], 0 offen sc1
    s_mov_b64 exec, -1
K1_stA:
    v_add_u32 v11, 49152, v11
    v_add_u32 v12, 49152, v12
    v_add_u32 v13, 49152, v13
    v_add_u32 v14, 49152, v14
    ds_read_b128 v[52:55], v13 offset:0
    ds_read_b128 v[56:59], v13 offset:2048
    ds_read_b64_tr_b16 v[44:45], v11 offset:0
    ds_read_b64_tr_b16 v[46:47], v11 offset:7680
    ds_read_b64_tr_b16 v[48:49], v11 offset:8
    ds_read_b64_tr_b16 v[50:51], v11 offset:7688
    ds_read_b64_tr_b16 v[28:29], v11 offset:16
    ds_read_b64_tr_b16 v[30:31], v11 offset:7696
    v_mfma_f32_16x16x32_bf16 v[96:99], v[32:35], v[64:67], v[96:99]
    v_mfma_f32_16x16x32_bf16 v[128:131], v[32:35], v[68:71], v[128:131]
    s_mul_i32 s26, s23, 6144
    s_add_u32 m0, s26, 0
    s_add_u32 s34, s38, 6
    s_sub_u32 s27, s34, 10
    s_cmp_ge_u32 s34, 10
    s_cselect_b32 s34, s27, s34
    s_mul_i32 s34, s35, s34
    buffer_load_dwordx4 v20, s[40:43], s34 offen lds
    ds_read_b64_tr_b16 v[32:33], v11 offset:24
    ds_read_b64_tr_b16 v[34:35], v11 offset:7704
    v_mfma_f32_16x16x32_bf16 v[100:103], v[36:39], v[64:67], v[100:103]
    v_mfma_f32_16x16x32_bf16 v[132:135], v[36:39], v[68:71], v[132:135]
    s_mul_i32 s26, s23, 6144
    s_add_u32 m0, s26, 1024
    s_add_u32 s34, s38, 6
    s_sub_u32 s27, s34, 10
    s_cmp_ge_u32 s34, 10
    s_cselect_b32 s34, s27, s34
    s_mul_i32 s34, s35, s34
    buffer_load_dwordx4 v21, s[40:43], s34 offen lds
    ds_read_b64_tr_b16 v[36:37], v11 offset:32
    ds_read_b64_tr_b16 v[38:39], v11 offset:7712
    v_mfma_f32_16x16x32_bf16 v[104:107], v[40:43], v[64:67], v[104:107]
    v_mfma_f32_16x16x32_bf16 v[136:139], v[40:43], v[68:71], v[136:139]
    s_mul_i32 s26, s23, 6144
    s_add_u32 m0, s26, 2048
    s_add_u32 s34, s38, 6
    s_sub_u32 s27, s34, 10
    s_cmp_ge_u32 s34, 10
    s_cselect_b32 s34, s27, s34
    s_mul_i32 s34, s35, s34
    buffer_load_dwordx4 v22, s[40:43], s34 offen lds
    ds_read_b64_tr_b16 v[40:41], v12 offset:0
    ds_read_b64_tr_b16 v[42:43], v12 offset:7680
    s_waitcnt lgkmcnt(10)
    v_mfma_f32_16x16x32_bf16 v[76:79], v[44:47], v[52:55], v[76:79]
    v_mfma_f32_16x16x32_bf16 v[108:111], v[44:47], v[56:59], v[108:111]
    s_mul_i32 s26, s23, 6144
    s_add_u32 m0, s26, 3072
    s_add_u32 s34, s38, 6
    s_sub_u32 s27, s34, 10
    s_cmp_ge_u32 s34, 10
    s_cselect_b32 s34, s27, s34
    s_mul_i32 s34, s35, s34
    buffer_load_dwordx4 v23, s[40:43], s34 offen lds
    ds_read_b64_tr_b16 v[44:45], v12 offset:8
    ds_read_b64_tr_b16 v[46:47], v12 offset:7688
    s_waitcnt lgkmcnt(10)
    v_mfma_f32_16x16x32_bf16 v[80:83], v[48:51], v[52:55], v[80:83]
    v_mfma_f32_16x16x32_bf16 v[112:115], v[48:51], v[56:59], v[112:115]
    s_mul_i32 s26, s23, 6144
    s_add_u32 m0, s26, 4096
    s_add_u32 s34, s38, 6
    s_sub_u32 s27, s34, 10
    s_cmp_ge_u32 s34, 10
    s_cselect_b32 s34, s27, s34
    s_mul_i32 s34, s35, s34
    buffer_load_dwordx4 v24, s[40:43], s34 offen lds
    ds_read_b64_tr_b16 v[48:49], v12 offset:16
    ds_read_b64_tr_b16 v[50:51], v12 offset:7696
    s_waitcnt lgkmcnt(10)
    v_mfma_f32_16x16x32_bf16 v[84:87], v[28:31], v[52:55], v[84:87]
    v_mfma_f32_16x16x32_bf16 v[116:119], v[28:31], v[56:59], v[116:119]
    s_mul_i32 s26, s23, 6144
    s_add_u32 m0, s26, 5120
    s_add_u32 s34, s38, 6
    s_sub_u32 s27, s34, 10
    s_cmp_ge_u32 s34, 10
    s_cselect_b32 s34, s27, s34
    s_mul_i32 s34, s35, s34
    buffer_load_dwordx4 v25, s[40:43], s34 offen lds
    ds_read_b128 v[64:67], v14 offset:0
    ds_read_b128 v[68:71], v14 offset:2048
    ds_read_b64_tr_b16 v[28:29], v11 offset:15360
    ds_read_b64_tr_b16 v[30:31], v11 offset:23040
    s_waitcnt lgkmcnt(12)
    v_mfma_f32_16x16x32_bf16 v[88:91], v[32:35], v[52:55], v[88:91]
    v_mfma_f32_16x16x32_bf16 v[120:123], v[32:35], v[56:59], v[120:123]
    ds_read_b64_tr_b16 v[32:33], v11 offset:15368
    ds_read_b64_tr_b16 v[34:35], v11 offset:23048
    s_waitcnt lgkmcnt(12)
    v_mfma_f32_16x16x32_bf16 v[92:95], v[36:39], v[52:55], v[92:95]
    v_mfma_f32_16x16x32_bf16 v[124:127], v[36:39], v[56:59], v[124:127]
    ds_read_b64_tr_b16 v[36:37], v11 offset:15376
    ds_read_b64_tr_b16 v[38:39], v11 offset:23056
    s_waitcnt lgkmcnt(12)
    v_mfma_f32_16x16x32_bf16 v[96:99], v[40:43], v[52:55], v[96:99]
    v_mfma_f32_16x16x32_bf16 v[128:131], v[40:43], v[56:59], v[128:131]
    ds_read_b64_tr_b16 v[40:41], v11 offset:15384
    ds_read_b64_tr_b16 v[42:43], v11 offset:23064
    s_waitcnt lgkmcnt(12)
    v_mfma_f32_16x16x32_bf16 v[100:103], v[44:47], v[52:55], v[100:103]
    v_mfma_f32_16x16x32_bf16 v[132:135], v[44:47], v[56:59], v[132:135]
    ds_read_b64_tr_b16 v[44:45], v11 offset:15392
    ds_read_b64_tr_b16 v[46:47], v11 offset:23072
    s_waitcnt lgkmcnt(12)
    v_mfma_f32_16x16x32_bf16 v[104:107], v[48:51], v[52:55], v[104:107]
    v_mfma_f32_16x16x32_bf16 v[136:139], v[48:51], v[56:59], v[136:139]
    ds_read_b64_tr_b16 v[48:49], v12 offset:15360
    ds_read_b64_tr_b16 v[50:51], v12 offset:23040
    s_waitcnt lgkmcnt(10)
    v_mfma_f32_16x16x32_bf16 v[76:79], v[28:31], v[64:67], v[76:79]
    v_mfma_f32_16x16x32_bf16 v[108:111], v[28:31], v[68:71], v[108:111]
    ds_read_b64_tr_b16 v[28:29], v12 offset:15368
    ds_read_b64_tr_b16 v[30:31], v12 offset:23048
    s_waitcnt lgkmcnt(10)
    v_mfma_f32_16x16x32_bf16 v[80:83], v[32:35], v[64:67], v[80:83]
    v_mfma_f32_16x16x32_bf16 v[112:115], v[32:35], v[68:71], v[112:115]
    ds_read_b64_tr_b16 v[32:33], v12 offset:15376
    ds_read_b64_tr_b16 v[34:35], v12 offset:23056
    s_waitcnt lgkmcnt(10)
    v_mfma_f32_16x16x32_bf16 v[84:87], v[36:39], v[64:67], v[84:87]
    v_mfma_f32_16x16x32_bf16 v[116:119], v[36:39], v[68:71], v[116:119]
    s_waitcnt lgkmcnt(8)
    v_mfma_f32_16x16x32_bf16 v[88:91], v[40:43], v[64:67], v[88:91]
    v_mfma_f32_16x16x32_bf16 v[120:123], v[40:43], v[68:71], v[120:123]
    s_waitcnt lgkmcnt(6)
    v_mfma_f32_16x16x32_bf16 v[92:95], v[44:47], v[64:67], v[92:95]
    v_mfma_f32_16x16x32_bf16 v[124:127], v[44:47], v[68:71], v[124:127]
    s_waitcnt vmcnt(6) lgkmcnt(0)
    s_barrier
    v_add_u32 v11, 49152, v11
    v_add_u32 v12, 49152, v12
    v_add_u32 v13, 49152, v13
    v_add_u32 v14, 49152, v14
    ds_read_b128 v[52:55], v13 offset:0
    ds_read_b128 v[56:59], v13 offset:2048
    ds_read_b64_tr_b16 v[36:37], v11 offset:0
    ds_read_b64_tr_b16 v[38:39], v11 offset:7680
    ds_read_b64_tr_b16 v[40:41], v11 offset:8
    ds_read_b64_tr_b16 v[42:43], v11 offset:7688
    ds_read_b64_tr_b16 v[44:45], v11 offset:16
    ds_read_b64_tr_b16 v[46:47], v11 offset:7696
    v_mfma_f32_16x16x32_bf16 v[96:99], v[48:51], v[64:67], v[96:99]
    v_mfma_f32_16x16x32_bf16 v[128:131], v[48:51], v[68:71], v[128:131]
    s_mul_i32 s26, s23, 6144
    s_add_u32 m0, s26, 49152
    s_add_u32 s34, s38, 7
    s_sub_u32 s27, s34, 10
    s_cmp_ge_u32 s34, 10
    s_cselect_b32 s34, s27, s34
    s_mul_i32 s34, s35, s34
    buffer_load_dwordx4 v20, s[40:43], s34 offen lds
    ds_read_b64_tr_b16 v[48:49], v11 offset:24
    ds_read_b64_tr_b16 v[50:51], v11 offset:7704
    v_mfma_f32_16x16x32_bf16 v[100:103], v[28:31], v[64:67], v[100:103]
    v_mfma_f32_16x16x32_bf16 v[132:135], v[28:31], v[68:71], v[132:135]
    s_mul_i32 s26, s23, 6144
    s_add_u32 m0, s26, 50176
    s_add_u32 s34, s38, 7
    s_sub_u32 s27, s34, 10
    s_cmp_ge_u32 s34, 10
    s_cselect_b32 s34, s27, s34
    s_mul_i32 s34, s35, s34
    buffer_load_dwordx4 v21, s[40:43], s34 offen lds
    ds_read_b64_tr_b16 v[28:29], v11 offset:32
    ds_read_b64_tr_b16 v[30:31], v11 offset:7712
    v_mfma_f32_16x16x32_bf16 v[104:107], v[32:35], v[64:67], v[104:107]
    v_mfma_f32_16x16x32_bf16 v[136:139], v[32:35], v[68:71], v[136:139]
    s_mul_i32 s26, s23, 6144
    s_add_u32 m0, s26, 51200
    s_add_u32 s34, s38, 7
    s_sub_u32 s27, s34, 10
    s_cmp_ge_u32 s34, 10
    s_cselect_b32 s34, s27, s34
    s_mul_i32 s34, s35, s34
    buffer_load_dwordx4 v22, s[40:43], s34 offen lds
    ds_read_b64_tr_b16 v[32:33], v12 offset:0
    ds_read_b64_tr_b16 v[34:35], v12 offset:7680
    s_waitcnt lgkmcnt(10)
    v_mfma_f32_16x16x32_bf16 v[76:79], v[36:39], v[52:55], v[76:79]
    v_mfma_f32_16x16x32_bf16 v[108:111], v[36:39], v[56:59], v[108:111]
    s_mul_i32 s26, s23, 6144
    s_add_u32 m0, s26, 52224
    s_add_u32 s34, s38, 7
    s_sub_u32 s27, s34, 10
    s_cmp_ge_u32 s34, 10
    s_cselect_b32 s34, s27, s34
    s_mul_i32 s34, s35, s34
    buffer_load_dwordx4 v23, s[40:43], s34 offen lds
    ds_read_b64_tr_b16 v[36:37], v12 offset:8
    ds_read_b64_tr_b16 v[38:39], v12 offset:7688
    s_waitcnt lgkmcnt(10)
    v_mfma_f32_16x16x32_bf16 v[80:83], v[40:43], v[52:55], v[80:83]
    v_mfma_f32_16x16x32_bf16 v[112:115], v[40:43], v[56:59], v[112:115]
    s_mul_i32 s26, s23, 6144
    s_add_u32 m0, s26, 53248
    s_add_u32 s34, s38, 7
    s_sub_u32 s27, s34, 10
    s_cmp_ge_u32 s34, 10
    s_cselect_b32 s34, s27, s34
    s_mul_i32 s34, s35, s34
    buffer_load_dwordx4 v24, s[40:43], s34 offen lds
    ds_read_b64_tr_b16 v[40:41], v12 offset:16
    ds_read_b64_tr_b16 v[42:43], v12 offset:7696
    s_waitcnt lgkmcnt(10)
    v_mfma_f32_16x16x32_bf16 v[84:87], v[44:47], v[52:55], v[84:87]
    v_mfma_f32_16x16x32_bf16 v[116:119], v[44:47], v[56:59], v[116:119]
    s_mul_i32 s26, s23, 6144
    s_add_u32 m0, s26, 54272
    s_add_u32 s34, s38, 7
    s_sub_u32 s27, s34, 10
    s_cmp_ge_u32 s34, 10
    s_cselect_b32 s34, s27, s34
    s_mul_i32 s34, s35, s34
    buffer_load_dwordx4 v25, s[40:43], s34 offen lds
    ds_read_b128 v[64:67], v14 offset:0
    ds_read_b128 v[68:71], v14 offset:2048
    ds_read_b64_tr_b16 v[44:45], v11 offset:15360
    ds_read_b64_tr_b16 v[46:47], v11 offset:23040
    s_waitcnt lgkmcnt(12)
    v_mfma_f32_16x16x32_bf16 v[88:91], v[48:51], v[52:55], v[88:91]
    v_mfma_f32_16x16x32_bf16 v[120:123], v[48:51], v[56:59], v[120:123]
    ds_read_b64_tr_b16 v[48:49], v11 offset:15368
    ds_read_b64_tr_b16 v[50:51], v11 offset:23048
    s_waitcnt lgkmcnt(12)
    v_mfma_f32_16x16x32_bf16 v[92:95], v[28:31], v[52:55], v[92:95]
    v_mfma_f32_16x16x32_bf16 v[124:127], v[28:31], v[56:59], v[124:127]
    ds_read_b64_tr_b16 v[28:29], v11 offset:15376
    ds_read_b64_tr_b16 v[30:31], v11 offset:23056
    s_waitcnt lgkmcnt(12)
    v_mfma_f32_16x16x32_bf16 v[96:99], v[32:35], v[52:55], v[96:99]
    v_mfma_f32_16x16x32_bf16 v[128:131], v[32:35], v[56:59], v[128:131]
    ds_read_b64_tr_b16 v[32:33], v11 offset:15384
    ds_read_b64_tr_b16 v[34:35], v11 offset:23064
    s_waitcnt lgkmcnt(12)
    v_mfma_f32_16x16x32_bf16 v[100:103], v[36:39], v[52:55], v[100:103]
    v_mfma_f32_16x16x32_bf16 v[132:135], v[36:39], v[56:59], v[132:135]
    ds_read_b64_tr_b16 v[36:37], v11 offset:15392
    ds_read_b64_tr_b16 v[38:39], v11 offset:23072
    s_waitcnt lgkmcnt(12)
    v_mfma_f32_16x16x32_bf16 v[104:107], v[40:43], v[52:55], v[104:107]
    v_mfma_f32_16x16x32_bf16 v[136:139], v[40:43], v[56:59], v[136:139]
    ds_read_b64_tr_b16 v[40:41], v12 offset:15360
    ds_read_b64_tr_b16 v[42:43], v12 offset:23040
    s_waitcnt lgkmcnt(10)
    v_mfma_f32_16x16x32_bf16 v[76:79], v[44:47], v[64:67], v[76:79]
    v_mfma_f32_16x16x32_bf16 v[108:111], v[44:47], v[68:71], v[108:111]
    ds_read_b64_tr_b16 v[44:45], v12 offset:15368
    ds_read_b64_tr_b16 v[46:47], v12 offset:23048
    s_waitcnt lgkmcnt(10)
    v_mfma_f32_16x16x32_bf16 v[80:83], v[48:51], v[64:67], v[80:83]
    v_mfma_f32_16x16x32_bf16 v[112:115], v[48:51], v[68:71], v[112:115]
    ds_read_b64_tr_b16 v[48:49], v12 offset:15376
    ds_read_b64_tr_b16 v[50:51], v12 offset:23056
    s_waitcnt lgkmcnt(10)
    v_mfma_f32_16x16x32_bf16 v[84:87], v[28:31], v[64:67], v[84:87]
    v_mfma_f32_16x16x32_bf16 v[116:119], v[28:31], v[68:71], v[116:119]
    s_waitcnt lgkmcnt(8)
    v_mfma_f32_16x16x32_bf16 v[88:91], v[32:35], v[64:67], v[88:91]
    v_mfma_f32_16x16x32_bf16 v[120:123], v[32:35], v[68:71], v[120:123]
    s_waitcnt lgkmcnt(6)
    v_mfma_f32_16x16x32_bf16 v[92:95], v[36:39], v[64:67], v[92:95]
    v_mfma_f32_16x16x32_bf16 v[124:127], v[36:39], v[68:71], v[124:127]
    s_waitcnt vmcnt(6) lgkmcnt(0)
    s_barrier
    v_subrev_u32 v11, 98304, v11
    v_subrev_u32 v12, 98304, v12
    v_subrev_u32 v13, 98304, v13
    v_subrev_u32 v14, 98304, v14
    ds_read_b128 v[52:55], v13 offset:0
    ds_read_b128 v[56:59], v13 offset:2048
    ds_read_b64_tr_b16 v[28:29], v11 offset:0
    ds_read_b64_tr_b16 v[30:31], v11 offset:7680
    ds_read_b64_tr_b16 v[32:33], v11 offset:8
    ds_read_b64_tr_b16 v[34:35], v11 offset:7688
    ds_read_b64_tr_b16 v[36:37], v11 offset:16
    ds_read_b64_tr_b16 v[38:39], v11 offset:7696
    v_mfma_f32_16x16x32_bf16 v[96:99], v[40:43], v[64:67], v[96:99]
    v_mfma_f32_16x16x32_bf16 v[128:131], v[40:43], v[68:71], v[128:131]
    s_mul_i32 s26, s23, 6144
    s_add_u32 m0, s26, 98304
    s_add_u32 s34, s38, 8
    s_sub_u32 s27, s34, 10
    s_cmp_ge_u32 s34, 10
    s_cselect_b32 s34, s27, s34
    s_mul_i32 s34, s35, s34
    buffer_load_dwordx4 v20, s[40:43], s34 offen lds
    ds_read_b64_tr_b16 v[40:41], v11 offset:24
    ds_read_b64_tr_b16 v[42:43], v11 offset:7704
    v_mfma_f32_16x16x32_bf16 v[100:103], v[44:47], v[64:67], v[100:103]
    v_mfma_f32_16x16x32_bf16 v[132:135], v[44:47], v[68:71], v[132:135]
    s_mul_i32 s26, s23, 6144
    s_add_u32 m0, s26, 99328
    s_add_u32 s34, s38, 8
    s_sub_u32 s27, s34, 10
    s_cmp_ge_u32 s34, 10
    s_cselect_b32 s34, s27, s34
    s_mul_i32 s34, s35, s34
    buffer_load_dwordx4 v21, s[40:43], s34 offen lds
    ds_read_b64_tr_b16 v[44:45], v11 offset:32
    ds_read_b64_tr_b16 v[46:47], v11 offset:7712
    v_mfma_f32_16x16x32_bf16 v[104:107], v[48:51], v[64:67], v[104:107]
    v_mfma_f32_16x16x32_bf16 v[136:139], v[48:51], v[68:71], v[136:139]
    s_mul_i32 s26, s23, 6144
    s_add_u32 m0, s26, 100352
    s_add_u32 s34, s38, 8
    s_sub_u32 s27, s34, 10
    s_cmp_ge_u32 s34, 10
    s_cselect_b32 s34, s27, s34
    s_mul_i32 s34, s35, s34
    buffer_load_dwordx4 v22, s[40:43], s34 offen lds
    ds_read_b64_tr_b16 v[48:49], v12 offset:0
    ds_read_b64_tr_b16 v[50:51], v12 offset:7680
    s_waitcnt lgkmcnt(10)
    v_mfma_f32_16x16x32_bf16 v[76:79], v[28:31], v[52:55], v[76:79]
    v_mfma_f32_16x16x32_bf16 v[108:111], v[28:31], v[56:59], v[108:111]
    s_mul_i32 s26, s23, 6144
    s_add_u32 m0, s26, 101376
    s_add_u32 s34, s38, 8
    s_sub_u32 s27, s34, 10
    s_cmp_ge_u32 s34, 10
    s_cselect_b32 s34, s27, s34
    s_mul_i32 s34, s35, s34
    buffer_load_dwordx4 v23, s[40:43], s34 offen lds
    ds_read_b64_tr_b16 v[28:29], v12 offset:8
    ds_read_b64_tr_b16 v[30:31], v12 offset:7688
    s_waitcnt lgkmcnt(10)
    v_mfma_f32_16x16x32_bf16 v[80:83], v[32:35], v[52:55], v[80:83]
    v_mfma_f32_16x16x32_bf16 v[112:115], v[32:35], v[56:59], v[112:115]
    s_mul_i32 s26, s23, 6144
    s_add_u32 m0, s26, 102400
    s_add_u32 s34, s38, 8
    s_sub_u32 s27, s34, 10
    s_cmp_ge_u32 s34, 10
    s_cselect_b32 s34, s27, s34
    s_mul_i32 s34, s35, s34
    buffer_load_dwordx4 v24, s[40:43], s34 offen lds
    ds_read_b64_tr_b16 v[32:33], v12 offset:16
    ds_read_b64_tr_b16 v[34:35], v12 offset:7696
    s_waitcnt lgkmcnt(10)
    v_mfma_f32_16x16x32_bf16 v[84:87], v[36:39], v[52:55], v[84:87]
    v_mfma_f32_16x16x32_bf16 v[116:119], v[36:39], v[56:59], v[116:119]
    s_mul_i32 s26, s23, 6144
    s_add_u32 m0, s26, 103424
    s_add_u32 s34, s38, 8
    s_sub_u32 s27, s34, 10
    s_cmp_ge_u32 s34, 10
    s_cselect_b32 s34, s27, s34
    s_mul_i32 s34, s35, s34
    buffer_load_dwordx4 v25, s[40:43], s34 offen lds
    ds_read_b128 v[64:67], v14 offset:0
    ds_read_b128 v[68:71], v14 offset:2048
    ds_read_b64_tr_b16 v[36:37], v11 offset:15360
    ds_read_b64_tr_b16 v[38:39], v11 offset:23040
    s_waitcnt lgkmcnt(12)
    v_mfma_f32_16x16x32_bf16 v[88:91], v[40:43], v[52:55], v[88:91]
    v_mfma_f32_16x16x32_bf16 v[120:123], v[40:43], v[56:59], v[120:123]
    ds_read_b64_tr_b16 v[40:41], v11 offset:15368
    ds_read_b64_tr_b16 v[42:43], v11 offset:23048
    s_waitcnt lgkmcnt(12)
    v_mfma_f32_16x16x32_bf16 v[92:95], v[44:47], v[52:55], v[92:95]
    v_mfma_f32_16x16x32_bf16 v[124:127], v[44:47], v[56:59], v[124:127]
    ds_read_b64_tr_b16 v[44:45], v11 offset:15376
    ds_read_b64_tr_b16 v[46:47], v11 offset:23056
    s_waitcnt lgkmcnt(12)
    v_mfma_f32_16x16x32_bf16 v[96:99], v[48:51], v[52:55], v[96:99]
    v_mfma_f32_16x16x32_bf16 v[128:131], v[48:51], v[56:59], v[128:131]
    ds_read_b64_tr_b16 v[48:49], v11 offset:15384
    ds_read_b64_tr_b16 v[50:51], v11 offset:23064
    s_waitcnt lgkmcnt(12)
    v_mfma_f32_16x16x32_bf16 v[100:103], v[28:31], v[52:55], v[100:103]
    v_mfma_f32_16x16x32_bf16 v[132:135], v[28:31], v[56:59], v[132:135]
    ds_read_b64_tr_b16 v[28:29], v11 offset:15392
    ds_read_b64_tr_b16 v[30:31], v11 offset:23072
    s_waitcnt lgkmcnt(12)
    v_mfma_f32_16x16x32_bf16 v[104:107], v[32:35], v[52:55], v[104:107]
    v_mfma_f32_16x16x32_bf16 v[136:139], v[32:35], v[56:59], v[136:139]
    ds_read_b64_tr_b16 v[32:33], v12 offset:15360
    ds_read_b64_tr_b16 v[34:35], v12 offset:23040
    s_waitcnt lgkmcnt(10)
    v_mfma_f32_16x16x32_bf16 v[76:79], v[36:39], v[64:67], v[76:79]
    v_mfma_f32_16x16x32_bf16 v[108:111], v[36:39], v[68:71], v[108:111]
    ds_read_b64_tr_b16 v[36:37], v12 offset:15368
    ds_read_b64_tr_b16 v[38:39], v12 offset:23048
    s_waitcnt lgkmcnt(10)
    v_mfma_f32_16x16x32_bf16 v[80:83], v[40:43], v[64:67], v[80:83]
    v_mfma_f32_16x16x32_bf16 v[112:115], v[40:43], v[68:71], v[112:115]
    ds_read_b64_tr_b16 v[40:41], v12 offset:15376
    ds_read_b64_tr_b16 v[42:43], v12 offset:23056
    s_waitcnt lgkmcnt(10)
    v_mfma_f32_16x16x32_bf16 v[84:87], v[44:47], v[64:67], v[84:87]
    v_mfma_f32_16x16x32_bf16 v[116:119], v[44:47], v[68:71], v[116:119]
    s_waitcnt lgkmcnt(8)
    v_mfma_f32_16x16x32_bf16 v[88:91], v[48:51], v[64:67], v[88:91]
    v_mfma_f32_16x16x32_bf16 v[120:123], v[48:51], v[68:71], v[120:123]
    s_waitcnt lgkmcnt(6)
    v_mfma_f32_16x16x32_bf16 v[92:95], v[28:31], v[64:67], v[92:95]
    v_mfma_f32_16x16x32_bf16 v[124:127], v[28:31], v[68:71], v[124:127]
    s_waitcnt vmcnt(6) lgkmcnt(0)
    s_barrier
    v_add_u32 v11, 49152, v11
    v_add_u32 v12, 49152, v12
    v_add_u32 v13, 49152, v13
    v_add_u32 v14, 49152, v14
    ds_read_b128 v[52:55], v13 offset:0
    ds_read_b128 v[56:59], v13 offset:2048
    ds_read_b64_tr_b16 v[44:45], v11 offset:0
    ds_read_b64_tr_b16 v[46:47], v11 offset:7680
    ds_read_b64_tr_b16 v[48:49], v11 offset:8
    ds_read_b64_tr_b16 v[50:51], v11 offset:7688
    ds_read_b64_tr_b16 v[28:29], v11 offset:16
    ds_read_b64_tr_b16 v[30:31], v11 offset:7696
    v_mfma_f32_16x16x32_bf16 v[96:99], v[32:35], v[64:67], v[96:99]
    v_mfma_f32_16x16x32_bf16 v[128:131], v[32:35], v[68:71], v[128:131]
    s_mul_i32 s26, s23, 6144
    s_add_u32 m0, s26, 0
    s_add_u32 s34, s38, 9
    s_sub_u32 s27, s34, 10
    s_cmp_ge_u32 s34, 10
    s_cselect_b32 s34, s27, s34
    s_mul_i32 s34, s35, s34
    buffer_load_dwordx4 v20, s[40:43], s34 offen lds
    ds_read_b64_tr_b16 v[32:33], v11 offset:24
    ds_read_b64_tr_b16 v[34:35], v11 offset:7704
    v_mfma_f32_16x16x32_bf16 v[100:103], v[36:39], v[64:67], v[100:103]
    v_mfma_f32_16x16x32_bf16 v[132:135], v[36:39], v[68:71], v[132:135]
    s_mul_i32 s26, s23, 6144
    s_add_u32 m0, s26, 1024
    s_add_u32 s34, s38, 9
    s_sub_u32 s27, s34, 10
    s_cmp_ge_u32 s34, 10
    s_cselect_b32 s34, s27, s34
    s_mul_i32 s34, s35, s34
    buffer_load_dwordx4 v21, s[40:43], s34 offen lds
    ds_read_b64_tr_b16 v[36:37], v11 offset:32
    ds_read_b64_tr_b16 v[38:39], v11 offset:7712
    v_mfma_f32_16x16x32_bf16 v[104:107], v[40:43], v[64:67], v[104:107]
    v_mfma_f32_16x16x32_bf16 v[136:139], v[40:43], v[68:71], v[136:139]
    s_mul_i32 s26, s23, 6144
    s_add_u32 m0, s26, 2048
    s_add_u32 s34, s38, 9
    s_sub_u32 s27, s34, 10
    s_cmp_ge_u32 s34, 10
    s_cselect_b32 s34, s27, s34
    s_mul_i32 s34, s35, s34
    buffer_load_dwordx4 v22, s[40:43], s34 offen lds
    ds_read_b64_tr_b16 v[40:41], v12 offset:0
    ds_read_b64_tr_b16 v[42:43], v12 offset:7680
    s_waitcnt lgkmcnt(10)
    v_mfma_f32_16x16x32_bf16 v[76:79], v[44:47], v[52:55], v[76:79]
    v_mfma_f32_16x16x32_bf16 v[108:111], v[44:47], v[56:59], v[108:111]
    s_mul_i32 s26, s23, 6144
    s_add_u32 m0, s26, 3072
    s_add_u32 s34, s38, 9
    s_sub_u32 s27, s34, 10
    s_cmp_ge_u32 s34, 10
    s_cselect_b32 s34, s27, s34
    s_mul_i32 s34, s35, s34
    buffer_load_dwordx4 v23, s[40:43], s34 offen lds
    ds_read_b64_tr_b16 v[44:45], v12 offset:8
    ds_read_b64_tr_b16 v[46:47], v12 offset:7688
    s_waitcnt lgkmcnt(10)
    v_mfma_f32_16x16x32_bf16 v[80:83], v[48:51], v[52:55], v[80:83]
    v_mfma_f32_16x16x32_bf16 v[112:115], v[48:51], v[56:59], v[112:115]
    s_mul_i32 s26, s23, 6144
    s_add_u32 m0, s26, 4096
    s_add_u32 s34, s38, 9
    s_sub_u32 s27, s34, 10
    s_cmp_ge_u32 s34, 10
    s_cselect_b32 s34, s27, s34
    s_mul_i32 s34, s35, s34
    buffer_load_dwordx4 v24, s[40:43], s34 offen lds
    ds_read_b64_tr_b16 v[48:49], v12 offset:16
    ds_read_b64_tr_b16 v[50:51], v12 offset:7696
    s_waitcnt lgkmcnt(10)
    v_mfma_f32_16x16x32_bf16 v[84:87], v[28:31], v[52:55], v[84:87]
    v_mfma_f32_16x16x32_bf16 v[116:119], v[28:31], v[56:59], v[116:119]
    s_mul_i32 s26, s23, 6144
    s_add_u32 m0, s26, 5120
    s_add_u32 s34, s38, 9
    s_sub_u32 s27, s34, 10
    s_cmp_ge_u32 s34, 10
    s_cselect_b32 s34, s27, s34
    s_mul_i32 s34, s35, s34
    buffer_load_dwordx4 v25, s[40:43], s34 offen lds
    ds_read_b128 v[64:67], v14 offset:0
    ds_read_b128 v[68:71], v14 offset:2048
    ds_read_b64_tr_b16 v[28:29], v11 offset:15360
    ds_read_b64_tr_b16 v[30:31], v11 offset:23040
    s_waitcnt lgkmcnt(12)
    v_mfma_f32_16x16x32_bf16 v[88:91], v[32:35], v[52:55], v[88:91]
    v_mfma_f32_16x16x32_bf16 v[120:123], v[32:35], v[56:59], v[120:123]
    ds_read_b64_tr_b16 v[32:33], v11 offset:15368
    ds_read_b64_tr_b16 v[34:35], v11 offset:23048
    s_waitcnt lgkmcnt(12)
    v_mfma_f32_16x16x32_bf16 v[92:95], v[36:39], v[52:55], v[92:95]
    v_mfma_f32_16x16x32_bf16 v[124:127], v[36:39], v[56:59], v[124:127]
    ds_read_b64_tr_b16 v[36:37], v11 offset:15376
    ds_read_b64_tr_b16 v[38:39], v11 offset:23056
    s_waitcnt lgkmcnt(12)
    v_mfma_f32_16x16x32_bf16 v[96:99], v[40:43], v[52:55], v[96:99]
    v_mfma_f32_16x16x32_bf16 v[128:131], v[40:43], v[56:59], v[128:131]
    ds_read_b64_tr_b16 v[40:41], v11 offset:15384
    ds_read_b64_tr_b16 v[42:43], v11 offset:23064
    s_waitcnt lgkmcnt(12)
    v_mfma_f32_16x16x32_bf16 v[100:103], v[44:47], v[52:55], v[100:103]
    v_mfma_f32_16x16x32_bf16 v[132:135], v[44:47], v[56:59], v[132:135]
    ds_read_b64_tr_b16 v[44:45], v11 offset:15392
    ds_read_b64_tr_b16 v[46:47], v11 offset:23072
    s_waitcnt lgkmcnt(12)
    v_mfma_f32_16x16x32_bf16 v[104:107], v[48:51], v[52:55], v[104:107]
    v_mfma_f32_16x16x32_bf16 v[136:139], v[48:51], v[56:59], v[136:139]
    ds_read_b64_tr_b16 v[48:49], v12 offset:15360
    ds_read_b64_tr_b16 v[50:51], v12 offset:23040
    s_waitcnt lgkmcnt(10)
    v_mfma_f32_16x16x32_bf16 v[76:79], v[28:31], v[64:67], v[76:79]
    v_mfma_f32_16x16x32_bf16 v[108:111], v[28:31], v[68:71], v[108:111]
    ds_read_b64_tr_b16 v[28:29], v12 offset:15368
    ds_read_b64_tr_b16 v[30:31], v12 offset:23048
    s_waitcnt lgkmcnt(10)
    v_mfma_f32_16x16x32_bf16 v[80:83], v[32:35], v[64:67], v[80:83]
    v_mfma_f32_16x16x32_bf16 v[112:115], v[32:35], v[68:71], v[112:115]
    ds_read_b64_tr_b16 v[32:33], v12 offset:15376
    ds_read_b64_tr_b16 v[34:35], v12 offset:23056
    s_waitcnt lgkmcnt(10)
    v_mfma_f32_16x16x32_bf16 v[84:87], v[36:39], v[64:67], v[84:87]
    v_mfma_f32_16x16x32_bf16 v[116:119], v[36:39], v[68:71], v[116:119]
    s_waitcnt lgkmcnt(8)
    v_mfma_f32_16x16x32_bf16 v[88:91], v[40:43], v[64:67], v[88:91]
    v_mfma_f32_16x16x32_bf16 v[120:123], v[40:43], v[68:71], v[120:123]
    s_waitcnt lgkmcnt(6)
    v_mfma_f32_16x16x32_bf16 v[92:95], v[44:47], v[64:67], v[92:95]
    v_mfma_f32_16x16x32_bf16 v[124:127], v[44:47], v[68:71], v[124:127]
    s_waitcnt vmcnt(6) lgkmcnt(0)
    s_barrier
    v_add_u32 v11, 49152, v11
    v_add_u32 v12, 49152, v12
    v_add_u32 v13, 49152, v13
    v_add_u32 v14, 49152, v14
    ds_read_b128 v[52:55], v13 offset:0
    ds_read_b128 v[56:59], v13 offset:2048
    ds_read_b64_tr_b16 v[36:37], v11 offset:0
    ds_read_b64_tr_b16 v[38:39], v11 offset:7680
    ds_read_b64_tr_b16 v[40:41], v11 offset:8
    ds_read_b64_tr_b16 v[42:43], v11 offset:7688
    ds_read_b64_tr_b16 v[44:45], v11 offset:16
    ds_read_b64_tr_b16 v[46:47], v11 offset:7696
    v_mfma_f32_16x16x32_bf16 v[96:99], v[48:51], v[64:67], v[96:99]
    v_mfma_f32_16x16x32_bf16 v[128:131], v[48:51], v[68:71], v[128:131]
    ds_read_b64_tr_b16 v[48:49], v11 offset:24
    ds_read_b64_tr_b16 v[50:51], v11 offset:7704
    v_mfma_f32_16x16x32_bf16 v[100:103], v[28:31], v[64:67], v[100:103]
    v_mfma_f32_16x16x32_bf16 v[132:135], v[28:31], v[68:71], v[132:135]
    ds_read_b64_tr_b16 v[28:29], v11 offset:32
    ds_read_b64_tr_b16 v[30:31], v11 offset:7712
    v_mfma_f32_16x16x32_bf16 v[104:107], v[32:35], v[64:67], v[104:107]
    v_mfma_f32_16x16x32_bf16 v[136:139], v[32:35], v[68:71], v[136:139]
    ds_read_b64_tr_b16 v[32:33], v12 offset:0
    ds_read_b64_tr_b16 v[34:35], v12 offset:7680
    s_waitcnt lgkmcnt(10)
    v_mfma_f32_16x16x32_bf16 v[76:79], v[36:39], v[52:55], v[76:79]
    v_mfma_f32_16x16x32_bf16 v[108:111], v[36:39], v[56:59], v[108:111]
    ds_read_b64_tr_b16 v[36:37], v12 offset:8
    ds_read_b64_tr_b16 v[38:39], v12 offset:7688
    s_waitcnt lgkmcnt(10)
    v_mfma_f32_16x16x32_bf16 v[80:83], v[40:43], v[52:55], v[80:83]
    v_mfma_f32_16x16x32_bf16 v[112:115], v[40:43], v[56:59], v[112:115]
    ds_read_b64_tr_b16 v[40:41], v12 offset:16
    ds_read_b64_tr_b16 v[42:43], v12 offset:7696
    s_waitcnt lgkmcnt(10)
    v_mfma_f32_16x16x32_bf16 v[84:87], v[44:47], v[52:55], v[84:87]
    v_mfma_f32_16x16x32_bf16 v[116:119], v[44:47], v[56:59], v[116:119]
    ds_read_b128 v[64:67], v14 offset:0
    ds_read_b128 v[68:71], v14 offset:2048
    ds_read_b64_tr_b16 v[44:45], v11 offset:15360
    ds_read_b64_tr_b16 v[46:47], v11 offset:23040
    s_waitcnt lgkmcnt(12)
    v_mfma_f32_16x16x32_bf16 v[88:91], v[48:51], v[52:55], v[88:91]
    v_mfma_f32_16x16x32_bf16 v[120:123], v[48:51], v[56:59], v[120:123]
    ds_read_b64_tr_b16 v[48:49], v11 offset:15368
    ds_read_b64_tr_b16 v[50:51], v11 offset:23048
    s_waitcnt lgkmcnt(12)
    v_mfma_f32_16x16x32_bf16 v[92:95], v[28:31], v[52:55], v[92:95]
    v_mfma_f32_16x16x32_bf16 v[124:127], v[28:31], v[56:59], v[124:127]
    ds_read_b64_tr_b16 v[28:29], v11 offset:15376
    ds_read_b64_tr_b16 v[30:31], v11 offset:23056
    s_waitcnt lgkmcnt(12)
    v_mfma_f32_16x16x32_bf16 v[96:99], v[32:35], v[52:55], v[96:99]
    v_mfma_f32_16x16x32_bf16 v[128:131], v[32:35], v[56:59], v[128:131]
    ds_read_b64_tr_b16 v[32:33], v11 offset:15384
    ds_read_b64_tr_b16 v[34:35], v11 offset:23064
    s_waitcnt lgkmcnt(12)
    v_mfma_f32_16x16x32_bf16 v[100:103], v[36:39], v[52:55], v[100:103]
    v_mfma_f32_16x16x32_bf16 v[132:135], v[36:39], v[56:59], v[132:135]
    ds_read_b64_tr_b16 v[36:37], v11 offset:15392
    ds_read_b64_tr_b16 v[38:39], v11 offset:23072
    s_waitcnt lgkmcnt(12)
    v_mfma_f32_16x16x32_bf16 v[104:107], v[40:43], v[52:55], v[104:107]
    v_mfma_f32_16x16x32_bf16 v[136:139], v[40:43], v[56:59], v[136:139]
    ds_read_b64_tr_b16 v[40:41], v12 offset:15360
    ds_read_b64_tr_b16 v[42:43], v12 offset:23040
    s_waitcnt lgkmcnt(10)
    v_mfma_f32_16x16x32_bf16 v[76:79], v[44:47], v[64:67], v[76:79]
    v_mfma_f32_16x16x32_bf16 v[108:111], v[44:47], v[68:71], v[108:111]
    ds_read_b64_tr_b16 v[44:45], v12 offset:15368
    ds_read_b64_tr_b16 v[46:47], v12 offset:23048
    s_waitcnt lgkmcnt(10)
    v_mfma_f32_16x16x32_bf16 v[80:83], v[48:51], v[64:67], v[80:83]
    v_mfma_f32_16x16x32_bf16 v[112:115], v[48:51], v[68:71], v[112:115]
    ds_read_b64_tr_b16 v[48:49], v12 offset:15376
    ds_read_b64_tr_b16 v[50:51], v12 offset:23056
    s_waitcnt lgkmcnt(10)
    v_mfma_f32_16x16x32_bf16 v[84:87], v[28:31], v[64:67], v[84:87]
    v_mfma_f32_16x16x32_bf16 v[116:119], v[28:31], v[68:71], v[116:119]
    s_waitcnt lgkmcnt(8)
    v_mfma_f32_16x16x32_bf16 v[88:91], v[32:35], v[64:67], v[88:91]
    v_mfma_f32_16x16x32_bf16 v[120:123], v[32:35], v[68:71], v[120:123]
    s_waitcnt lgkmcnt(6)
    v_mfma_f32_16x16x32_bf16 v[92:95], v[36:39], v[64:67], v[92:95]
    v_mfma_f32_16x16x32_bf16 v[124:127], v[36:39], v[68:71], v[124:127]
    s_waitcnt vmcnt(0) lgkmcnt(0)
    s_barrier
    v_subrev_u32 v11, 98304, v11
    v_subrev_u32 v12, 98304, v12
    v_subrev_u32 v13, 98304, v13
    v_subrev_u32 v14, 98304, v14
    ds_read_b128 v[52:55], v13 offset:0
    ds_read_b128 v[56:59], v13 offset:2048
    ds_read_b64_tr_b16 v[28:29], v11 offset:0
    ds_read_b64_tr_b16 v[30:31], v11 offset:7680
    ds_read_b64_tr_b16 v[32:33], v11 offset:8
    ds_read_b64_tr_b16 v[34:35], v11 offset:7688
    ds_read_b64_tr_b16 v[36:37], v11 offset:16
    ds_read_b64_tr_b16 v[38:39], v11 offset:7696
    v_mfma_f32_16x16x32_bf16 v[96:99], v[40:43], v[64:67], v[96:99]
    v_mfma_f32_16x16x32_bf16 v[128:131], v[40:43], v[68:71], v[128:131]
    ds_read_b64_tr_b16 v[40:41], v11 offset:24
    ds_read_b64_tr_b16 v[42:43], v11 offset:7704
    v_mfma_f32_16x16x32_bf16 v[100:103], v[44:47], v[64:67], v[100:103]
    v_mfma_f32_16x16x32_bf16 v[132:135], v[44:47], v[68:71], v[132:135]
    ds_read_b64_tr_b16 v[44:45], v11 offset:32
    ds_read_b64_tr_b16 v[46:47], v11 offset:7712
    v_mfma_f32_16x16x32_bf16 v[104:107], v[48:51], v[64:67], v[104:107]
    v_mfma_f32_16x16x32_bf16 v[136:139], v[48:51], v[68:71], v[136:139]
    ds_read_b64_tr_b16 v[48:49], v12 offset:0
    ds_read_b64_tr_b16 v[50:51], v12 offset:7680
    s_waitcnt lgkmcnt(10)
    v_mfma_f32_16x16x32_bf16 v[76:79], v[28:31], v[52:55], v[76:79]
    v_mfma_f32_16x16x32_bf16 v[108:111], v[28:31], v[56:59], v[108:111]
    ds_read_b64_tr_b16 v[28:29], v12 offset:8
    ds_read_b64_tr_b16 v[30:31], v12 offset:7688
    s_waitcnt lgkmcnt(10)
    v_mfma_f32_16x16x32_bf16 v[80:83], v[32:35], v[52:55], v[80:83]
    v_mfma_f32_16x16x32_bf16 v[112:115], v[32:35], v[56:59], v[112:115]
    ds_read_b64_tr_b16 v[32:33], v12 offset:16
    ds_read_b64_tr_b16 v[34:35], v12 offset:7696
    s_waitcnt lgkmcnt(10)
    v_mfma_f32_16x16x32_bf16 v[84:87], v[36:39], v[52:55], v[84:87]
    v_mfma_f32_16x16x32_bf16 v[116:119], v[36:39], v[56:59], v[116:119]
    ds_read_b128 v[64:67], v14 offset:0
    ds_read_b128 v[68:71], v14 offset:2048
    ds_read_b64_tr_b16 v[36:37], v11 offset:15360
    ds_read_b64_tr_b16 v[38:39], v11 offset:23040
    s_waitcnt lgkmcnt(12)
    v_mfma_f32_16x16x32_bf16 v[88:91], v[40:43], v[52:55], v[88:91]
    v_mfma_f32_16x16x32_bf16 v[120:123], v[40:43], v[56:59], v[120:123]
    ds_read_b64_tr_b16 v[40:41], v11 offset:15368
    ds_read_b64_tr_b16 v[42:43], v11 offset:23048
    s_waitcnt lgkmcnt(12)
    v_mfma_f32_16x16x32_bf16 v[92:95], v[44:47], v[52:55], v[92:95]
    v_mfma_f32_16x16x32_bf16 v[124:127], v[44:47], v[56:59], v[124:127]
    ds_read_b64_tr_b16 v[44:45], v11 offset:15376
    ds_read_b64_tr_b16 v[46:47], v11 offset:23056
    s_waitcnt lgkmcnt(12)
    v_mfma_f32_16x16x32_bf16 v[96:99], v[48:51], v[52:55], v[96:99]
    v_mfma_f32_16x16x32_bf16 v[128:131], v[48:51], v[56:59], v[128:131]
    ds_read_b64_tr_b16 v[48:49], v11 offset:15384
    ds_read_b64_tr_b16 v[50:51], v11 offset:23064
    s_waitcnt lgkmcnt(12)
    v_mfma_f32_16x16x32_bf16 v[100:103], v[28:31], v[52:55], v[100:103]
    v_mfma_f32_16x16x32_bf16 v[132:135], v[28:31], v[56:59], v[132:135]
    ds_read_b64_tr_b16 v[28:29], v11 offset:15392
    ds_read_b64_tr_b16 v[30:31], v11 offset:23072
    s_waitcnt lgkmcnt(12)
    v_mfma_f32_16x16x32_bf16 v[104:107], v[32:35], v[52:55], v[104:107]
    v_mfma_f32_16x16x32_bf16 v[136:139], v[32:35], v[56:59], v[136:139]
    ds_read_b64_tr_b16 v[32:33], v12 offset:15360
    ds_read_b64_tr_b16 v[34:35], v12 offset:23040
    s_waitcnt lgkmcnt(10)
    v_mfma_f32_16x16x32_bf16 v[76:79], v[36:39], v[64:67], v[76:79]
    v_mfma_f32_16x16x32_bf16 v[108:111], v[36:39], v[68:71], v[108:111]
    ds_read_b64_tr_b16 v[36:37], v12 offset:15368
    ds_read_b64_tr_b16 v[38:39], v12 offset:23048
    s_waitcnt lgkmcnt(10)
    v_mfma_f32_16x16x32_bf16 v[80:83], v[40:43], v[64:67], v[80:83]
    v_mfma_f32_16x16x32_bf16 v[112:115], v[40:43], v[68:71], v[112:115]
    ds_read_b64_tr_b16 v[40:41], v12 offset:15376
    ds_read_b64_tr_b16 v[42:43], v12 offset:23056
    s_waitcnt lgkmcnt(10)
    v_mfma_f32_16x16x32_bf16 v[84:87], v[44:47], v[64:67], v[84:87]
    v_mfma_f32_16x16x32_bf16 v[116:119], v[44:47], v[68:71], v[116:119]
    s_waitcnt lgkmcnt(8)
    v_mfma_f32_16x16x32_bf16 v[88:91], v[48:51], v[64:67], v[88:91]
    v_mfma_f32_16x16x32_bf16 v[120:123], v[48:51], v[68:71], v[120:123]
    s_waitcnt lgkmcnt(6)
    v_mfma_f32_16x16x32_bf16 v[92:95], v[28:31], v[64:67], v[92:95]
    v_mfma_f32_16x16x32_bf16 v[124:127], v[28:31], v[68:71], v[124:127]
    s_waitcnt lgkmcnt(4)
    v_mfma_f32_16x16x32_bf16 v[96:99], v[32:35], v[64:67], v[96:99]
    v_mfma_f32_16x16x32_bf16 v[128:131], v[32:35], v[68:71], v[128:131]
    s_waitcnt lgkmcnt(2)
    v_mfma_f32_16x16x32_bf16 v[100:103], v[36:39], v[64:67], v[100:103]
    v_mfma_f32_16x16x32_bf16 v[132:135], v[36:39], v[68:71], v[132:135]
    s_waitcnt lgkmcnt(0)
    v_mfma_f32_16x16x32_bf16 v[104:107], v[40:43], v[64:67], v[104:107]
    v_mfma_f32_16x16x32_bf16 v[136:139], v[40:43], v[68:71], v[136:139]
    v_mov_b32 v19, 0
    s_cmp_lg_u32 s23, 7
    s_cbranch_scc1 K1_ciA
    s_load_dwordx2 s[44:45], s[0:1], 72
    s_waitcnt lgkmcnt(0)
    s_mov_b32 s48, s44
    s_and_b32 s49, s45, 0xffff
    s_mov_b32 s50, 256
    s_mov_b32 s51, 0x00020000
    buffer_load_dword v19, v19, s[48:51], 0 offen sc1
K1_ciA:
    s_barrier
    v_and_b32 v2, 3, v1
    v_bfe_u32 v3, v1, 2, 2
    v_mul_u32_u24 v3, 40, v3
    v_mul_u32_u24 v4, 800, v10
    v_add_u32 v3, v3, v4
    v_add_u32 v3, 147456, v3
    v_mov_b32 v4, 150656
    v_cmp_eq_u32 vcc, v2, v10
    s_nop 1
    v_cndmask_b32 v3, v4, v3, vcc
    ds_read_b64_tr_b16 v[148:149], v3 offset:0
    ds_read_b64_tr_b16 v[150:151], v3 offset:160
    ds_read_b64_tr_b16 v[152:153], v3 offset:320
    ds_read_b64_tr_b16 v[154:155], v3 offset:480
    ds_read_b64_tr_b16 v[156:157], v3 offset:640
    v_mov_b32 v158, 0
    v_mov_b32 v159, 0
    ds_read_b64_tr_b16 v[160:161], v3 offset:8
    ds_read_b64_tr_b16 v[162:163], v3 offset:168
    ds_read_b64_tr_b16 v[164:165], v3 offset:328
    ds_read_b64_tr_b16 v[166:167], v3 offset:488
    ds_read_b64_tr_b16 v[168:169], v3 offset:648
    v_mov_b32 v170, 0
    v_mov_b32 v171, 0
    ds_read_b64_tr_b16 v[172:173], v3 offset:16
    ds_read_b64_tr_b16 v[174:175], v3 offset:176
    ds_read_b64_tr_b16 v[176:177], v3 offset:336
    ds_read_b64_tr_b16 v[178:179], v3 offset:496
    ds_read_b64_tr_b16 v[180:181], v3 offset:656
    v_mov_b32 v182, 0
    v_mov_b32 v183, 0
    ds_read_b64_tr_b16 v[184:185], v3 offset:24
    ds_read_b64_tr_b16 v[186:187], v3 offset:184
    ds_read_b64_tr_b16 v[188:189], v3 offset:344
    ds_read_b64_tr_b16 v[190:191], v3 offset:504
    ds_read_b64_tr_b16 v[192:193], v3 offset:664
    v_mov_b32 v194, 0
    v_mov_b32 v195, 0
    ds_read_b64_tr_b16 v[196:197], v3 offset:32
    ds_read_b64_tr_b16 v[198:199], v3 offset:192
    ds_read_b64_tr_b16 v[200:201], v3 offset:352
    ds_read_b64_tr_b16 v[202:203], v3 offset:512
    ds_read_b64_tr_b16 v[204:205], v3 offset:672
    v_mov_b32 v206, 0
    v_mov_b32 v207, 0
    v_mov_b32 v218, 0
    v_mov_b32 v219, 0
    s_lshl_b32 s26, s20, 3
    s_lshl_b32 s27, s24, 1
    s_add_u32 s26, s26, s27
    s_lshl_b32 s26, s26, 5
    s_lshl_b32 s27, s21, 2
    s_add_u32 s26, s26, s27
    s_mul_i32 s26, s26, 1280
    s_add_u32 s26, s26, 0
    v_and_b32 v2, 15, v1
    v_mul_u32_u24 v4, 1280, v10
    v_lshl_add_u32 v4, v2, 4, v4
    v_add_u32 v4, s26, v4
    v_add_u32 v9, 40960, v4
    s_mul_i32 s26, s24, 2560
    v_mul_u32_u24 v5, 80, v2
    v_mul_u32_u24 v6, 10240, v10
    v_add_u32 v5, v5, v6
    v_add_u32 v5, s26, v5
    s_mul_i32 s26, s24, 1536
    s_mul_i32 s27, s25, 24
    s_add_u32 s26, s26, s27
    v_mul_u32_u24 v6, 48, v2
    v_mul_u32_u24 v7, 6144, v10
    v_add_u32 v6, v6, v7
    v_add_u32 v6, s26, v6
    s_cmp_eq_u32 s25, 1
    s_cselect_b64 s[28:29], -1, 0
    v_mov_b32 v226, 0x3f80
    v_mov_b32 v227, 0
    v_cvt_pk_bf16_f32 v220, v96, v97
    v_cvt_pk_bf16_f32 v221, v98, v99
    v_cvt_pk_bf16_f32 v222, v100, v101
    v_cvt_pk_bf16_f32 v223, v102, v103
    v_cvt_pk_bf16_f32 v224, v104, v105
    v_cvt_pk_bf16_f32 v225, v106, v107
    v_cndmask_b32 v224, v224, v226, s[28:29]
    v_cndmask_b32 v225, v225, v227, s[28:29]
    ds_write_b64 v6, v[220:221] offset:40960
    ds_write_b64 v6, v[222:223] offset:40968
    ds_write_b64 v6, v[224:225] offset:40976
    s_nop 0
    v_cvt_pk_bf16_f32 v220, v128, v129
    v_cvt_pk_bf16_f32 v221, v130, v131
    v_cvt_pk_bf16_f32 v222, v132, v133
    v_cvt_pk_bf16_f32 v223, v134, v135
    v_cvt_pk_bf16_f32 v224, v136, v137
    v_cvt_pk_bf16_f32 v225, v138, v139
    v_cndmask_b32 v224, v224, v226, s[28:29]
    v_cndmask_b32 v225, v225, v227, s[28:29]
    ds_write_b64 v6, v[220:221] offset:41728
    ds_write_b64 v6, v[222:223] offset:41736
    ds_write_b64 v6, v[224:225] offset:41744
    s_nop 0
    s_waitcnt lgkmcnt(0)
    v_cvt_pk_bf16_f32 v208, v76, v77
    v_cvt_pk_bf16_f32 v209, v78, v79
    v_cvt_pk_bf16_f32 v210, v80, v81
    v_cvt_pk_bf16_f32 v211, v82, v83
    v_cvt_pk_bf16_f32 v212, v84, v85
    v_cvt_pk_bf16_f32 v213, v86, v87
    v_cvt_pk_bf16_f32 v214, v88, v89
    v_cvt_pk_bf16_f32 v215, v90, v91
    v_cvt_pk_bf16_f32 v216, v92, v93
    v_cvt_pk_bf16_f32 v217, v94, v95
    s_nop 1
    v_mfma_f32_16x16x32_bf16 v[220:223], v[148:151], v[208:211], 0
    v_mfma_f32_16x16x32_bf16 v[224:227], v[160:163], v[208:211], 0
    v_mfma_f32_16x16x32_bf16 v[228:231], v[172:175], v[208:211], 0
    v_mfma_f32_16x16x32_bf16 v[232:235], v[184:187], v[208:211], 0
    v_mfma_f32_16x16x32_bf16 v[236:239], v[196:199], v[208:211], 0
    v_mfma_f32_16x16x32_bf16 v[220:223], v[152:155], v[212:215], v[220:223]
    v_mfma_f32_16x16x32_bf16 v[224:227], v[164:167], v[212:215], v[224:227]
    v_mfma_f32_16x16x32_bf16 v[228:231], v[176:179], v[212:215], v[228:231]
    v_mfma_f32_16x16x32_bf16 v[232:235], v[188:191], v[212:215], v[232:235]
    v_mfma_f32_16x16x32_bf16 v[236:239], v[200:203], v[212:215], v[236:239]
    v_mfma_f32_16x16x32_bf16 v[220:223], v[156:159], v[216:219], v[220:223]
    v_mfma_f32_16x16x32_bf16 v[224:227], v[168:171], v[216:219], v[224:227]
    v_mfma_f32_16x16x32_bf16 v[228:231], v[180:183], v[216:219], v[228:231]
    v_mfma_f32_16x16x32_bf16 v[232:235], v[192:195], v[216:219], v[232:235]
    v_mfma_f32_16x16x32_bf16 v[236:239], v[204:207], v[216:219], v[236:239]
    s_nop 7
    v_cvt_pk_bf16_f32 v76, v220, v221
    v_cvt_pk_bf16_f32 v77, v222, v223
    v_cvt_pk_bf16_f32 v78, v224, v225
    v_cvt_pk_bf16_f32 v79, v226, v227
    v_cvt_pk_bf16_f32 v80, v228, v229
    v_cvt_pk_bf16_f32 v81, v230, v231
    v_cvt_pk_bf16_f32 v82, v232, v233
    v_cvt_pk_bf16_f32 v83, v234, v235
    v_cvt_pk_bf16_f32 v84, v236, v237
    v_cvt_pk_bf16_f32 v85, v238, v239
    v_lshlrev_b32 v220, 16, v76
    v_and_b32 v221, 0xffff0000, v76
    v_lshlrev_b32 v222, 16, v77
    v_and_b32 v223, 0xffff0000, v77
    v_lshlrev_b32 v224, 16, v78
    v_and_b32 v225, 0xffff0000, v78
    v_lshlrev_b32 v226, 16, v79
    v_and_b32 v227, 0xffff0000, v79
    v_lshlrev_b32 v228, 16, v80
    v_and_b32 v229, 0xffff0000, v80
    v_lshlrev_b32 v230, 16, v81
    v_and_b32 v231, 0xffff0000, v81
    v_lshlrev_b32 v232, 16, v82
    v_and_b32 v233, 0xffff0000, v82
    v_lshlrev_b32 v234, 16, v83
    v_and_b32 v235, 0xffff0000, v83
    v_lshlrev_b32 v236, 16, v84
    v_and_b32 v237, 0xffff0000, v84
    v_lshlrev_b32 v238, 16, v85
    v_and_b32 v239, 0xffff0000, v85
    v_max3_f32 v208, v220, v221, v222
    v_min3_f32 v209, v220, v221, v222
    v_max3_f32 v208, v208, v223, v224
    v_min3_f32 v209, v209, v223, v224
    v_max3_f32 v208, v208, v225, v226
    v_min3_f32 v209, v209, v225, v226
    v_max3_f32 v208, v208, v227, v228
    v_min3_f32 v209, v209, v227, v228
    v_max3_f32 v208, v208, v229, v230
    v_min3_f32 v209, v209, v229, v230
    v_max3_f32 v208, v208, v231, v232
    v_min3_f32 v209, v209, v231, v232
    v_max3_f32 v208, v208, v233, v234
    v_min3_f32 v209, v209, v233, v234
    v_max3_f32 v208, v208, v235, v236
    v_min3_f32 v209, v209, v235, v236
    v_max3_f32 v208, v208, v237, v238
    v_min3_f32 v209, v209, v237, v238
    v_max_f32 v208, v208, v239
    v_min_f32 v209, v209, v239
    v_mul_f32 v210, s37, v208
    v_mul_f32 v211, s36, v209
    v_pk_fma_f32 v[76:77], v[220:221], s[36:37], v[210:211] op_sel_hi:[1,0,0]
    v_pk_fma_f32 v[220:221], v[220:221], s[36:37], v[210:211] op_sel:[0,1,1] op_sel_hi:[1,1,1]
    v_pk_fma_f32 v[78:79], v[222:223], s[36:37], v[210:211] op_sel_hi:[1,0,0]
    v_pk_fma_f32 v[222:223], v[222:223], s[36:37], v[210:211] op_sel:[0,1,1] op_sel_hi:[1,1,1]
    v_pk_fma_f32 v[80:81], v[224:225], s[36:37], v[210:211] op_sel_hi:[1,0,0]
    v_pk_fma_f32 v[224:225], v[224:225], s[36:37], v[210:211] op_sel:[0,1,1] op_sel_hi:[1,1,1]
    v_pk_fma_f32 v[82:83], v[226:227], s[36:37], v[210:211] op_sel_hi:[1,0,0]
    v_pk_fma_f32 v[226:227], v[226:227], s[36:37], v[210:211] op_sel:[0,1,1] op_sel_hi:[1,1,1]
    v_pk_fma_f32 v[84:85], v[228:229], s[36:37], v[210:211] op_sel_hi:[1,0,0]
    v_pk_fma_f32 v[228:229], v[228:229], s[36:37], v[210:211] op_sel:[0,1,1] op_sel_hi:[1,1,1]
    v_pk_fma_f32 v[86:87], v[230:231], s[36:37], v[210:211] op_sel_hi:[1,0,0]
    v_pk_fma_f32 v[230:231], v[230:231], s[36:37], v[210:211] op_sel:[0,1,1] op_sel_hi:[1,1,1]
    v_pk_fma_f32 v[88:89], v[232:233], s[36:37], v[210:211] op_sel_hi:[1,0,0]
    v_pk_fma_f32 v[232:233], v[232:233], s[36:37], v[210:211] op_sel:[0,1,1] op_sel_hi:[1,1,1]
    v_pk_fma_f32 v[90:91], v[234:235], s[36:37], v[210:211] op_sel_hi:[1,0,0]
    v_pk_fma_f32 v[234:235], v[234:235], s[36:37], v[210:211] op_sel:[0,1,1] op_sel_hi:[1,1,1]
    v_pk_fma_f32 v[92:93], v[236:237], s[36:37], v[210:211] op_sel_hi:[1,0,0]
    v_pk_fma_f32 v[236:237], v[236:237], s[36:37], v[210:211] op_sel:[0,1,1] op_sel_hi:[1,1,1]
    v_pk_fma_f32 v[94:95], v[238:239], s[36:37], v[210:211] op_sel_hi:[1,0,0]
    v_pk_fma_f32 v[238:239], v[238:239], s[36:37], v[210:211] op_sel:[0,1,1] op_sel_hi:[1,1,1]
    v_exp_f32 v76, v76
    v_exp_f32 v220, v220
    v_exp_f32 v77, v77
    v_exp_f32 v221, v221
    v_exp_f32 v78, v78
    v_exp_f32 v222, v222
    v_exp_f32 v79, v79
    v_exp_f32 v223, v223
    v_exp_f32 v80, v80
    v_exp_f32 v224, v224
    v_exp_f32 v81, v81
    v_exp_f32 v225, v225
    v_exp_f32 v82, v82
    v_exp_f32 v226, v226
    v_exp_f32 v83, v83
    v_exp_f32 v227, v227
    v_exp_f32 v84, v84
    v_exp_f32 v228, v228
    v_exp_f32 v85, v85
    v_exp_f32 v229, v229
    v_exp_f32 v86, v86
    v_exp_f32 v230, v230
    v_exp_f32 v87, v87
    v_exp_f32 v231, v231
    v_exp_f32 v88, v88
    v_exp_f32 v232, v232
    v_exp_f32 v89, v89
    v_exp_f32 v233, v233
    v_exp_f32 v90, v90
    v_exp_f32 v234, v234
    v_exp_f32 v91, v91
    v_exp_f32 v235, v235
    v_exp_f32 v92, v92
    v_exp_f32 v236, v236
    v_exp_f32 v93, v93
    v_exp_f32 v237, v237
    v_exp_f32 v94, v94
    v_exp_f32 v238, v238
    v_exp_f32 v95, v95
    v_exp_f32 v239, v239
    s_nop 0
    v_pk_add_f32 v[208:209], v[76:77], v[78:79]
    v_pk_add_f32 v[210:211], v[220:221], v[222:223]
    v_pk_add_f32 v[208:209], v[208:209], v[80:81]
    v_pk_add_f32 v[210:211], v[210:211], v[224:225]
    v_pk_add_f32 v[208:209], v[208:209], v[82:83]
    v_pk_add_f32 v[210:211], v[210:211], v[226:227]
    v_pk_add_f32 v[208:209], v[208:209], v[84:85]
    v_pk_add_f32 v[210:211], v[210:211], v[228:229]
    v_pk_add_f32 v[208:209], v[208:209], v[86:87]
    v_pk_add_f32 v[210:211], v[210:211], v[230:231]
    v_pk_add_f32 v[208:209], v[208:209], v[88:89]
    v_pk_add_f32 v[210:211], v[210:211], v[232:233]
    v_pk_add_f32 v[208:209], v[208:209], v[90:91]
    v_pk_add_f32 v[210:211], v[210:211], v[234:235]
    v_pk_add_f32 v[208:209], v[208:209], v[92:93]
    v_pk_add_f32 v[210:211], v[210:211], v[236:237]
    v_pk_add_f32 v[208:209], v[208:209], v[94:95]
    v_pk_add_f32 v[210:211], v[210:211], v[238:239]
    v_add_f32 v208, v208, v209
    v_add_f32 v210, v210, v211
    v_rcp_f32 v208, v208
    v_rcp_f32 v210, v210
    s_nop 0
    v_pk_mul_f32 v[76:77], v[76:77], v[208:209] op_sel_hi:[1,0]
    v_pk_mul_f32 v[220:221], v[220:221], v[210:211] op_sel_hi:[1,0]
    v_pk_mul_f32 v[78:79], v[78:79], v[208:209] op_sel_hi:[1,0]
    v_pk_mul_f32 v[222:223], v[222:223], v[210:211] op_sel_hi:[1,0]
    v_pk_mul_f32 v[80:81], v[80:81], v[208:209] op_sel_hi:[1,0]
    v_pk_mul_f32 v[224:225], v[224:225], v[210:211] op_sel_hi:[1,0]
    v_pk_mul_f32 v[82:83], v[82:83], v[208:209] op_sel_hi:[1,0]
    v_pk_mul_f32 v[226:227], v[226:227], v[210:211] op_sel_hi:[1,0]
    v_pk_mul_f32 v[84:85], v[84:85], v[208:209] op_sel_hi:[1,0]
    v_pk_mul_f32 v[228:229], v[228:229], v[210:211] op_sel_hi:[1,0]
    v_pk_mul_f32 v[86:87], v[86:87], v[208:209] op_sel_hi:[1,0]
    v_pk_mul_f32 v[230:231], v[230:231], v[210:211] op_sel_hi:[1,0]
    v_pk_mul_f32 v[88:89], v[88:89], v[208:209] op_sel_hi:[1,0]
    v_pk_mul_f32 v[232:233], v[232:233], v[210:211] op_sel_hi:[1,0]
    v_pk_mul_f32 v[90:91], v[90:91], v[208:209] op_sel_hi:[1,0]
    v_pk_mul_f32 v[234:235], v[234:235], v[210:211] op_sel_hi:[1,0]
    v_pk_mul_f32 v[92:93], v[92:93], v[208:209] op_sel_hi:[1,0]
    v_pk_mul_f32 v[236:237], v[236:237], v[210:211] op_sel_hi:[1,0]
    v_pk_mul_f32 v[94:95], v[94:95], v[208:209] op_sel_hi:[1,0]
    v_pk_mul_f32 v[238:239], v[238:239], v[210:211] op_sel_hi:[1,0]
    v_cvt_pk_bf16_f32 v28, v76, v77
    v_cvt_pk_bf16_f32 v29, v78, v79
    v_cvt_pk_bf16_f32 v30, v80, v81
    v_cvt_pk_bf16_f32 v31, v82, v83
    v_cvt_pk_bf16_f32 v32, v84, v85
    v_cvt_pk_bf16_f32 v33, v86, v87
    v_cvt_pk_bf16_f32 v34, v88, v89
    v_cvt_pk_bf16_f32 v35, v90, v91
    v_cvt_pk_bf16_f32 v36, v92, v93
    v_cvt_pk_bf16_f32 v37, v94, v95
    v_cvt_pk_bf16_f32 v38, v220, v221
    v_cvt_pk_bf16_f32 v39, v222, v223
    v_cvt_pk_bf16_f32 v40, v224, v225
    v_cvt_pk_bf16_f32 v41, v226, v227
    v_cvt_pk_bf16_f32 v42, v228, v229
    v_cvt_pk_bf16_f32 v43, v230, v231
    v_cvt_pk_bf16_f32 v44, v232, v233
    v_cvt_pk_bf16_f32 v45, v234, v235
    v_cvt_pk_bf16_f32 v46, v236, v237
    v_cvt_pk_bf16_f32 v47, v238, v239
    s_cmp_eq_u32 s25, 0
    s_cbranch_scc0 K1_ak_1
    buffer_store_dwordx4 v[28:31], v4, s[12:15], 0 offen offset:0 sc1
    buffer_store_dwordx4 v[32:35], v4, s[12:15], 0 offen offset:256 sc1
    buffer_store_dwordx4 v[36:39], v4, s[12:15], 0 offen offset:512 sc1
    buffer_store_dwordx4 v[40:43], v4, s[12:15], 0 offen offset:768 sc1
    buffer_store_dwordx4 v[44:47], v4, s[12:15], 0 offen offset:1024 sc1
    s_branch K1_ae_2
K1_ak_1:
    ds_write_b128 v5, v[28:31] offset:0
    ds_write_b128 v5, v[32:35] offset:16
    ds_write_b128 v5, v[36:39] offset:32
    ds_write_b128 v5, v[40:43] offset:48
    ds_write_b128 v5, v[44:47] offset:64
K1_ae_2:
    s_nop 1
    v_cvt_pk_bf16_f32 v208, v108, v109
    v_cvt_pk_bf16_f32 v209, v110, v111
    v_cvt_pk_bf16_f32 v210, v112, v113
    v_cvt_pk_bf16_f32 v211, v114, v115
    v_cvt_pk_bf16_f32 v212, v116, v117
    v_cvt_pk_bf16_f32 v213, v118, v119
    v_cvt_pk_bf16_f32 v214, v120, v121
    v_cvt_pk_bf16_f32 v215, v122, v123
    v_cvt_pk_bf16_f32 v216, v124, v125
    v_cvt_pk_bf16_f32 v217, v126, v127
    s_nop 1
    v_mfma_f32_16x16x32_bf16 v[220:223], v[148:151], v[208:211], 0
    v_mfma_f32_16x16x32_bf16 v[224:227], v[160:163], v[208:211], 0
    v_mfma_f32_16x16x32_bf16 v[228:231], v[172:175], v[208:211], 0
    v_mfma_f32_16x16x32_bf16 v[232:235], v[184:187], v[208:211], 0
    v_mfma_f32_16x16x32_bf16 v[236:239], v[196:199], v[208:211], 0
    v_mfma_f32_16x16x32_bf16 v[220:223], v[152:155], v[212:215], v[220:223]
    v_mfma_f32_16x16x32_bf16 v[224:227], v[164:167], v[212:215], v[224:227]
    v_mfma_f32_16x16x32_bf16 v[228:231], v[176:179], v[212:215], v[228:231]
    v_mfma_f32_16x16x32_bf16 v[232:235], v[188:191], v[212:215], v[232:235]
    v_mfma_f32_16x16x32_bf16 v[236:239], v[200:203], v[212:215], v[236:239]
    v_mfma_f32_16x16x32_bf16 v[220:223], v[156:159], v[216:219], v[220:223]
    v_mfma_f32_16x16x32_bf16 v[224:227], v[168:171], v[216:219], v[224:227]
    v_mfma_f32_16x16x32_bf16 v[228:231], v[180:183], v[216:219], v[228:231]
    v_mfma_f32_16x16x32_bf16 v[232:235], v[192:195], v[216:219], v[232:235]
    v_mfma_f32_16x16x32_bf16 v[236:239], v[204:207], v[216:219], v[236:239]
    s_nop 7
    v_cvt_pk_bf16_f32 v108, v220, v221
    v_cvt_pk_bf16_f32 v109, v222, v223
    v_cvt_pk_bf16_f32 v110, v224, v225
    v_cvt_pk_bf16_f32 v111, v226, v227
    v_cvt_pk_bf16_f32 v112, v228, v229
    v_cvt_pk_bf16_f32 v113, v230, v231
    v_cvt_pk_bf16_f32 v114, v232, v233
    v_cvt_pk_bf16_f32 v115, v234, v235
    v_cvt_pk_bf16_f32 v116, v236, v237
    v_cvt_pk_bf16_f32 v117, v238, v239
    v_lshlrev_b32 v220, 16, v108
    v_and_b32 v221, 0xffff0000, v108
    v_lshlrev_b32 v222, 16, v109
    v_and_b32 v223, 0xffff0000, v109
    v_lshlrev_b32 v224, 16, v110
    v_and_b32 v225, 0xffff0000, v110
    v_lshlrev_b32 v226, 16, v111
    v_and_b32 v227, 0xffff0000, v111
    v_lshlrev_b32 v228, 16, v112
    v_and_b32 v229, 0xffff0000, v112
    v_lshlrev_b32 v230, 16, v113
    v_and_b32 v231, 0xffff0000, v113
    v_lshlrev_b32 v232, 16, v114
    v_and_b32 v233, 0xffff0000, v114
    v_lshlrev_b32 v234, 16, v115
    v_and_b32 v235, 0xffff0000, v115
    v_lshlrev_b32 v236, 16, v116
    v_and_b32 v237, 0xffff0000, v116
    v_lshlrev_b32 v238, 16, v117
    v_and_b32 v239, 0xffff0000, v117
    v_max3_f32 v208, v220, v221, v222
    v_min3_f32 v209, v220, v221, v222
    v_max3_f32 v208, v208, v223, v224
    v_min3_f32 v209, v209, v223, v224
    v_max3_f32 v208, v208, v225, v226
    v_min3_f32 v209, v209, v225, v226
    v_max3_f32 v208, v208, v227, v228
    v_min3_f32 v209, v209, v227, v228
    v_max3_f32 v208, v208, v229, v230
    v_min3_f32 v209, v209, v229, v230
    v_max3_f32 v208, v208, v231, v232
    v_min3_f32 v209, v209, v231, v232
    v_max3_f32 v208, v208, v233, v234
    v_min3_f32 v209, v209, v233, v234
    v_max3_f32 v208, v208, v235, v236
    v_min3_f32 v209, v209, v235, v236
    v_max3_f32 v208, v208, v237, v238
    v_min3_f32 v209, v209, v237, v238
    v_max_f32 v208, v208, v239
    v_min_f32 v209, v209, v239
    v_mul_f32 v210, s37, v208
    v_mul_f32 v211, s36, v209
    v_pk_fma_f32 v[108:109], v[220:221], s[36:37], v[210:211] op_sel_hi:[1,0,0]
    v_pk_fma_f32 v[220:221], v[220:221], s[36:37], v[210:211] op_sel:[0,1,1] op_sel_hi:[1,1,1]
    v_pk_fma_f32 v[110:111], v[222:223], s[36:37], v[210:211] op_sel_hi:[1,0,0]
    v_pk_fma_f32 v[222:223], v[222:223], s[36:37], v[210:211] op_sel:[0,1,1] op_sel_hi:[1,1,1]
    v_pk_fma_f32 v[112:113], v[224:225], s[36:37], v[210:211] op_sel_hi:[1,0,0]
    v_pk_fma_f32 v[224:225], v[224:225], s[36:37], v[210:211] op_sel:[0,1,1] op_sel_hi:[1,1,1]
    v_pk_fma_f32 v[114:115], v[226:227], s[36:37], v[210:211] op_sel_hi:[1,0,0]
    v_pk_fma_f32 v[226:227], v[226:227], s[36:37], v[210:211] op_sel:[0,1,1] op_sel_hi:[1,1,1]
    v_pk_fma_f32 v[116:117], v[228:229], s[36:37], v[210:211] op_sel_hi:[1,0,0]
    v_pk_fma_f32 v[228:229], v[228:229], s[36:37], v[210:211] op_sel:[0,1,1] op_sel_hi:[1,1,1]
    v_pk_fma_f32 v[118:119], v[230:231], s[36:37], v[210:211] op_sel_hi:[1,0,0]
    v_pk_fma_f32 v[230:231], v[230:231], s[36:37], v[210:211] op_sel:[0,1,1] op_sel_hi:[1,1,1]
    v_pk_fma_f32 v[120:121], v[232:233], s[36:37], v[210:211] op_sel_hi:[1,0,0]
    v_pk_fma_f32 v[232:233], v[232:233], s[36:37], v[210:211] op_sel:[0,1,1] op_sel_hi:[1,1,1]
    v_pk_fma_f32 v[122:123], v[234:235], s[36:37], v[210:211] op_sel_hi:[1,0,0]
    v_pk_fma_f32 v[234:235], v[234:235], s[36:37], v[210:211] op_sel:[0,1,1] op_sel_hi:[1,1,1]
    v_pk_fma_f32 v[124:125], v[236:237], s[36:37], v[210:211] op_sel_hi:[1,0,0]
    v_pk_fma_f32 v[236:237], v[236:237], s[36:37], v[210:211] op_sel:[0,1,1] op_sel_hi:[1,1,1]
    v_pk_fma_f32 v[126:127], v[238:239], s[36:37], v[210:211] op_sel_hi:[1,0,0]
    v_pk_fma_f32 v[238:239], v[238:239], s[36:37], v[210:211] op_sel:[0,1,1] op_sel_hi:[1,1,1]
    v_exp_f32 v108, v108
    v_exp_f32 v220, v220
    v_exp_f32 v109, v109
    v_exp_f32 v221, v221
    v_exp_f32 v110, v110
    v_exp_f32 v222, v222
    v_exp_f32 v111, v111
    v_exp_f32 v223, v223
    v_exp_f32 v112, v112
    v_exp_f32 v224, v224
    v_exp_f32 v113, v113
    v_exp_f32 v225, v225
    v_exp_f32 v114, v114
    v_exp_f32 v226, v226
    v_exp_f32 v115, v115
    v_exp_f32 v227, v227
    v_exp_f32 v116, v116
    v_exp_f32 v228, v228
    v_exp_f32 v117, v117
    v_exp_f32 v229, v229
    v_exp_f32 v118, v118
    v_exp_f32 v230, v230
    v_exp_f32 v119, v119
    v_exp_f32 v231, v231
    v_exp_f32 v120, v120
    v_exp_f32 v232, v232
    v_exp_f32 v121, v121
    v_exp_f32 v233, v233
    v_exp_f32 v122, v122
    v_exp_f32 v234, v234
    v_exp_f32 v123, v123
    v_exp_f32 v235, v235
    v_exp_f32 v124, v124
    v_exp_f32 v236, v236
    v_exp_f32 v125, v125
    v_exp_f32 v237, v237
    v_exp_f32 v126, v126
    v_exp_f32 v238, v238
    v_exp_f32 v127, v127
    v_exp_f32 v239, v239
    s_nop 0
    v_pk_add_f32 v[208:209], v[108:109], v[110:111]
    v_pk_add_f32 v[210:211], v[220:221], v[222:223]
    v_pk_add_f32 v[208:209], v[208:209], v[112:113]
    v_pk_add_f32 v[210:211], v[210:211], v[224:225]
    v_pk_add_f32 v[208:209], v[208:209], v[114:115]
    v_pk_add_f32 v[210:211], v[210:211], v[226:227]
    v_pk_add_f32 v[208:209], v[208:209], v[116:117]
    v_pk_add_f32 v[210:211], v[210:211], v[228:229]
    v_pk_add_f32 v[208:209], v[208:209], v[118:119]
    v_pk_add_f32 v[210:211], v[210:211], v[230:231]
    v_pk_add_f32 v[208:209], v[208:209], v[120:121]
    v_pk_add_f32 v[210:211], v[210:211], v[232:233]
    v_pk_add_f32 v[208:209], v[208:209], v[122:123]
    v_pk_add_f32 v[210:211], v[210:211], v[234:235]
    v_pk_add_f32 v[208:209], v[208:209], v[124:125]
    v_pk_add_f32 v[210:211], v[210:211], v[236:237]
    v_pk_add_f32 v[208:209], v[208:209], v[126:127]
    v_pk_add_f32 v[210:211], v[210:211], v[238:239]
    v_add_f32 v208, v208, v209
    v_add_f32 v210, v210, v211
    v_rcp_f32 v208, v208
    v_rcp_f32 v210, v210
    s_nop 0
    v_pk_mul_f32 v[108:109], v[108:109], v[208:209] op_sel_hi:[1,0]
    v_pk_mul_f32 v[220:221], v[220:221], v[210:211] op_sel_hi:[1,0]
    v_pk_mul_f32 v[110:111], v[110:111], v[208:209] op_sel_hi:[1,0]
    v_pk_mul_f32 v[222:223], v[222:223], v[210:211] op_sel_hi:[1,0]
    v_pk_mul_f32 v[112:113], v[112:113], v[208:209] op_sel_hi:[1,0]
    v_pk_mul_f32 v[224:225], v[224:225], v[210:211] op_sel_hi:[1,0]
    v_pk_mul_f32 v[114:115], v[114:115], v[208:209] op_sel_hi:[1,0]
    v_pk_mul_f32 v[226:227], v[226:227], v[210:211] op_sel_hi:[1,0]
    v_pk_mul_f32 v[116:117], v[116:117], v[208:209] op_sel_hi:[1,0]
    v_pk_mul_f32 v[228:229], v[228:229], v[210:211] op_sel_hi:[1,0]
    v_pk_mul_f32 v[118:119], v[118:119], v[208:209] op_sel_hi:[1,0]
    v_pk_mul_f32 v[230:231], v[230:231], v[210:211] op_sel_hi:[1,0]
    v_pk_mul_f32 v[120:121], v[120:121], v[208:209] op_sel_hi:[1,0]
    v_pk_mul_f32 v[232:233], v[232:233], v[210:211] op_sel_hi:[1,0]
    v_pk_mul_f32 v[122:123], v[122:123], v[208:209] op_sel_hi:[1,0]
    v_pk_mul_f32 v[234:235], v[234:235], v[210:211] op_sel_hi:[1,0]
    v_pk_mul_f32 v[124:125], v[124:125], v[208:209] op_sel_hi:[1,0]
    v_pk_mul_f32 v[236:237], v[236:237], v[210:211] op_sel_hi:[1,0]
    v_pk_mul_f32 v[126:127], v[126:127], v[208:209] op_sel_hi:[1,0]
    v_pk_mul_f32 v[238:239], v[238:239], v[210:211] op_sel_hi:[1,0]
    v_cvt_pk_bf16_f32 v28, v108, v109
    v_cvt_pk_bf16_f32 v29, v110, v111
    v_cvt_pk_bf16_f32 v30, v112, v113
    v_cvt_pk_bf16_f32 v31, v114, v115
    v_cvt_pk_bf16_f32 v32, v116, v117
    v_cvt_pk_bf16_f32 v33, v118, v119
    v_cvt_pk_bf16_f32 v34, v120, v121
    v_cvt_pk_bf16_f32 v35, v122, v123
    v_cvt_pk_bf16_f32 v36, v124, v125
    v_cvt_pk_bf16_f32 v37, v126, v127
    v_cvt_pk_bf16_f32 v38, v220, v221
    v_cvt_pk_bf16_f32 v39, v222, v223
    v_cvt_pk_bf16_f32 v40, v224, v225
    v_cvt_pk_bf16_f32 v41, v226, v227
    v_cvt_pk_bf16_f32 v42, v228, v229
    v_cvt_pk_bf16_f32 v43, v230, v231
    v_cvt_pk_bf16_f32 v44, v232, v233
    v_cvt_pk_bf16_f32 v45, v234, v235
    v_cvt_pk_bf16_f32 v46, v236, v237
    v_cvt_pk_bf16_f32 v47, v238, v239
    s_cmp_eq_u32 s25, 0
    s_cbranch_scc0 K1_ak_3
    buffer_store_dwordx4 v[28:31], v9, s[12:15], 0 offen offset:0 sc1
    buffer_store_dwordx4 v[32:35], v9, s[12:15], 0 offen offset:256 sc1
    buffer_store_dwordx4 v[36:39], v9, s[12:15], 0 offen offset:512 sc1
    buffer_store_dwordx4 v[40:43], v9, s[12:15], 0 offen offset:768 sc1
    buffer_store_dwordx4 v[44:47], v9, s[12:15], 0 offen offset:1024 sc1
    s_branch K1_ae_4
K1_ak_3:
    ds_write_b128 v5, v[28:31] offset:1280
    ds_write_b128 v5, v[32:35] offset:1296
    ds_write_b128 v5, v[36:39] offset:1312
    ds_write_b128 v5, v[40:43] offset:1328
    ds_write_b128 v5, v[44:47] offset:1344
K1_ae_4:
    s_nop 1
    s_waitcnt lgkmcnt(0)
    s_barrier
    v_and_b32 v2, 3, v1
    v_bfe_u32 v3, v1, 2, 2
    v_lshl_add_u32 v3, v10, 3, v3
    v_mul_u32_u24 v4, 80, v3
    v_lshl_add_u32 v4, v2, 3, v4
    s_mul_i32 s26, s24, 10240
    v_add_u32 v4, s26, v4
    v_mul_u32_u24 v5, 48, v3
    v_lshl_add_u32 v5, v2, 3, v5
    s_mul_i32 s26, s24, 6144
    s_add_u32 s26, s26, 40960
    v_add_u32 v5, s26, v5
    s_lshl_b32 s26, s20, 5
    s_lshl_b32 s27, s21, 2
    s_add_u32 s26, s26, s27
    s_add_u32 s26, s26, s24
    s_mul_i32 s26, s26, 6144
    s_add_u32 s26, s26, 8388608
    v_and_b32 v2, 15, v1
    v_mul_u32_u24 v2, 192, v2
    v_lshl_add_u32 v2, v10, 4, v2
    v_add_u32 v2, s26, v2
    s_mul_i32 s26, s25, 3
    s_add_u32 s26, s26, 0
    s_lshr_b32 s27, s26, 1
    s_and_b32 s28, s26, 1
    s_lshl_b32 s29, s27, 5
    v_add_u32 v184, s29, v4
    s_lshl_b32 s29, s28, 5
    v_add_u32 v187, s29, v5
    s_lshl_b32 s29, s27, 6
    s_mul_i32 s30, s28, 3072
    s_add_u32 s29, s29, s30
    v_add_u32 v190, s29, v2
    s_mul_i32 s26, s25, 3
    s_add_u32 s26, s26, 1
    s_lshr_b32 s27, s26, 1
    s_and_b32 s28, s26, 1
    s_lshl_b32 s29, s27, 5
    v_add_u32 v185, s29, v4
    s_lshl_b32 s29, s28, 5
    v_add_u32 v188, s29, v5
    s_lshl_b32 s29, s27, 6
    s_mul_i32 s30, s28, 3072
    s_add_u32 s29, s29, s30
    v_add_u32 v191, s29, v2
    s_mul_i32 s26, s25, 3
    s_add_u32 s26, s26, 2
    s_lshr_b32 s27, s26, 1
    s_and_b32 s28, s26, 1
    s_lshl_b32 s29, s27, 5
    v_add_u32 v186, s29, v4
    s_lshl_b32 s29, s28, 5
    v_add_u32 v189, s29, v5
    s_lshl_b32 s29, s27, 6
    s_mul_i32 s30, s28, 3072
    s_add_u32 s29, s29, s30
    v_add_u32 v192, s29, v2
    ds_read_b64_tr_b16 v[76:77], v184 offset:0
    ds_read_b64_tr_b16 v[124:125], v187 offset:0
    ds_read_b64_tr_b16 v[78:79], v184 offset:320
    ds_read_b64_tr_b16 v[126:127], v187 offset:192
    ds_read_b64_tr_b16 v[92:93], v185 offset:0
    ds_read_b64_tr_b16 v[140:141], v188 offset:0
    ds_read_b64_tr_b16 v[94:95], v185 offset:320
    ds_read_b64_tr_b16 v[142:143], v188 offset:192
    ds_read_b64_tr_b16 v[108:109], v186 offset:0
    ds_read_b64_tr_b16 v[156:157], v189 offset:0
    ds_read_b64_tr_b16 v[110:111], v186 offset:320
    ds_read_b64_tr_b16 v[158:159], v189 offset:192
    s_waitcnt lgkmcnt(0)
    ds_read_b64_tr_b16 v[80:81], v184 offset:2560
    ds_read_b64_tr_b16 v[128:129], v187 offset:1536
    ds_read_b64_tr_b16 v[82:83], v184 offset:2880
    ds_read_b64_tr_b16 v[130:131], v187 offset:1728
    ds_read_b64_tr_b16 v[96:97], v185 offset:2560
    ds_read_b64_tr_b16 v[144:145], v188 offset:1536
    ds_read_b64_tr_b16 v[98:99], v185 offset:2880
    ds_read_b64_tr_b16 v[146:147], v188 offset:1728
    ds_read_b64_tr_b16 v[112:113], v186 offset:2560
    ds_read_b64_tr_b16 v[160:161], v189 offset:1536
    ds_read_b64_tr_b16 v[114:115], v186 offset:2880
    ds_read_b64_tr_b16 v[162:163], v189 offset:1728
    s_waitcnt lgkmcnt(0)
    ds_read_b64_tr_b16 v[84:85], v184 offset:5120
    ds_read_b64_tr_b16 v[132:133], v187 offset:3072
    ds_read_b64_tr_b16 v[86:87], v184 offset:5440
    ds_read_b64_tr_b16 v[134:135], v187 offset:3264
    ds_read_b64_tr_b16 v[100:101], v185 offset:5120
    ds_read_b64_tr_b16 v[148:149], v188 offset:3072
    ds_read_b64_tr_b16 v[102:103], v185 offset:5440
    ds_read_b64_tr_b16 v[150:151], v188 offset:3264
    ds_read_b64_tr_b16 v[116:117], v186 offset:5120
    ds_read_b64_tr_b16 v[164:165], v189 offset:3072
    ds_read_b64_tr_b16 v[118:119], v186 offset:5440
    ds_read_b64_tr_b16 v[166:167], v189 offset:3264
    s_waitcnt lgkmcnt(0)
    ds_read_b64_tr_b16 v[88:89], v184 offset:7680
    ds_read_b64_tr_b16 v[136:137], v187 offset:4608
    ds_read_b64_tr_b16 v[90:91], v184 offset:8000
    ds_read_b64_tr_b16 v[138:139], v187 offset:4800
    ds_read_b64_tr_b16 v[104:105], v185 offset:7680
    ds_read_b64_tr_b16 v[152:153], v188 offset:4608
    ds_read_b64_tr_b16 v[106:107], v185 offset:8000
    ds_read_b64_tr_b16 v[154:155], v188 offset:4800
    ds_read_b64_tr_b16 v[120:121], v186 offset:7680
    ds_read_b64_tr_b16 v[168:169], v189 offset:4608
    ds_read_b64_tr_b16 v[122:123], v186 offset:8000
    ds_read_b64_tr_b16 v[170:171], v189 offset:4800
    s_waitcnt lgkmcnt(0)
    v_mfma_f32_16x16x32_bf16 v[172:175], v[76:79], v[124:127], 0
    v_mfma_f32_16x16x32_bf16 v[176:179], v[92:95], v[140:143], 0
    v_mfma_f32_16x16x32_bf16 v[180:183], v[108:111], v[156:159], 0
    v_mfma_f32_16x16x32_bf16 v[172:175], v[80:83], v[128:131], v[172:175]
    v_mfma_f32_16x16x32_bf16 v[176:179], v[96:99], v[144:147], v[176:179]
    v_mfma_f32_16x16x32_bf16 v[180:183], v[112:115], v[160:163], v[180:183]
    v_mfma_f32_16x16x32_bf16 v[172:175], v[84:87], v[132:135], v[172:175]
    v_mfma_f32_16x16x32_bf16 v[176:179], v[100:103], v[148:151], v[176:179]
    v_mfma_f32_16x16x32_bf16 v[180:183], v[116:119], v[164:167], v[180:183]
    v_mfma_f32_16x16x32_bf16 v[172:175], v[88:91], v[136:139], v[172:175]
    v_mfma_f32_16x16x32_bf16 v[176:179], v[104:107], v[152:155], v[176:179]
    v_mfma_f32_16x16x32_bf16 v[180:183], v[120:123], v[168:171], v[180:183]
    s_nop 7
    buffer_store_dwordx4 v[172:175], v190, s[12:15], 0 offen sc1
    buffer_store_dwordx4 v[176:179], v191, s[12:15], 0 offen sc1
    buffer_store_dwordx4 v[180:183], v192, s[12:15], 0 offen sc1
    s_cmp_ge_u32 s23, 4
    s_cbranch_scc1 K1_gdone
    s_load_dwordx2 s[44:45], s[0:1], 56
    s_waitcnt lgkmcnt(0)
    s_mov_b32 s16, s44
    s_and_b32 s17, s45, 0xffff
    s_mov_b32 s18, 1280
    s_mov_b32 s19, 0x00020000
    s_lshl_b32 s26, s20, 7
    s_lshl_b32 s27, s21, 4
    s_add_u32 s26, s26, s27
    s_lshl_b32 s27, s23, 2
    s_add_u32 s26, s26, s27
    v_add_u32 v2, s26, v10
    v_and_b32 v3, 15, v1
    v_mul_u32_u24 v3, 80, v3
    v_mul_u32_u24 v4, 1280, v2
    v_add_u32 v4, v4, v3
    buffer_load_dwordx4 v[188:191], v4, s[4:7], 0 offen offset:0
    buffer_load_dwordx4 v[208:211], v3, s[16:19], 0 offen offset:0
    buffer_load_dwordx4 v[192:195], v4, s[4:7], 0 offen offset:16
    buffer_load_dwordx4 v[212:215], v3, s[16:19], 0 offen offset:16
    buffer_load_dwordx4 v[196:199], v4, s[4:7], 0 offen offset:32
    buffer_load_dwordx4 v[216:219], v3, s[16:19], 0 offen offset:32
    buffer_load_dwordx4 v[200:203], v4, s[4:7], 0 offen offset:48
    buffer_load_dwordx4 v[220:223], v3, s[16:19], 0 offen offset:48
    buffer_load_dwordx4 v[204:207], v4, s[4:7], 0 offen offset:64
    buffer_load_dwordx4 v[224:227], v3, s[16:19], 0 offen offset:64
    s_waitcnt vmcnt(0)
    v_mov_b32 v28, 0
    v_mov_b32 v29, 0
    v_lshlrev_b32 v30, 16, v188
    v_and_b32 v31, 0xffff0000, v188
    v_lshlrev_b32 v32, 16, v208
    v_and_b32 v33, 0xffff0000, v208
    v_mul_f32 v30, v30, v32
    v_mul_f32 v31, v31, v33
    v_cvt_pk_bf16_f32 v30, v30, v31
    v_lshlrev_b32 v31, 16, v30
    v_and_b32 v30, 0xffff0000, v30
    v_add_f32 v28, v28, v31
    v_add_f32 v29, v29, v30
    v_lshlrev_b32 v30, 16, v189
    v_and_b32 v31, 0xffff0000, v189
    v_lshlrev_b32 v32, 16, v209
    v_and_b32 v33, 0xffff0000, v209
    v_mul_f32 v30, v30, v32
    v_mul_f32 v31, v31, v33
    v_cvt_pk_bf16_f32 v30, v30, v31
    v_lshlrev_b32 v31, 16, v30
    v_and_b32 v30, 0xffff0000, v30
    v_add_f32 v28, v28, v31
    v_add_f32 v29, v29, v30
    v_lshlrev_b32 v30, 16, v190
    v_and_b32 v31, 0xffff0000, v190
    v_lshlrev_b32 v32, 16, v210
    v_and_b32 v33, 0xffff0000, v210
    v_mul_f32 v30, v30, v32
    v_mul_f32 v31, v31, v33
    v_cvt_pk_bf16_f32 v30, v30, v31
    v_lshlrev_b32 v31, 16, v30
    v_and_b32 v30, 0xffff0000, v30
    v_add_f32 v28, v28, v31
    v_add_f32 v29, v29, v30
    v_lshlrev_b32 v30, 16, v191
    v_and_b32 v31, 0xffff0000, v191
    v_lshlrev_b32 v32, 16, v211
    v_and_b32 v33, 0xffff0000, v211
    v_mul_f32 v30, v30, v32
    v_mul_f32 v31, v31, v33
    v_cvt_pk_bf16_f32 v30, v30, v31
    v_lshlrev_b32 v31, 16, v30
    v_and_b32 v30, 0xffff0000, v30
    v_add_f32 v28, v28, v31
    v_add_f32 v29, v29, v30
    v_lshlrev_b32 v30, 16, v192
    v_and_b32 v31, 0xffff0000, v192
    v_lshlrev_b32 v32, 16, v212
    v_and_b32 v33, 0xffff0000, v212
    v_mul_f32 v30, v30, v32
    v_mul_f32 v31, v31, v33
    v_cvt_pk_bf16_f32 v30, v30, v31
    v_lshlrev_b32 v31, 16, v30
    v_and_b32 v30, 0xffff0000, v30
    v_add_f32 v28, v28, v31
    v_add_f32 v29, v29, v30
    v_lshlrev_b32 v30, 16, v193
    v_and_b32 v31, 0xffff0000, v193
    v_lshlrev_b32 v32, 16, v213
    v_and_b32 v33, 0xffff0000, v213
    v_mul_f32 v30, v30, v32
    v_mul_f32 v31, v31, v33
    v_cvt_pk_bf16_f32 v30, v30, v31
    v_lshlrev_b32 v31, 16, v30
    v_and_b32 v30, 0xffff0000, v30
    v_add_f32 v28, v28, v31
    v_add_f32 v29, v29, v30
    v_lshlrev_b32 v30, 16, v194
    v_and_b32 v31, 0xffff0000, v194
    v_lshlrev_b32 v32, 16, v214
    v_and_b32 v33, 0xffff0000, v214
    v_mul_f32 v30, v30, v32
    v_mul_f32 v31, v31, v33
    v_cvt_pk_bf16_f32 v30, v30, v31
    v_lshlrev_b32 v31, 16, v30
    v_and_b32 v30, 0xffff0000, v30
    v_add_f32 v28, v28, v31
    v_add_f32 v29, v29, v30
    v_lshlrev_b32 v30, 16, v195
    v_and_b32 v31, 0xffff0000, v195
    v_lshlrev_b32 v32, 16, v215
    v_and_b32 v33, 0xffff0000, v215
    v_mul_f32 v30, v30, v32
    v_mul_f32 v31, v31, v33
    v_cvt_pk_bf16_f32 v30, v30, v31
    v_lshlrev_b32 v31, 16, v30
    v_and_b32 v30, 0xffff0000, v30
    v_add_f32 v28, v28, v31
    v_add_f32 v29, v29, v30
    v_lshlrev_b32 v30, 16, v196
    v_and_b32 v31, 0xffff0000, v196
    v_lshlrev_b32 v32, 16, v216
    v_and_b32 v33, 0xffff0000, v216
    v_mul_f32 v30, v30, v32
    v_mul_f32 v31, v31, v33
    v_cvt_pk_bf16_f32 v30, v30, v31
    v_lshlrev_b32 v31, 16, v30
    v_and_b32 v30, 0xffff0000, v30
    v_add_f32 v28, v28, v31
    v_add_f32 v29, v29, v30
    v_lshlrev_b32 v30, 16, v197
    v_and_b32 v31, 0xffff0000, v197
    v_lshlrev_b32 v32, 16, v217
    v_and_b32 v33, 0xffff0000, v217
    v_mul_f32 v30, v30, v32
    v_mul_f32 v31, v31, v33
    v_cvt_pk_bf16_f32 v30, v30, v31
    v_lshlrev_b32 v31, 16, v30
    v_and_b32 v30, 0xffff0000, v30
    v_add_f32 v28, v28, v31
    v_add_f32 v29, v29, v30
    v_lshlrev_b32 v30, 16, v198
    v_and_b32 v31, 0xffff0000, v198
    v_lshlrev_b32 v32, 16, v218
    v_and_b32 v33, 0xffff0000, v218
    v_mul_f32 v30, v30, v32
    v_mul_f32 v31, v31, v33
    v_cvt_pk_bf16_f32 v30, v30, v31
    v_lshlrev_b32 v31, 16, v30
    v_and_b32 v30, 0xffff0000, v30
    v_add_f32 v28, v28, v31
    v_add_f32 v29, v29, v30
    v_lshlrev_b32 v30, 16, v199
    v_and_b32 v31, 0xffff0000, v199
    v_lshlrev_b32 v32, 16, v219
    v_and_b32 v33, 0xffff0000, v219
    v_mul_f32 v30, v30, v32
    v_mul_f32 v31, v31, v33
    v_cvt_pk_bf16_f32 v30, v30, v31
    v_lshlrev_b32 v31, 16, v30
    v_and_b32 v30, 0xffff0000, v30
    v_add_f32 v28, v28, v31
    v_add_f32 v29, v29, v30
    v_lshlrev_b32 v30, 16, v200
    v_and_b32 v31, 0xffff0000, v200
    v_lshlrev_b32 v32, 16, v220
    v_and_b32 v33, 0xffff0000, v220
    v_mul_f32 v30, v30, v32
    v_mul_f32 v31, v31, v33
    v_cvt_pk_bf16_f32 v30, v30, v31
    v_lshlrev_b32 v31, 16, v30
    v_and_b32 v30, 0xffff0000, v30
    v_add_f32 v28, v28, v31
    v_add_f32 v29, v29, v30
    v_lshlrev_b32 v30, 16, v201
    v_and_b32 v31, 0xffff0000, v201
    v_lshlrev_b32 v32, 16, v221
    v_and_b32 v33, 0xffff0000, v221
    v_mul_f32 v30, v30, v32
    v_mul_f32 v31, v31, v33
    v_cvt_pk_bf16_f32 v30, v30, v31
    v_lshlrev_b32 v31, 16, v30
    v_and_b32 v30, 0xffff0000, v30
    v_add_f32 v28, v28, v31
    v_add_f32 v29, v29, v30
    v_lshlrev_b32 v30, 16, v202
    v_and_b32 v31, 0xffff0000, v202
    v_lshlrev_b32 v32, 16, v222
    v_and_b32 v33, 0xffff0000, v222
    v_mul_f32 v30, v30, v32
    v_mul_f32 v31, v31, v33
    v_cvt_pk_bf16_f32 v30, v30, v31
    v_lshlrev_b32 v31, 16, v30
    v_and_b32 v30, 0xffff0000, v30
    v_add_f32 v28, v28, v31
    v_add_f32 v29, v29, v30
    v_lshlrev_b32 v30, 16, v203
    v_and_b32 v31, 0xffff0000, v203
    v_lshlrev_b32 v32, 16, v223
    v_and_b32 v33, 0xffff0000, v223
    v_mul_f32 v30, v30, v32
    v_mul_f32 v31, v31, v33
    v_cvt_pk_bf16_f32 v30, v30, v31
    v_lshlrev_b32 v31, 16, v30
    v_and_b32 v30, 0xffff0000, v30
    v_add_f32 v28, v28, v31
    v_add_f32 v29, v29, v30
    v_lshlrev_b32 v30, 16, v204
    v_and_b32 v31, 0xffff0000, v204
    v_lshlrev_b32 v32, 16, v224
    v_and_b32 v33, 0xffff0000, v224
    v_mul_f32 v30, v30, v32
    v_mul_f32 v31, v31, v33
    v_cvt_pk_bf16_f32 v30, v30, v31
    v_lshlrev_b32 v31, 16, v30
    v_and_b32 v30, 0xffff0000, v30
    v_add_f32 v28, v28, v31
    v_add_f32 v29, v29, v30
    v_lshlrev_b32 v30, 16, v205
    v_and_b32 v31, 0xffff0000, v205
    v_lshlrev_b32 v32, 16, v225
    v_and_b32 v33, 0xffff0000, v225
    v_mul_f32 v30, v30, v32
    v_mul_f32 v31, v31, v33
    v_cvt_pk_bf16_f32 v30, v30, v31
    v_lshlrev_b32 v31, 16, v30
    v_and_b32 v30, 0xffff0000, v30
    v_add_f32 v28, v28, v31
    v_add_f32 v29, v29, v30
    v_lshlrev_b32 v30, 16, v206
    v_and_b32 v31, 0xffff0000, v206
    v_lshlrev_b32 v32, 16, v226
    v_and_b32 v33, 0xffff0000, v226
    v_mul_f32 v30, v30, v32
    v_mul_f32 v31, v31, v33
    v_cvt_pk_bf16_f32 v30, v30, v31
    v_lshlrev_b32 v31, 16, v30
    v_and_b32 v30, 0xffff0000, v30
    v_add_f32 v28, v28, v31
    v_add_f32 v29, v29, v30
    v_lshlrev_b32 v30, 16, v207
    v_and_b32 v31, 0xffff0000, v207
    v_lshlrev_b32 v32, 16, v227
    v_and_b32 v33, 0xffff0000, v227
    v_mul_f32 v30, v30, v32
    v_mul_f32 v31, v31, v33
    v_cvt_pk_bf16_f32 v30, v30, v31
    v_lshlrev_b32 v31, 16, v30
    v_and_b32 v30, 0xffff0000, v30
    v_add_f32 v28, v28, v31
    v_add_f32 v29, v29, v30
    v_add_f32 v28, v28, v29
    ds_swizzle_b32 v29, v28 offset:1055
    s_waitcnt lgkmcnt(0)
    v_add_f32 v28, v28, v29
    ds_swizzle_b32 v29, v28 offset:2079
    s_waitcnt lgkmcnt(0)
    v_add_f32 v28, v28, v29
    ds_swizzle_b32 v29, v28 offset:4127
    s_waitcnt lgkmcnt(0)
    v_add_f32 v28, v28, v29
    ds_swizzle_b32 v29, v28 offset:8223
    s_waitcnt lgkmcnt(0)
    v_add_f32 v28, v28, v29
    v_cvt_pk_bf16_f32 v28, v28, v28
    v_lshlrev_b32 v28, 16, v28
    v_mul_f32 v28, s37, v28
    v_exp_f32 v28, v28
    s_nop 0
    v_add_f32 v28, 1.0, v28
    v_rcp_f32 v28, v28
    s_nop 0
    v_cvt_pk_bf16_f32 v28, v28, v28
    v_lshlrev_b32 v28, 16, v28
    v_lshlrev_b32 v2, 2, v2
    v_add_u32 v2, 13631488, v2
    v_and_b32 v3, 15, v1
    v_cmp_eq_u32 vcc, 0, v3
    s_and_saveexec_b64 s[28:29], vcc
    buffer_store_dword v28, v2, s[12:15], 0 offen sc1
    s_mov_b64 exec, s[28:29]
K1_gdone:
    s_cmp_lg_u32 s23, 7
    s_cbranch_scc1 K1_sA_c
    s_waitcnt vmcnt(0)
    v_readfirstlane_b32 s26, v19
    s_nop 3
    s_cmp_ge_u32 s26, 256
    s_cbranch_scc1 K1_sA_c
    s_load_dwordx2 s[44:45], s[0:1], 72
    s_waitcnt lgkmcnt(0)
    s_mov_b32 s48, s44
    s_and_b32 s49, s45, 0xffff
    s_mov_b32 s50, 256
    s_mov_b32 s51, 0x00020000
    v_mov_b32 v2, 0
    s_mov_b32 s28, 0
K1_sA_l:
    buffer_load_dword v3, v2, s[48:51], 0 offen sc1
    s_waitcnt vmcnt(0)
    v_readfirstlane_b32 s26, v3
    s_nop 3
    s_cmp_ge_u32 s26, 256
    s_cbranch_scc1 K1_sA_c
    s_add_u32 s28, s28, 1
    s_cmp_lt_u32 s28, 0x40000
    s_cbranch_scc0 K1_sA_c
    s_sleep 2
    s_branch K1_sA_l
K1_sA_c:
    s_waitcnt vmcnt(0) lgkmcnt(0)
    s_barrier
    s_cmp_lg_u32 s23, 0
    s_cbranch_scc1 K1_sA
    s_add_u32 s27, s20, 8
    s_cmp_eq_u32 s22, 0
    s_cselect_b32 s26, s21, s27
    s_cselect_b32 s27, s20, s21
    s_lshl_b32 s26, s26, 7
    s_lshl_b32 s27, s27, 2
    s_add_u32 s26, s26, s27
    s_add_u32 s26, s26, 14684160
    v_mov_b32 v2, s26
    v_mov_b32 v3, 1
    s_mov_b64 exec, 1
    buffer_store_dword v3, v2, s[12:15], 0 offen sc1
    s_mov_b64 exec, -1
K1_sA:
    s_branch K1_tail
K1_B:
    s_mul_i32 s26, s2, 7
    s_add_u32 s26, s26, s23
    s_cmp_ge_u32 s23, 7
    s_cselect_b32 s26, 1600, s26
    s_mov_b32 s96, s26
    s_cmp_ge_u32 s26, 1600
    s_cbranch_scc1 K1_rlB
    s_load_dwordx2 s[92:93], s[0:1], 24
    s_load_dwordx2 s[94:95], s[0:1], 48
    s_mul_i32 s27, s26, 52429
    s_lshr_b32 s27, s27, 18
    s_mul_i32 s28, s27, 5
    s_sub_u32 s28, s26, s28
    s_mul_i32 s29, s27, 3277
    s_lshr_b32 s29, s29, 16
    s_mul_i32 s30, s29, 20
    s_sub_u32 s30, s27, s30
    s_and_b32 s31, s29, 7
    s_mul_i32 s31, s31, 160
    s_mul_i32 s30, s30, 40960
    s_add_u32 s31, s31, s30
    s_lshl_b32 s28, s28, 6
    v_add_u32 v172, s28, v1
    v_mul_u32_u24 v173, 6554, v172
    v_lshrrev_b32 v173, 16, v173
    v_mul_u32_u24 v174, 10, v173
    v_sub_u32 v174, v172, v174
    v_bfe_u32 v175, v173, 4, 1
    v_bfe_u32 v176, v173, 2, 2
    v_and_b32 v177, 3, v173
    v_lshl_add_u32 v177, v175, 2, v177
    v_lshl_add_u32 v177, v176, 3, v177
    v_mul_u32_u24 v177, 1280, v177
    v_lshl_add_u32 v177, v174, 4, v177
    v_add_u32 v177, s31, v177
    s_waitcnt lgkmcnt(0)
    s_cmp_lt_u32 s29, 8
    s_cselect_b32 s92, s92, s94
    s_cselect_b32 s93, s93, s95
    s_mov_b32 s84, s92
    s_and_b32 s85, s93, 0xffff
    s_mov_b32 s86, 819200
    s_mov_b32 s87, 0x00020000
    buffer_load_dwordx4 v[180:183], v177, s[84:87], 0 offen
K1_rlB:
    v_lshrrev_b32 v2, 2, v1
    v_mul_u32_u24 v2, 480, v2
    v_and_b32 v3, 3, v1
    v_mul_u32_u24 v3, 40, v3
    v_add_u32 v2, v2, v3
    s_mul_i32 s26, s25, 160
    v_add_u32 v11, s26, v2
    s_mul_i32 s26, s25, 24
    s_add_u32 s26, s26, 320
    v_add_u32 v12, s26, v2
    s_add_u32 s26, s23, 0
    s_cmp_ge_u32 s26, 10
    s_cselect_b32 s26, s23, s26
    s_add_u32 s26, s26, 5
    s_cmp_ge_u32 s26, 10
    s_mov_b32 s28, 120
    s_cselect_b32 s27, 240, s28
    s_lshl_b32 s26, s26, 3
    s_add_u32 s26, s26, s27
    v_add_u32 v17, s26, v2
    s_add_u32 s26, s23, 8
    s_cmp_ge_u32 s26, 10
    s_cselect_b32 s26, s23, s26
    s_add_u32 s26, s26, 5
    s_cmp_ge_u32 s26, 10
    s_mov_b32 s28, 120
    s_cselect_b32 s27, 240, s28
    s_lshl_b32 s26, s26, 3
    s_add_u32 s26, s26, s27
    v_add_u32 v18, s26, v2
    v_and_b32 v2, 15, v1
    v_and_b32 v3, 7, v1
    v_xor_b32 v3, v3, v10
    v_lshlrev_b32 v3, 4, v3
    v_lshl_add_u32 v3, v2, 7, v3
    v_add_u32 v15, 30720, v3
    v_xor_b32 v16, 64, v15
    s_lshl_b32 s26, s24, 12
    s_add_u32 s26, s26, 2048
    v_add_u32 v13, s26, v15
    v_add_u32 v14, s26, v16
    s_waitcnt vmcnt(6)
    s_barrier
    ds_read_b128 v[52:55], v13 offset:0
    ds_read_b128 v[56:59], v13 offset:2048
    ds_read_b128 v[60:63], v15
    ds_read_b64_tr_b16 v[28:29], v11 offset:0
    ds_read_b64_tr_b16 v[30:31], v11 offset:7680
    ds_read_b64_tr_b16 v[32:33], v11 offset:8
    ds_read_b64_tr_b16 v[34:35], v11 offset:7688
    ds_read_b64_tr_b16 v[36:37], v11 offset:16
    ds_read_b64_tr_b16 v[38:39], v11 offset:7696
    ds_read_b64_tr_b16 v[40:41], v11 offset:24
    ds_read_b64_tr_b16 v[42:43], v11 offset:7704
    ds_read_b64_tr_b16 v[44:45], v17 offset:0
    ds_read_b64_tr_b16 v[46:47], v17 offset:7680
    ds_read_b64_tr_b16 v[48:49], v11 offset:32
    ds_read_b64_tr_b16 v[50:51], v11 offset:7712
    s_waitcnt lgkmcnt(10)
    v_mfma_f32_16x16x32_bf16 v[76:79], v[28:31], v[52:55], 0
    v_mfma_f32_16x16x32_bf16 v[108:111], v[28:31], v[56:59], 0
    s_mul_i32 s26, s23, 6144
    s_add_u32 m0, s26, 98304
    s_add_u32 s34, s38, 2
    s_sub_u32 s27, s34, 10
    s_cmp_ge_u32 s34, 10
    s_cselect_b32 s34, s27, s34
    s_mul_i32 s34, s35, s34
    buffer_load_dwordx4 v20, s[40:43], s34 offen lds
    ds_read_b64_tr_b16 v[28:29], v12 offset:0
    ds_read_b64_tr_b16 v[30:31], v12 offset:7680
    s_waitcnt lgkmcnt(10)
    v_mfma_f32_16x16x32_bf16 v[80:83], v[32:35], v[52:55], 0
    v_mfma_f32_16x16x32_bf16 v[112:115], v[32:35], v[56:59], 0
    s_mul_i32 s26, s23, 6144
    s_add_u32 m0, s26, 99328
    s_add_u32 s34, s38, 2
    s_sub_u32 s27, s34, 10
    s_cmp_ge_u32 s34, 10
    s_cselect_b32 s34, s27, s34
    s_mul_i32 s34, s35, s34
    buffer_load_dwordx4 v21, s[40:43], s34 offen lds
    ds_read_b64_tr_b16 v[32:33], v12 offset:8
    ds_read_b64_tr_b16 v[34:35], v12 offset:7688
    s_waitcnt lgkmcnt(10)
    v_mfma_f32_16x16x32_bf16 v[84:87], v[36:39], v[52:55], 0
    v_mfma_f32_16x16x32_bf16 v[116:119], v[36:39], v[56:59], 0
    s_mul_i32 s26, s23, 6144
    s_add_u32 m0, s26, 100352
    s_add_u32 s34, s38, 2
    s_sub_u32 s27, s34, 10
    s_cmp_ge_u32 s34, 10
    s_cselect_b32 s34, s27, s34
    s_mul_i32 s34, s35, s34
    buffer_load_dwordx4 v22, s[40:43], s34 offen lds
    ds_read_b64_tr_b16 v[36:37], v12 offset:16
    ds_read_b64_tr_b16 v[38:39], v12 offset:7696
    s_waitcnt lgkmcnt(10)
    v_mfma_f32_16x16x32_bf16 v[88:91], v[40:43], v[52:55], 0
    v_mfma_f32_16x16x32_bf16 v[120:123], v[40:43], v[56:59], 0
    s_mul_i32 s26, s23, 6144
    s_add_u32 m0, s26, 101376
    s_add_u32 s34, s38, 2
    s_sub_u32 s27, s34, 10
    s_cmp_ge_u32 s34, 10
    s_cselect_b32 s34, s27, s34
    s_mul_i32 s34, s35, s34
    buffer_load_dwordx4 v23, s[40:43], s34 offen lds
    ds_read_b64_tr_b16 v[40:41], v18 offset:0
    ds_read_b64_tr_b16 v[42:43], v18 offset:7680
    s_waitcnt lgkmcnt(10)
    v_mfma_f32_16x16x32_bf16 v[140:143], v[44:47], v[60:63], 0
    s_mul_i32 s26, s23, 6144
    s_add_u32 m0, s26, 102400
    s_add_u32 s34, s38, 2
    s_sub_u32 s27, s34, 10
    s_cmp_ge_u32 s34, 10
    s_cselect_b32 s34, s27, s34
    s_mul_i32 s34, s35, s34
    buffer_load_dwordx4 v24, s[40:43], s34 offen lds
    ds_read_b128 v[64:67], v14 offset:0
    ds_read_b128 v[68:71], v14 offset:2048
    ds_read_b128 v[72:75], v16
    ds_read_b64_tr_b16 v[44:45], v11 offset:15360
    ds_read_b64_tr_b16 v[46:47], v11 offset:23040
    s_waitcnt lgkmcnt(13)
    v_mfma_f32_16x16x32_bf16 v[92:95], v[48:51], v[52:55], 0
    v_mfma_f32_16x16x32_bf16 v[124:127], v[48:51], v[56:59], 0
    s_mul_i32 s26, s23, 6144
    s_add_u32 m0, s26, 103424
    s_add_u32 s34, s38, 2
    s_sub_u32 s27, s34, 10
    s_cmp_ge_u32 s34, 10
    s_cselect_b32 s34, s27, s34
    s_mul_i32 s34, s35, s34
    buffer_load_dwordx4 v25, s[40:43], s34 offen lds
    ds_read_b64_tr_b16 v[48:49], v11 offset:15368
    ds_read_b64_tr_b16 v[50:51], v11 offset:23048
    s_waitcnt lgkmcnt(13)
    v_mfma_f32_16x16x32_bf16 v[96:99], v[28:31], v[52:55], 0
    v_mfma_f32_16x16x32_bf16 v[128:131], v[28:31], v[56:59], 0
    ds_read_b64_tr_b16 v[28:29], v11 offset:15376
    ds_read_b64_tr_b16 v[30:31], v11 offset:23056
    s_waitcnt lgkmcnt(13)
    v_mfma_f32_16x16x32_bf16 v[100:103], v[32:35], v[52:55], 0
    v_mfma_f32_16x16x32_bf16 v[132:135], v[32:35], v[56:59], 0
    ds_read_b64_tr_b16 v[32:33], v11 offset:15384
    ds_read_b64_tr_b16 v[34:35], v11 offset:23064
    s_waitcnt lgkmcnt(13)
    v_mfma_f32_16x16x32_bf16 v[104:107], v[36:39], v[52:55], 0
    v_mfma_f32_16x16x32_bf16 v[136:139], v[36:39], v[56:59], 0
    ds_read_b64_tr_b16 v[36:37], v17 offset:15360
    ds_read_b64_tr_b16 v[38:39], v17 offset:23040
    s_waitcnt lgkmcnt(13)
    v_mfma_f32_16x16x32_bf16 v[144:147], v[40:43], v[60:63], 0
    ds_read_b64_tr_b16 v[40:41], v11 offset:15392
    ds_read_b64_tr_b16 v[42:43], v11 offset:23072
    s_waitcnt lgkmcnt(10)
    v_mfma_f32_16x16x32_bf16 v[76:79], v[44:47], v[64:67], v[76:79]
    v_mfma_f32_16x16x32_bf16 v[108:111], v[44:47], v[68:71], v[108:111]
    ds_read_b64_tr_b16 v[44:45], v12 offset:15360
    ds_read_b64_tr_b16 v[46:47], v12 offset:23040
    s_waitcnt lgkmcnt(10)
    v_mfma_f32_16x16x32_bf16 v[80:83], v[48:51], v[64:67], v[80:83]
    v_mfma_f32_16x16x32_bf16 v[112:115], v[48:51], v[68:71], v[112:115]
    ds_read_b64_tr_b16 v[48:49], v12 offset:15368
    ds_read_b64_tr_b16 v[50:51], v12 offset:23048
    s_waitcnt lgkmcnt(10)
    v_mfma_f32_16x16x32_bf16 v[84:87], v[28:31], v[64:67], v[84:87]
    v_mfma_f32_16x16x32_bf16 v[116:119], v[28:31], v[68:71], v[116:119]
    ds_read_b64_tr_b16 v[28:29], v12 offset:15376
    ds_read_b64_tr_b16 v[30:31], v12 offset:23056
    s_waitcnt lgkmcnt(10)
    v_mfma_f32_16x16x32_bf16 v[88:91], v[32:35], v[64:67], v[88:91]
    v_mfma_f32_16x16x32_bf16 v[120:123], v[32:35], v[68:71], v[120:123]
    ds_read_b64_tr_b16 v[32:33], v18 offset:15360
    ds_read_b64_tr_b16 v[34:35], v18 offset:23040
    s_waitcnt lgkmcnt(10)
    v_mfma_f32_16x16x32_bf16 v[140:143], v[36:39], v[72:75], v[140:143]
    s_waitcnt lgkmcnt(8)
    v_mfma_f32_16x16x32_bf16 v[92:95], v[40:43], v[64:67], v[92:95]
    v_mfma_f32_16x16x32_bf16 v[124:127], v[40:43], v[68:71], v[124:127]
    s_waitcnt lgkmcnt(6)
    v_mfma_f32_16x16x32_bf16 v[96:99], v[44:47], v[64:67], v[96:99]
    v_mfma_f32_16x16x32_bf16 v[128:131], v[44:47], v[68:71], v[128:131]
    s_waitcnt vmcnt(6) lgkmcnt(0)
    s_barrier
    v_add_u32 v11, 49152, v11
    v_add_u32 v12, 49152, v12
    v_add_u32 v13, 49152, v13
    v_add_u32 v14, 49152, v14
    v_add_u32 v15, 49152, v15
    v_add_u32 v16, 49152, v16
    v_add_u32 v17, 49152, v17
    v_add_u32 v18, 49152, v18
    ds_read_b128 v[52:55], v13 offset:0
    ds_read_b128 v[56:59], v13 offset:2048
    ds_read_b128 v[60:63], v15
    ds_read_b64_tr_b16 v[36:37], v11 offset:0
    ds_read_b64_tr_b16 v[38:39], v11 offset:7680
    ds_read_b64_tr_b16 v[40:41], v11 offset:8
    ds_read_b64_tr_b16 v[42:43], v11 offset:7688
    ds_read_b64_tr_b16 v[44:45], v11 offset:16
    ds_read_b64_tr_b16 v[46:47], v11 offset:7696
    v_mfma_f32_16x16x32_bf16 v[100:103], v[48:51], v[64:67], v[100:103]
    v_mfma_f32_16x16x32_bf16 v[132:135], v[48:51], v[68:71], v[132:135]
    s_mul_i32 s26, s23, 6144
    s_add_u32 m0, s26, 0
    s_add_u32 s34, s38, 3
    s_sub_u32 s27, s34, 10
    s_cmp_ge_u32 s34, 10
    s_cselect_b32 s34, s27, s34
    s_mul_i32 s34, s35, s34
    buffer_load_dwordx4 v20, s[40:43], s34 offen lds
    ds_read_b64_tr_b16 v[48:49], v11 offset:24
    ds_read_b64_tr_b16 v[50:51], v11 offset:7704
    v_mfma_f32_16x16x32_bf16 v[104:107], v[28:31], v[64:67], v[104:107]
    v_mfma_f32_16x16x32_bf16 v[136:139], v[28:31], v[68:71], v[136:139]
    s_mul_i32 s26, s23, 6144
    s_add_u32 m0, s26, 1024
    s_add_u32 s34, s38, 3
    s_sub_u32 s27, s34, 10
    s_cmp_ge_u32 s34, 10
    s_cselect_b32 s34, s27, s34
    s_mul_i32 s34, s35, s34
    buffer_load_dwordx4 v21, s[40:43], s34 offen lds
    ds_read_b64_tr_b16 v[28:29], v17 offset:0
    ds_read_b64_tr_b16 v[30:31], v17 offset:7680
    v_mfma_f32_16x16x32_bf16 v[144:147], v[32:35], v[72:75], v[144:147]
    s_mul_i32 s26, s23, 6144
    s_add_u32 m0, s26, 2048
    s_add_u32 s34, s38, 3
    s_sub_u32 s27, s34, 10
    s_cmp_ge_u32 s34, 10
    s_cselect_b32 s34, s27, s34
    s_mul_i32 s34, s35, s34
    buffer_load_dwordx4 v22, s[40:43], s34 offen lds
    ds_read_b64_tr_b16 v[32:33], v11 offset:32
    ds_read_b64_tr_b16 v[34:35], v11 offset:7712
    s_waitcnt lgkmcnt(10)
    v_mfma_f32_16x16x32_bf16 v[76:79], v[36:39], v[52:55], v[76:79]
    v_mfma_f32_16x16x32_bf16 v[108:111], v[36:39], v[56:59], v[108:111]
    s_mul_i32 s26, s23, 6144
    s_add_u32 m0, s26, 3072
    s_add_u32 s34, s38, 3
    s_sub_u32 s27, s34, 10
    s_cmp_ge_u32 s34, 10
    s_cselect_b32 s34, s27, s34
    s_mul_i32 s34, s35, s34
    buffer_load_dwordx4 v23, s[40:43], s34 offen lds
    ds_read_b64_tr_b16 v[36:37], v12 offset:0
    ds_read_b64_tr_b16 v[38:39], v12 offset:7680
    s_waitcnt lgkmcnt(10)
    v_mfma_f32_16x16x32_bf16 v[80:83], v[40:43], v[52:55], v[80:83]
    v_mfma_f32_16x16x32_bf16 v[112:115], v[40:43], v[56:59], v[112:115]
    s_mul_i32 s26, s23, 6144
    s_add_u32 m0, s26, 4096
    s_add_u32 s34, s38, 3
    s_sub_u32 s27, s34, 10
    s_cmp_ge_u32 s34, 10
    s_cselect_b32 s34, s27, s34
    s_mul_i32 s34, s35, s34
    buffer_load_dwordx4 v24, s[40:43], s34 offen lds
    ds_read_b64_tr_b16 v[40:41], v12 offset:8
    ds_read_b64_tr_b16 v[42:43], v12 offset:7688
    s_waitcnt lgkmcnt(10)
    v_mfma_f32_16x16x32_bf16 v[84:87], v[44:47], v[52:55], v[84:87]
    v_mfma_f32_16x16x32_bf16 v[116:119], v[44:47], v[56:59], v[116:119]
    s_mul_i32 s26, s23, 6144
    s_add_u32 m0, s26, 5120
    s_add_u32 s34, s38, 3
    s_sub_u32 s27, s34, 10
    s_cmp_ge_u32 s34, 10
    s_cselect_b32 s34, s27, s34
    s_mul_i32 s34, s35, s34
    buffer_load_dwordx4 v25, s[40:43], s34 offen lds
    ds_read_b64_tr_b16 v[44:45], v12 offset:16
    ds_read_b64_tr_b16 v[46:47], v12 offset:7696
    s_waitcnt lgkmcnt(10)
    v_mfma_f32_16x16x32_bf16 v[88:91], v[48:51], v[52:55], v[88:91]
    v_mfma_f32_16x16x32_bf16 v[120:123], v[48:51], v[56:59], v[120:123]
    ds_read_b64_tr_b16 v[48:49], v18 offset:0
    ds_read_b64_tr_b16 v[50:51], v18 offset:7680
    s_waitcnt lgkmcnt(10)
    v_mfma_f32_16x16x32_bf16 v[140:143], v[28:31], v[60:63], v[140:143]
    ds_read_b128 v[64:67], v14 offset:0
    ds_read_b128 v[68:71], v14 offset:2048
    ds_read_b128 v[72:75], v16
    ds_read_b64_tr_b16 v[28:29], v11 offset:15360
    ds_read_b64_tr_b16 v[30:31], v11 offset:23040
    s_waitcnt lgkmcnt(13)
    v_mfma_f32_16x16x32_bf16 v[92:95], v[32:35], v[52:55], v[92:95]
    v_mfma_f32_16x16x32_bf16 v[124:127], v[32:35], v[56:59], v[124:127]
    ds_read_b64_tr_b16 v[32:33], v11 offset:15368
    ds_read_b64_tr_b16 v[34:35], v11 offset:23048
    s_waitcnt lgkmcnt(13)
    v_mfma_f32_16x16x32_bf16 v[96:99], v[36:39], v[52:55], v[96:99]
    v_mfma_f32_16x16x32_bf16 v[128:131], v[36:39], v[56:59], v[128:131]
    ds_read_b64_tr_b16 v[36:37], v11 offset:15376
    ds_read_b64_tr_b16 v[38:39], v11 offset:23056
    s_waitcnt lgkmcnt(13)
    v_mfma_f32_16x16x32_bf16 v[100:103], v[40:43], v[52:55], v[100:103]
    v_mfma_f32_16x16x32_bf16 v[132:135], v[40:43], v[56:59], v[132:135]
    ds_read_b64_tr_b16 v[40:41], v11 offset:15384
    ds_read_b64_tr_b16 v[42:43], v11 offset:23064
    s_waitcnt lgkmcnt(13)
    v_mfma_f32_16x16x32_bf16 v[104:107], v[44:47], v[52:55], v[104:107]
    v_mfma_f32_16x16x32_bf16 v[136:139], v[44:47], v[56:59], v[136:139]
    ds_read_b64_tr_b16 v[44:45], v17 offset:15360
    ds_read_b64_tr_b16 v[46:47], v17 offset:23040
    s_waitcnt lgkmcnt(13)
    v_mfma_f32_16x16x32_bf16 v[144:147], v[48:51], v[60:63], v[144:147]
    ds_read_b64_tr_b16 v[48:49], v11 offset:15392
    ds_read_b64_tr_b16 v[50:51], v11 offset:23072
    s_waitcnt lgkmcnt(10)
    v_mfma_f32_16x16x32_bf16 v[76:79], v[28:31], v[64:67], v[76:79]
    v_mfma_f32_16x16x32_bf16 v[108:111], v[28:31], v[68:71], v[108:111]
    ds_read_b64_tr_b16 v[28:29], v12 offset:15360
    ds_read_b64_tr_b16 v[30:31], v12 offset:23040
    s_waitcnt lgkmcnt(10)
    v_mfma_f32_16x16x32_bf16 v[80:83], v[32:35], v[64:67], v[80:83]
    v_mfma_f32_16x16x32_bf16 v[112:115], v[32:35], v[68:71], v[112:115]
    ds_read_b64_tr_b16 v[32:33], v12 offset:15368
    ds_read_b64_tr_b16 v[34:35], v12 offset:23048
    s_waitcnt lgkmcnt(10)
    v_mfma_f32_16x16x32_bf16 v[84:87], v[36:39], v[64:67], v[84:87]
    v_mfma_f32_16x16x32_bf16 v[116:119], v[36:39], v[68:71], v[116:119]
    ds_read_b64_tr_b16 v[36:37], v12 offset:15376
    ds_read_b64_tr_b16 v[38:39], v12 offset:23056
    s_waitcnt lgkmcnt(10)
    v_mfma_f32_16x16x32_bf16 v[88:91], v[40:43], v[64:67], v[88:91]
    v_mfma_f32_16x16x32_bf16 v[120:123], v[40:43], v[68:71], v[120:123]
    ds_read_b64_tr_b16 v[40:41], v18 offset:15360
    ds_read_b64_tr_b16 v[42:43], v18 offset:23040
    s_waitcnt lgkmcnt(10)
    v_mfma_f32_16x16x32_bf16 v[140:143], v[44:47], v[72:75], v[140:143]
    s_waitcnt lgkmcnt(8)
    v_mfma_f32_16x16x32_bf16 v[92:95], v[48:51], v[64:67], v[92:95]
    v_mfma_f32_16x16x32_bf16 v[124:127], v[48:51], v[68:71], v[124:127]
    s_waitcnt lgkmcnt(6)
    v_mfma_f32_16x16x32_bf16 v[96:99], v[28:31], v[64:67], v[96:99]
    v_mfma_f32_16x16x32_bf16 v[128:131], v[28:31], v[68:71], v[128:131]
    s_waitcnt vmcnt(6) lgkmcnt(0)
    s_barrier
    s_cmp_ge_u32 s96, 1600
    s_cbranch_scc1 K1_rsB
    s_lshl_b32 s26, s96, 10
    s_add_u32 s26, s26, 29360128
    v_lshlrev_b32 v184, 4, v1
    buffer_store_dwordx4 v[180:183], v184, s[12:15], s26 offen sc1
K1_rsB:
    v_add_u32 v11, 49152, v11
    v_add_u32 v12, 49152, v12
    v_add_u32 v13, 49152, v13
    v_add_u32 v14, 49152, v14
    v_add_u32 v15, 49152, v15
    v_add_u32 v16, 49152, v16
    v_add_u32 v17, 49152, v17
    v_add_u32 v18, 49152, v18
    ds_read_b128 v[52:55], v13 offset:0
    ds_read_b128 v[56:59], v13 offset:2048
    ds_read_b128 v[60:63], v15
    ds_read_b64_tr_b16 v[44:45], v11 offset:0
    ds_read_b64_tr_b16 v[46:47], v11 offset:7680
    ds_read_b64_tr_b16 v[48:49], v11 offset:8
    ds_read_b64_tr_b16 v[50:51], v11 offset:7688
    ds_read_b64_tr_b16 v[28:29], v11 offset:16
    ds_read_b64_tr_b16 v[30:31], v11 offset:7696
    v_mfma_f32_16x16x32_bf16 v[100:103], v[32:35], v[64:67], v[100:103]
    v_mfma_f32_16x16x32_bf16 v[132:135], v[32:35], v[68:71], v[132:135]
    s_mul_i32 s26, s23, 6144
    s_add_u32 m0, s26, 49152
    s_add_u32 s34, s38, 4
    s_sub_u32 s27, s34, 10
    s_cmp_ge_u32 s34, 10
    s_cselect_b32 s34, s27, s34
    s_mul_i32 s34, s35, s34
    buffer_load_dwordx4 v20, s[40:43], s34 offen lds
    ds_read_b64_tr_b16 v[32:33], v11 offset:24
    ds_read_b64_tr_b16 v[34:35], v11 offset:7704
    v_mfma_f32_16x16x32_bf16 v[104:107], v[36:39], v[64:67], v[104:107]
    v_mfma_f32_16x16x32_bf16 v[136:139], v[36:39], v[68:71], v[136:139]
    s_mul_i32 s26, s23, 6144
    s_add_u32 m0, s26, 50176
    s_add_u32 s34, s38, 4
    s_sub_u32 s27, s34, 10
    s_cmp_ge_u32 s34, 10
    s_cselect_b32 s34, s27, s34
    s_mul_i32 s34, s35, s34
    buffer_load_dwordx4 v21, s[40:43], s34 offen lds
    ds_read_b64_tr_b16 v[36:37], v17 offset:0
    ds_read_b64_tr_b16 v[38:39], v17 offset:7680
    v_mfma_f32_16x16x32_bf16 v[144:147], v[40:43], v[72:75], v[144:147]
    s_mul_i32 s26, s23, 6144
    s_add_u32 m0, s26, 51200
    s_add_u32 s34, s38, 4
    s_sub_u32 s27, s34, 10
    s_cmp_ge_u32 s34, 10
    s_cselect_b32 s34, s27, s34
    s_mul_i32 s34, s35, s34
    buffer_load_dwordx4 v22, s[40:43], s34 offen lds
    ds_read_b64_tr_b16 v[40:41], v11 offset:32
    ds_read_b64_tr_b16 v[42:43], v11 offset:7712
    s_waitcnt lgkmcnt(10)
    v_mfma_f32_16x16x32_bf16 v[76:79], v[44:47], v[52:55], v[76:79]
    v_mfma_f32_16x16x32_bf16 v[108:111], v[44:47], v[56:59], v[108:111]
    s_mul_i32 s26, s23, 6144
    s_add_u32 m0, s26, 52224
    s_add_u32 s34, s38, 4
    s_sub_u32 s27, s34, 10
    s_cmp_ge_u32 s34, 10
    s_cselect_b32 s34, s27, s34
    s_mul_i32 s34, s35, s34
    buffer_load_dwordx4 v23, s[40:43], s34 offen lds
    ds_read_b64_tr_b16 v[44:45], v12 offset:0
    ds_read_b64_tr_b16 v[46:47], v12 offset:7680
    s_waitcnt lgkmcnt(10)
    v_mfma_f32_16x16x32_bf16 v[80:83], v[48:51], v[52:55], v[80:83]
    v_mfma_f32_16x16x32_bf16 v[112:115], v[48:51], v[56:59], v[112:115]
    s_mul_i32 s26, s23, 6144
    s_add_u32 m0, s26, 53248
    s_add_u32 s34, s38, 4
    s_sub_u32 s27, s34, 10
    s_cmp_ge_u32 s34, 10
    s_cselect_b32 s34, s27, s34
    s_mul_i32 s34, s35, s34
    buffer_load_dwordx4 v24, s[40:43], s34 offen lds
    ds_read_b64_tr_b16 v[48:49], v12 offset:8
    ds_read_b64_tr_b16 v[50:51], v12 offset:7688
    s_waitcnt lgkmcnt(10)
    v_mfma_f32_16x16x32_bf16 v[84:87], v[28:31], v[52:55], v[84:87]
    v_mfma_f32_16x16x32_bf16 v[116:119], v[28:31], v[56:59], v[116:119]
    s_mul_i32 s26, s23, 6144
    s_add_u32 m0, s26, 54272
    s_add_u32 s34, s38, 4
    s_sub_u32 s27, s34, 10
    s_cmp_ge_u32 s34, 10
    s_cselect_b32 s34, s27, s34
    s_mul_i32 s34, s35, s34
    buffer_load_dwordx4 v25, s[40:43], s34 offen lds
    ds_read_b64_tr_b16 v[28:29], v12 offset:16
    ds_read_b64_tr_b16 v[30:31], v12 offset:7696
    s_waitcnt lgkmcnt(10)
    v_mfma_f32_16x16x32_bf16 v[88:91], v[32:35], v[52:55], v[88:91]
    v_mfma_f32_16x16x32_bf16 v[120:123], v[32:35], v[56:59], v[120:123]
    ds_read_b64_tr_b16 v[32:33], v18 offset:0
    ds_read_b64_tr_b16 v[34:35], v18 offset:7680
    s_waitcnt lgkmcnt(10)
    v_mfma_f32_16x16x32_bf16 v[140:143], v[36:39], v[60:63], v[140:143]
    ds_read_b128 v[64:67], v14 offset:0
    ds_read_b128 v[68:71], v14 offset:2048
    ds_read_b128 v[72:75], v16
    ds_read_b64_tr_b16 v[36:37], v11 offset:15360
    ds_read_b64_tr_b16 v[38:39], v11 offset:23040
    s_waitcnt lgkmcnt(13)
    v_mfma_f32_16x16x32_bf16 v[92:95], v[40:43], v[52:55], v[92:95]
    v_mfma_f32_16x16x32_bf16 v[124:127], v[40:43], v[56:59], v[124:127]
    ds_read_b64_tr_b16 v[40:41], v11 offset:15368
    ds_read_b64_tr_b16 v[42:43], v11 offset:23048
    s_waitcnt lgkmcnt(13)
    v_mfma_f32_16x16x32_bf16 v[96:99], v[44:47], v[52:55], v[96:99]
    v_mfma_f32_16x16x32_bf16 v[128:131], v[44:47], v[56:59], v[128:131]
    ds_read_b64_tr_b16 v[44:45], v11 offset:15376
    ds_read_b64_tr_b16 v[46:47], v11 offset:23056
    s_waitcnt lgkmcnt(13)
    v_mfma_f32_16x16x32_bf16 v[100:103], v[48:51], v[52:55], v[100:103]
    v_mfma_f32_16x16x32_bf16 v[132:135], v[48:51], v[56:59], v[132:135]
    ds_read_b64_tr_b16 v[48:49], v11 offset:15384
    ds_read_b64_tr_b16 v[50:51], v11 offset:23064
    s_waitcnt lgkmcnt(13)
    v_mfma_f32_16x16x32_bf16 v[104:107], v[28:31], v[52:55], v[104:107]
    v_mfma_f32_16x16x32_bf16 v[136:139], v[28:31], v[56:59], v[136:139]
    ds_read_b64_tr_b16 v[28:29], v17 offset:15360
    ds_read_b64_tr_b16 v[30:31], v17 offset:23040
    s_waitcnt lgkmcnt(13)
    v_mfma_f32_16x16x32_bf16 v[144:147], v[32:35], v[60:63], v[144:147]
    ds_read_b64_tr_b16 v[32:33], v11 offset:15392
    ds_read_b64_tr_b16 v[34:35], v11 offset:23072
    s_waitcnt lgkmcnt(10)
    v_mfma_f32_16x16x32_bf16 v[76:79], v[36:39], v[64:67], v[76:79]
    v_mfma_f32_16x16x32_bf16 v[108:111], v[36:39], v[68:71], v[108:111]
    ds_read_b64_tr_b16 v[36:37], v12 offset:15360
    ds_read_b64_tr_b16 v[38:39], v12 offset:23040
    s_waitcnt lgkmcnt(10)
    v_mfma_f32_16x16x32_bf16 v[80:83], v[40:43], v[64:67], v[80:83]
    v_mfma_f32_16x16x32_bf16 v[112:115], v[40:43], v[68:71], v[112:115]
    ds_read_b64_tr_b16 v[40:41], v12 offset:15368
    ds_read_b64_tr_b16 v[42:43], v12 offset:23048
    s_waitcnt lgkmcnt(10)
    v_mfma_f32_16x16x32_bf16 v[84:87], v[44:47], v[64:67], v[84:87]
    v_mfma_f32_16x16x32_bf16 v[116:119], v[44:47], v[68:71], v[116:119]
    ds_read_b64_tr_b16 v[44:45], v12 offset:15376
    ds_read_b64_tr_b16 v[46:47], v12 offset:23056
    s_waitcnt lgkmcnt(10)
    v_mfma_f32_16x16x32_bf16 v[88:91], v[48:51], v[64:67], v[88:91]
    v_mfma_f32_16x16x32_bf16 v[120:123], v[48:51], v[68:71], v[120:123]
    ds_read_b64_tr_b16 v[48:49], v18 offset:15360
    ds_read_b64_tr_b16 v[50:51], v18 offset:23040
    s_waitcnt lgkmcnt(10)
    v_mfma_f32_16x16x32_bf16 v[140:143], v[28:31], v[72:75], v[140:143]
    s_waitcnt lgkmcnt(8)
    v_mfma_f32_16x16x32_bf16 v[92:95], v[32:35], v[64:67], v[92:95]
    v_mfma_f32_16x16x32_bf16 v[124:127], v[32:35], v[68:71], v[124:127]
    s_waitcnt lgkmcnt(6)
    v_mfma_f32_16x16x32_bf16 v[96:99], v[36:39], v[64:67], v[96:99]
    v_mfma_f32_16x16x32_bf16 v[128:131], v[36:39], v[68:71], v[128:131]
    s_waitcnt vmcnt(6) lgkmcnt(0)
    s_barrier
    v_subrev_u32 v11, 98304, v11
    v_subrev_u32 v12, 98304, v12
    v_subrev_u32 v13, 98304, v13
    v_subrev_u32 v14, 98304, v14
    v_subrev_u32 v15, 98304, v15
    v_subrev_u32 v16, 98304, v16
    v_subrev_u32 v17, 98304, v17
    v_subrev_u32 v18, 98304, v18
    ds_read_b128 v[52:55], v13 offset:0
    ds_read_b128 v[56:59], v13 offset:2048
    ds_read_b128 v[60:63], v15
    ds_read_b64_tr_b16 v[28:29], v11 offset:0
    ds_read_b64_tr_b16 v[30:31], v11 offset:7680
    ds_read_b64_tr_b16 v[32:33], v11 offset:8
    ds_read_b64_tr_b16 v[34:35], v11 offset:7688
    ds_read_b64_tr_b16 v[36:37], v11 offset:16
    ds_read_b64_tr_b16 v[38:39], v11 offset:7696
    v_mfma_f32_16x16x32_bf16 v[100:103], v[40:43], v[64:67], v[100:103]
    v_mfma_f32_16x16x32_bf16 v[132:135], v[40:43], v[68:71], v[132:135]
    s_mul_i32 s26, s23, 6144
    s_add_u32 m0, s26, 98304
    s_add_u32 s34, s38, 5
    s_sub_u32 s27, s34, 10
    s_cmp_ge_u32 s34, 10
    s_cselect_b32 s34, s27, s34
    s_mul_i32 s34, s35, s34
    buffer_load_dwordx4 v20, s[40:43], s34 offen lds
    ds_read_b64_tr_b16 v[40:41], v11 offset:24
    ds_read_b64_tr_b16 v[42:43], v11 offset:7704
    v_mfma_f32_16x16x32_bf16 v[104:107], v[44:47], v[64:67], v[104:107]
    v_mfma_f32_16x16x32_bf16 v[136:139], v[44:47], v[68:71], v[136:139]
    s_mul_i32 s26, s23, 6144
    s_add_u32 m0, s26, 99328
    s_add_u32 s34, s38, 5
    s_sub_u32 s27, s34, 10
    s_cmp_ge_u32 s34, 10
    s_cselect_b32 s34, s27, s34
    s_mul_i32 s34, s35, s34
    buffer_load_dwordx4 v21, s[40:43], s34 offen lds
    ds_read_b64_tr_b16 v[44:45], v17 offset:0
    ds_read_b64_tr_b16 v[46:47], v17 offset:7680
    v_mfma_f32_16x16x32_bf16 v[144:147], v[48:51], v[72:75], v[144:147]
    s_mul_i32 s26, s23, 6144
    s_add_u32 m0, s26, 100352
    s_add_u32 s34, s38, 5
    s_sub_u32 s27, s34, 10
    s_cmp_ge_u32 s34, 10
    s_cselect_b32 s34, s27, s34
    s_mul_i32 s34, s35, s34
    buffer_load_dwordx4 v22, s[40:43], s34 offen lds
    ds_read_b64_tr_b16 v[48:49], v11 offset:32
    ds_read_b64_tr_b16 v[50:51], v11 offset:7712
    s_waitcnt lgkmcnt(10)
    v_mfma_f32_16x16x32_bf16 v[76:79], v[28:31], v[52:55], v[76:79]
    v_mfma_f32_16x16x32_bf16 v[108:111], v[28:31], v[56:59], v[108:111]
    s_mul_i32 s26, s23, 6144
    s_add_u32 m0, s26, 101376
    s_add_u32 s34, s38, 5
    s_sub_u32 s27, s34, 10
    s_cmp_ge_u32 s34, 10
    s_cselect_b32 s34, s27, s34
    s_mul_i32 s34, s35, s34
    buffer_load_dwordx4 v23, s[40:43], s34 offen lds
    ds_read_b64_tr_b16 v[28:29], v12 offset:0
    ds_read_b64_tr_b16 v[30:31], v12 offset:7680
    s_waitcnt lgkmcnt(10)
    v_mfma_f32_16x16x32_bf16 v[80:83], v[32:35], v[52:55], v[80:83]
    v_mfma_f32_16x16x32_bf16 v[112:115], v[32:35], v[56:59], v[112:115]
    s_mul_i32 s26, s23, 6144
    s_add_u32 m0, s26, 102400
    s_add_u32 s34, s38, 5
    s_sub_u32 s27, s34, 10
    s_cmp_ge_u32 s34, 10
    s_cselect_b32 s34, s27, s34
    s_mul_i32 s34, s35, s34
    buffer_load_dwordx4 v24, s[40:43], s34 offen lds
    ds_read_b64_tr_b16 v[32:33], v12 offset:8
    ds_read_b64_tr_b16 v[34:35], v12 offset:7688
    s_waitcnt lgkmcnt(10)
    v_mfma_f32_16x16x32_bf16 v[84:87], v[36:39], v[52:55], v[84:87]
    v_mfma_f32_16x16x32_bf16 v[116:119], v[36:39], v[56:59], v[116:119]
    s_mul_i32 s26, s23, 6144
    s_add_u32 m0, s26, 103424
    s_add_u32 s34, s38, 5
    s_sub_u32 s27, s34, 10
    s_cmp_ge_u32 s34, 10
    s_cselect_b32 s34, s27, s34
    s_mul_i32 s34, s35, s34
    buffer_load_dwordx4 v25, s[40:43], s34 offen lds
    ds_read_b64_tr_b16 v[36:37], v12 offset:16
    ds_read_b64_tr_b16 v[38:39], v12 offset:7696
    s_waitcnt lgkmcnt(10)
    v_mfma_f32_16x16x32_bf16 v[88:91], v[40:43], v[52:55], v[88:91]
    v_mfma_f32_16x16x32_bf16 v[120:123], v[40:43], v[56:59], v[120:123]
    ds_read_b64_tr_b16 v[40:41], v18 offset:0
    ds_read_b64_tr_b16 v[42:43], v18 offset:7680
    s_waitcnt lgkmcnt(10)
    v_mfma_f32_16x16x32_bf16 v[140:143], v[44:47], v[60:63], v[140:143]
    ds_read_b128 v[64:67], v14 offset:0
    ds_read_b128 v[68:71], v14 offset:2048
    ds_read_b128 v[72:75], v16
    ds_read_b64_tr_b16 v[44:45], v11 offset:15360
    ds_read_b64_tr_b16 v[46:47], v11 offset:23040
    s_waitcnt lgkmcnt(13)
    v_mfma_f32_16x16x32_bf16 v[92:95], v[48:51], v[52:55], v[92:95]
    v_mfma_f32_16x16x32_bf16 v[124:127], v[48:51], v[56:59], v[124:127]
    ds_read_b64_tr_b16 v[48:49], v11 offset:15368
    ds_read_b64_tr_b16 v[50:51], v11 offset:23048
    s_waitcnt lgkmcnt(13)
    v_mfma_f32_16x16x32_bf16 v[96:99], v[28:31], v[52:55], v[96:99]
    v_mfma_f32_16x16x32_bf16 v[128:131], v[28:31], v[56:59], v[128:131]
    ds_read_b64_tr_b16 v[28:29], v11 offset:15376
    ds_read_b64_tr_b16 v[30:31], v11 offset:23056
    s_waitcnt lgkmcnt(13)
    v_mfma_f32_16x16x32_bf16 v[100:103], v[32:35], v[52:55], v[100:103]
    v_mfma_f32_16x16x32_bf16 v[132:135], v[32:35], v[56:59], v[132:135]
    ds_read_b64_tr_b16 v[32:33], v11 offset:15384
    ds_read_b64_tr_b16 v[34:35], v11 offset:23064
    s_waitcnt lgkmcnt(13)
    v_mfma_f32_16x16x32_bf16 v[104:107], v[36:39], v[52:55], v[104:107]
    v_mfma_f32_16x16x32_bf16 v[136:139], v[36:39], v[56:59], v[136:139]
    ds_read_b64_tr_b16 v[36:37], v17 offset:15360
    ds_read_b64_tr_b16 v[38:39], v17 offset:23040
    s_waitcnt lgkmcnt(13)
    v_mfma_f32_16x16x32_bf16 v[144:147], v[40:43], v[60:63], v[144:147]
    ds_read_b64_tr_b16 v[40:41], v11 offset:15392
    ds_read_b64_tr_b16 v[42:43], v11 offset:23072
    s_waitcnt lgkmcnt(10)
    v_mfma_f32_16x16x32_bf16 v[76:79], v[44:47], v[64:67], v[76:79]
    v_mfma_f32_16x16x32_bf16 v[108:111], v[44:47], v[68:71], v[108:111]
    ds_read_b64_tr_b16 v[44:45], v12 offset:15360
    ds_read_b64_tr_b16 v[46:47], v12 offset:23040
    s_waitcnt lgkmcnt(10)
    v_mfma_f32_16x16x32_bf16 v[80:83], v[48:51], v[64:67], v[80:83]
    v_mfma_f32_16x16x32_bf16 v[112:115], v[48:51], v[68:71], v[112:115]
    ds_read_b64_tr_b16 v[48:49], v12 offset:15368
    ds_read_b64_tr_b16 v[50:51], v12 offset:23048
    s_waitcnt lgkmcnt(10)
    v_mfma_f32_16x16x32_bf16 v[84:87], v[28:31], v[64:67], v[84:87]
    v_mfma_f32_16x16x32_bf16 v[116:119], v[28:31], v[68:71], v[116:119]
    ds_read_b64_tr_b16 v[28:29], v12 offset:15376
    ds_read_b64_tr_b16 v[30:31], v12 offset:23056
    s_waitcnt lgkmcnt(10)
    v_mfma_f32_16x16x32_bf16 v[88:91], v[32:35], v[64:67], v[88:91]
    v_mfma_f32_16x16x32_bf16 v[120:123], v[32:35], v[68:71], v[120:123]
    ds_read_b64_tr_b16 v[32:33], v18 offset:15360
    ds_read_b64_tr_b16 v[34:35], v18 offset:23040
    s_waitcnt lgkmcnt(10)
    v_mfma_f32_16x16x32_bf16 v[140:143], v[36:39], v[72:75], v[140:143]
    s_waitcnt lgkmcnt(8)
    v_mfma_f32_16x16x32_bf16 v[92:95], v[40:43], v[64:67], v[92:95]
    v_mfma_f32_16x16x32_bf16 v[124:127], v[40:43], v[68:71], v[124:127]
    s_waitcnt lgkmcnt(6)
    v_mfma_f32_16x16x32_bf16 v[96:99], v[44:47], v[64:67], v[96:99]
    v_mfma_f32_16x16x32_bf16 v[128:131], v[44:47], v[68:71], v[128:131]
    s_waitcnt vmcnt(6) lgkmcnt(0)
    s_barrier
    s_cmp_lg_u32 s23, 7
    s_cbranch_scc1 K1_stB
    s_load_dwordx2 s[44:45], s[0:1], 72
    s_waitcnt lgkmcnt(0)
    s_mov_b32 s48, s44
    s_and_b32 s49, s45, 0xffff
    s_mov_b32 s50, 256
    s_mov_b32 s51, 0x00020000
    v_mov_b32 v2, 0
    v_mov_b32 v3, 1
    s_mov_b64 exec, 1
    buffer_atomic_add v3, v2, s[48:51], 0 offen sc1
    s_mov_b64 exec, -1
K1_stB:
    v_add_u32 v11, 49152, v11
    v_add_u32 v12, 49152, v12
    v_add_u32 v13, 49152, v13
    v_add_u32 v14, 49152, v14
    v_add_u32 v15, 49152, v15
    v_add_u32 v16, 49152, v16
    v_add_u32 v17, 49152, v17
    v_add_u32 v18, 49152, v18
    ds_read_b128 v[52:55], v13 offset:0
    ds_read_b128 v[56:59], v13 offset:2048
    ds_read_b128 v[60:63], v15
    ds_read_b64_tr_b16 v[36:37], v11 offset:0
    ds_read_b64_tr_b16 v[38:39], v11 offset:7680
    ds_read_b64_tr_b16 v[40:41], v11 offset:8
    ds_read_b64_tr_b16 v[42:43], v11 offset:7688
    ds_read_b64_tr_b16 v[44:45], v11 offset:16
    ds_read_b64_tr_b16 v[46:47], v11 offset:7696
    v_mfma_f32_16x16x32_bf16 v[100:103], v[48:51], v[64:67], v[100:103]
    v_mfma_f32_16x16x32_bf16 v[132:135], v[48:51], v[68:71], v[132:135]
    s_mul_i32 s26, s23, 6144
    s_add_u32 m0, s26, 0
    s_add_u32 s34, s38, 6
    s_sub_u32 s27, s34, 10
    s_cmp_ge_u32 s34, 10
    s_cselect_b32 s34, s27, s34
    s_mul_i32 s34, s35, s34
    buffer_load_dwordx4 v20, s[40:43], s34 offen lds
    ds_read_b64_tr_b16 v[48:49], v11 offset:24
    ds_read_b64_tr_b16 v[50:51], v11 offset:7704
    v_mfma_f32_16x16x32_bf16 v[104:107], v[28:31], v[64:67], v[104:107]
    v_mfma_f32_16x16x32_bf16 v[136:139], v[28:31], v[68:71], v[136:139]
    s_mul_i32 s26, s23, 6144
    s_add_u32 m0, s26, 1024
    s_add_u32 s34, s38, 6
    s_sub_u32 s27, s34, 10
    s_cmp_ge_u32 s34, 10
    s_cselect_b32 s34, s27, s34
    s_mul_i32 s34, s35, s34
    buffer_load_dwordx4 v21, s[40:43], s34 offen lds
    ds_read_b64_tr_b16 v[28:29], v17 offset:0
    ds_read_b64_tr_b16 v[30:31], v17 offset:7680
    v_mfma_f32_16x16x32_bf16 v[144:147], v[32:35], v[72:75], v[144:147]
    s_mul_i32 s26, s23, 6144
    s_add_u32 m0, s26, 2048
    s_add_u32 s34, s38, 6
    s_sub_u32 s27, s34, 10
    s_cmp_ge_u32 s34, 10
    s_cselect_b32 s34, s27, s34
    s_mul_i32 s34, s35, s34
    buffer_load_dwordx4 v22, s[40:43], s34 offen lds
    ds_read_b64_tr_b16 v[32:33], v11 offset:32
    ds_read_b64_tr_b16 v[34:35], v11 offset:7712
    s_waitcnt lgkmcnt(10)
    v_mfma_f32_16x16x32_bf16 v[76:79], v[36:39], v[52:55], v[76:79]
    v_mfma_f32_16x16x32_bf16 v[108:111], v[36:39], v[56:59], v[108:111]
    s_mul_i32 s26, s23, 6144
    s_add_u32 m0, s26, 3072
    s_add_u32 s34, s38, 6
    s_sub_u32 s27, s34, 10
    s_cmp_ge_u32 s34, 10
    s_cselect_b32 s34, s27, s34
    s_mul_i32 s34, s35, s34
    buffer_load_dwordx4 v23, s[40:43], s34 offen lds
    ds_read_b64_tr_b16 v[36:37], v12 offset:0
    ds_read_b64_tr_b16 v[38:39], v12 offset:7680
    s_waitcnt lgkmcnt(10)
    v_mfma_f32_16x16x32_bf16 v[80:83], v[40:43], v[52:55], v[80:83]
    v_mfma_f32_16x16x32_bf16 v[112:115], v[40:43], v[56:59], v[112:115]
    s_mul_i32 s26, s23, 6144
    s_add_u32 m0, s26, 4096
    s_add_u32 s34, s38, 6
    s_sub_u32 s27, s34, 10
    s_cmp_ge_u32 s34, 10
    s_cselect_b32 s34, s27, s34
    s_mul_i32 s34, s35, s34
    buffer_load_dwordx4 v24, s[40:43], s34 offen lds
    ds_read_b64_tr_b16 v[40:41], v12 offset:8
    ds_read_b64_tr_b16 v[42:43], v12 offset:7688
    s_waitcnt lgkmcnt(10)
    v_mfma_f32_16x16x32_bf16 v[84:87], v[44:47], v[52:55], v[84:87]
    v_mfma_f32_16x16x32_bf16 v[116:119], v[44:47], v[56:59], v[116:119]
    s_mul_i32 s26, s23, 6144
    s_add_u32 m0, s26, 5120
    s_add_u32 s34, s38, 6
    s_sub_u32 s27, s34, 10
    s_cmp_ge_u32 s34, 10
    s_cselect_b32 s34, s27, s34
    s_mul_i32 s34, s35, s34
    buffer_load_dwordx4 v25, s[40:43], s34 offen lds
    ds_read_b64_tr_b16 v[44:45], v12 offset:16
    ds_read_b64_tr_b16 v[46:47], v12 offset:7696
    s_waitcnt lgkmcnt(10)
    v_mfma_f32_16x16x32_bf16 v[88:91], v[48:51], v[52:55], v[88:91]
    v_mfma_f32_16x16x32_bf16 v[120:123], v[48:51], v[56:59], v[120:123]
    ds_read_b64_tr_b16 v[48:49], v18 offset:0
    ds_read_b64_tr_b16 v[50:51], v18 offset:7680
    s_waitcnt lgkmcnt(10)
    v_mfma_f32_16x16x32_bf16 v[140:143], v[28:31], v[60:63], v[140:143]
    ds_read_b128 v[64:67], v14 offset:0
    ds_read_b128 v[68:71], v14 offset:2048
    ds_read_b128 v[72:75], v16
    ds_read_b64_tr_b16 v[28:29], v11 offset:15360
    ds_read_b64_tr_b16 v[30:31], v11 offset:23040
    s_waitcnt lgkmcnt(13)
    v_mfma_f32_16x16x32_bf16 v[92:95], v[32:35], v[52:55], v[92:95]
    v_mfma_f32_16x16x32_bf16 v[124:127], v[32:35], v[56:59], v[124:127]
    ds_read_b64_tr_b16 v[32:33], v11 offset:15368
    ds_read_b64_tr_b16 v[34:35], v11 offset:23048
    s_waitcnt lgkmcnt(13)
    v_mfma_f32_16x16x32_bf16 v[96:99], v[36:39], v[52:55], v[96:99]
    v_mfma_f32_16x16x32_bf16 v[128:131], v[36:39], v[56:59], v[128:131]
    ds_read_b64_tr_b16 v[36:37], v11 offset:15376
    ds_read_b64_tr_b16 v[38:39], v11 offset:23056
    s_waitcnt lgkmcnt(13)
    v_mfma_f32_16x16x32_bf16 v[100:103], v[40:43], v[52:55], v[100:103]
    v_mfma_f32_16x16x32_bf16 v[132:135], v[40:43], v[56:59], v[132:135]
    ds_read_b64_tr_b16 v[40:41], v11 offset:15384
    ds_read_b64_tr_b16 v[42:43], v11 offset:23064
    s_waitcnt lgkmcnt(13)
    v_mfma_f32_16x16x32_bf16 v[104:107], v[44:47], v[52:55], v[104:107]
    v_mfma_f32_16x16x32_bf16 v[136:139], v[44:47], v[56:59], v[136:139]
    ds_read_b64_tr_b16 v[44:45], v17 offset:15360
    ds_read_b64_tr_b16 v[46:47], v17 offset:23040
    s_waitcnt lgkmcnt(13)
    v_mfma_f32_16x16x32_bf16 v[144:147], v[48:51], v[60:63], v[144:147]
    ds_read_b64_tr_b16 v[48:49], v11 offset:15392
    ds_read_b64_tr_b16 v[50:51], v11 offset:23072
    s_waitcnt lgkmcnt(10)
    v_mfma_f32_16x16x32_bf16 v[76:79], v[28:31], v[64:67], v[76:79]
    v_mfma_f32_16x16x32_bf16 v[108:111], v[28:31], v[68:71], v[108:111]
    ds_read_b64_tr_b16 v[28:29], v12 offset:15360
    ds_read_b64_tr_b16 v[30:31], v12 offset:23040
    s_waitcnt lgkmcnt(10)
    v_mfma_f32_16x16x32_bf16 v[80:83], v[32:35], v[64:67], v[80:83]
    v_mfma_f32_16x16x32_bf16 v[112:115], v[32:35], v[68:71], v[112:115]
    ds_read_b64_tr_b16 v[32:33], v12 offset:15368
    ds_read_b64_tr_b16 v[34:35], v12 offset:23048
    s_waitcnt lgkmcnt(10)
    v_mfma_f32_16x16x32_bf16 v[84:87], v[36:39], v[64:67], v[84:87]
    v_mfma_f32_16x16x32_bf16 v[116:119], v[36:39], v[68:71], v[116:119]
    ds_read_b64_tr_b16 v[36:37], v12 offset:15376
    ds_read_b64_tr_b16 v[38:39], v12 offset:23056
    s_waitcnt lgkmcnt(10)
    v_mfma_f32_16x16x32_bf16 v[88:91], v[40:43], v[64:67], v[88:91]
    v_mfma_f32_16x16x32_bf16 v[120:123], v[40:43], v[68:71], v[120:123]
    ds_read_b64_tr_b16 v[40:41], v18 offset:15360
    ds_read_b64_tr_b16 v[42:43], v18 offset:23040
    s_waitcnt lgkmcnt(10)
    v_mfma_f32_16x16x32_bf16 v[140:143], v[44:47], v[72:75], v[140:143]
    s_waitcnt lgkmcnt(8)
    v_mfma_f32_16x16x32_bf16 v[92:95], v[48:51], v[64:67], v[92:95]
    v_mfma_f32_16x16x32_bf16 v[124:127], v[48:51], v[68:71], v[124:127]
    s_waitcnt lgkmcnt(6)
    v_mfma_f32_16x16x32_bf16 v[96:99], v[28:31], v[64:67], v[96:99]
    v_mfma_f32_16x16x32_bf16 v[128:131], v[28:31], v[68:71], v[128:131]
    s_waitcnt vmcnt(6) lgkmcnt(0)
    s_barrier
    v_add_u32 v11, 49152, v11
    v_add_u32 v12, 49152, v12
    v_add_u32 v13, 49152, v13
    v_add_u32 v14, 49152, v14
    v_add_u32 v15, 49152, v15
    v_add_u32 v16, 49152, v16
    v_add_u32 v17, 49152, v17
    v_add_u32 v18, 49152, v18
    ds_read_b128 v[52:55], v13 offset:0
    ds_read_b128 v[56:59], v13 offset:2048
    ds_read_b128 v[60:63], v15
    ds_read_b64_tr_b16 v[44:45], v11 offset:0
    ds_read_b64_tr_b16 v[46:47], v11 offset:7680
    ds_read_b64_tr_b16 v[48:49], v11 offset:8
    ds_read_b64_tr_b16 v[50:51], v11 offset:7688
    ds_read_b64_tr_b16 v[28:29], v11 offset:16
    ds_read_b64_tr_b16 v[30:31], v11 offset:7696
    v_mfma_f32_16x16x32_bf16 v[100:103], v[32:35], v[64:67], v[100:103]
    v_mfma_f32_16x16x32_bf16 v[132:135], v[32:35], v[68:71], v[132:135]
    s_mul_i32 s26, s23, 6144
    s_add_u32 m0, s26, 49152
    s_add_u32 s34, s38, 7
    s_sub_u32 s27, s34, 10
    s_cmp_ge_u32 s34, 10
    s_cselect_b32 s34, s27, s34
    s_mul_i32 s34, s35, s34
    buffer_load_dwordx4 v20, s[40:43], s34 offen lds
    ds_read_b64_tr_b16 v[32:33], v11 offset:24
    ds_read_b64_tr_b16 v[34:35], v11 offset:7704
    v_mfma_f32_16x16x32_bf16 v[104:107], v[36:39], v[64:67], v[104:107]
    v_mfma_f32_16x16x32_bf16 v[136:139], v[36:39], v[68:71], v[136:139]
    s_mul_i32 s26, s23, 6144
    s_add_u32 m0, s26, 50176
    s_add_u32 s34, s38, 7
    s_sub_u32 s27, s34, 10
    s_cmp_ge_u32 s34, 10
    s_cselect_b32 s34, s27, s34
    s_mul_i32 s34, s35, s34
    buffer_load_dwordx4 v21, s[40:43], s34 offen lds
    ds_read_b64_tr_b16 v[36:37], v17 offset:0
    ds_read_b64_tr_b16 v[38:39], v17 offset:7680
    v_mfma_f32_16x16x32_bf16 v[144:147], v[40:43], v[72:75], v[144:147]
    s_mul_i32 s26, s23, 6144
    s_add_u32 m0, s26, 51200
    s_add_u32 s34, s38, 7
    s_sub_u32 s27, s34, 10
    s_cmp_ge_u32 s34, 10
    s_cselect_b32 s34, s27, s34
    s_mul_i32 s34, s35, s34
    buffer_load_dwordx4 v22, s[40:43], s34 offen lds
    ds_read_b64_tr_b16 v[40:41], v11 offset:32
    ds_read_b64_tr_b16 v[42:43], v11 offset:7712
    s_waitcnt lgkmcnt(10)
    v_mfma_f32_16x16x32_bf16 v[76:79], v[44:47], v[52:55], v[76:79]
    v_mfma_f32_16x16x32_bf16 v[108:111], v[44:47], v[56:59], v[108:111]
    s_mul_i32 s26, s23, 6144
    s_add_u32 m0, s26, 52224
    s_add_u32 s34, s38, 7
    s_sub_u32 s27, s34, 10
    s_cmp_ge_u32 s34, 10
    s_cselect_b32 s34, s27, s34
    s_mul_i32 s34, s35, s34
    buffer_load_dwordx4 v23, s[40:43], s34 offen lds
    ds_read_b64_tr_b16 v[44:45], v12 offset:0
    ds_read_b64_tr_b16 v[46:47], v12 offset:7680
    s_waitcnt lgkmcnt(10)
    v_mfma_f32_16x16x32_bf16 v[80:83], v[48:51], v[52:55], v[80:83]
    v_mfma_f32_16x16x32_bf16 v[112:115], v[48:51], v[56:59], v[112:115]
    s_mul_i32 s26, s23, 6144
    s_add_u32 m0, s26, 53248
    s_add_u32 s34, s38, 7
    s_sub_u32 s27, s34, 10
    s_cmp_ge_u32 s34, 10
    s_cselect_b32 s34, s27, s34
    s_mul_i32 s34, s35, s34
    buffer_load_dwordx4 v24, s[40:43], s34 offen lds
    ds_read_b64_tr_b16 v[48:49], v12 offset:8
    ds_read_b64_tr_b16 v[50:51], v12 offset:7688
    s_waitcnt lgkmcnt(10)
    v_mfma_f32_16x16x32_bf16 v[84:87], v[28:31], v[52:55], v[84:87]
    v_mfma_f32_16x16x32_bf16 v[116:119], v[28:31], v[56:59], v[116:119]
    s_mul_i32 s26, s23, 6144
    s_add_u32 m0, s26, 54272
    s_add_u32 s34, s38, 7
    s_sub_u32 s27, s34, 10
    s_cmp_ge_u32 s34, 10
    s_cselect_b32 s34, s27, s34
    s_mul_i32 s34, s35, s34
    buffer_load_dwordx4 v25, s[40:43], s34 offen lds
    ds_read_b64_tr_b16 v[28:29], v12 offset:16
    ds_read_b64_tr_b16 v[30:31], v12 offset:7696
    s_waitcnt lgkmcnt(10)
    v_mfma_f32_16x16x32_bf16 v[88:91], v[32:35], v[52:55], v[88:91]
    v_mfma_f32_16x16x32_bf16 v[120:123], v[32:35], v[56:59], v[120:123]
    ds_read_b64_tr_b16 v[32:33], v18 offset:0
    ds_read_b64_tr_b16 v[34:35], v18 offset:7680
    s_waitcnt lgkmcnt(10)
    v_mfma_f32_16x16x32_bf16 v[140:143], v[36:39], v[60:63], v[140:143]
    ds_read_b128 v[64:67], v14 offset:0
    ds_read_b128 v[68:71], v14 offset:2048
    ds_read_b128 v[72:75], v16
    ds_read_b64_tr_b16 v[36:37], v11 offset:15360
    ds_read_b64_tr_b16 v[38:39], v11 offset:23040
    s_waitcnt lgkmcnt(13)
    v_mfma_f32_16x16x32_bf16 v[92:95], v[40:43], v[52:55], v[92:95]
    v_mfma_f32_16x16x32_bf16 v[124:127], v[40:43], v[56:59], v[124:127]
    ds_read_b64_tr_b16 v[40:41], v11 offset:15368
    ds_read_b64_tr_b16 v[42:43], v11 offset:23048
    s_waitcnt lgkmcnt(13)
    v_mfma_f32_16x16x32_bf16 v[96:99], v[44:47], v[52:55], v[96:99]
    v_mfma_f32_16x16x32_bf16 v[128:131], v[44:47], v[56:59], v[128:131]
    ds_read_b64_tr_b16 v[44:45], v11 offset:15376
    ds_read_b64_tr_b16 v[46:47], v11 offset:23056
    s_waitcnt lgkmcnt(13)
    v_mfma_f32_16x16x32_bf16 v[100:103], v[48:51], v[52:55], v[100:103]
    v_mfma_f32_16x16x32_bf16 v[132:135], v[48:51], v[56:59], v[132:135]
    ds_read_b64_tr_b16 v[48:49], v11 offset:15384
    ds_read_b64_tr_b16 v[50:51], v11 offset:23064
    s_waitcnt lgkmcnt(13)
    v_mfma_f32_16x16x32_bf16 v[104:107], v[28:31], v[52:55], v[104:107]
    v_mfma_f32_16x16x32_bf16 v[136:139], v[28:31], v[56:59], v[136:139]
    ds_read_b64_tr_b16 v[28:29], v17 offset:15360
    ds_read_b64_tr_b16 v[30:31], v17 offset:23040
    s_waitcnt lgkmcnt(13)
    v_mfma_f32_16x16x32_bf16 v[144:147], v[32:35], v[60:63], v[144:147]
    ds_read_b64_tr_b16 v[32:33], v11 offset:15392
    ds_read_b64_tr_b16 v[34:35], v11 offset:23072
    s_waitcnt lgkmcnt(10)
    v_mfma_f32_16x16x32_bf16 v[76:79], v[36:39], v[64:67], v[76:79]
    v_mfma_f32_16x16x32_bf16 v[108:111], v[36:39], v[68:71], v[108:111]
    ds_read_b64_tr_b16 v[36:37], v12 offset:15360
    ds_read_b64_tr_b16 v[38:39], v12 offset:23040
    s_waitcnt lgkmcnt(10)
    v_mfma_f32_16x16x32_bf16 v[80:83], v[40:43], v[64:67], v[80:83]
    v_mfma_f32_16x16x32_bf16 v[112:115], v[40:43], v[68:71], v[112:115]
    ds_read_b64_tr_b16 v[40:41], v12 offset:15368
    ds_read_b64_tr_b16 v[42:43], v12 offset:23048
    s_waitcnt lgkmcnt(10)
    v_mfma_f32_16x16x32_bf16 v[84:87], v[44:47], v[64:67], v[84:87]
    v_mfma_f32_16x16x32_bf16 v[116:119], v[44:47], v[68:71], v[116:119]
    ds_read_b64_tr_b16 v[44:45], v12 offset:15376
    ds_read_b64_tr_b16 v[46:47], v12 offset:23056
    s_waitcnt lgkmcnt(10)
    v_mfma_f32_16x16x32_bf16 v[88:91], v[48:51], v[64:67], v[88:91]
    v_mfma_f32_16x16x32_bf16 v[120:123], v[48:51], v[68:71], v[120:123]
    ds_read_b64_tr_b16 v[48:49], v18 offset:15360
    ds_read_b64_tr_b16 v[50:51], v18 offset:23040
    s_waitcnt lgkmcnt(10)
    v_mfma_f32_16x16x32_bf16 v[140:143], v[28:31], v[72:75], v[140:143]
    s_waitcnt lgkmcnt(8)
    v_mfma_f32_16x16x32_bf16 v[92:95], v[32:35], v[64:67], v[92:95]
    v_mfma_f32_16x16x32_bf16 v[124:127], v[32:35], v[68:71], v[124:127]
    s_waitcnt lgkmcnt(6)
    v_mfma_f32_16x16x32_bf16 v[96:99], v[36:39], v[64:67], v[96:99]
    v_mfma_f32_16x16x32_bf16 v[128:131], v[36:39], v[68:71], v[128:131]
    s_waitcnt vmcnt(6) lgkmcnt(0)
    s_barrier
    v_subrev_u32 v11, 98304, v11
    v_subrev_u32 v12, 98304, v12
    v_subrev_u32 v13, 98304, v13
    v_subrev_u32 v14, 98304, v14
    v_subrev_u32 v15, 98304, v15
    v_subrev_u32 v16, 98304, v16
    v_subrev_u32 v17, 98304, v17
    v_subrev_u32 v18, 98304, v18
    ds_read_b128 v[52:55], v13 offset:0
    ds_read_b128 v[56:59], v13 offset:2048
    ds_read_b128 v[60:63], v15
    ds_read_b64_tr_b16 v[28:29], v11 offset:0
    ds_read_b64_tr_b16 v[30:31], v11 offset:7680
    ds_read_b64_tr_b16 v[32:33], v11 offset:8
    ds_read_b64_tr_b16 v[34:35], v11 offset:7688
    ds_read_b64_tr_b16 v[36:37], v11 offset:16
    ds_read_b64_tr_b16 v[38:39], v11 offset:7696
    v_mfma_f32_16x16x32_bf16 v[100:103], v[40:43], v[64:67], v[100:103]
    v_mfma_f32_16x16x32_bf16 v[132:135], v[40:43], v[68:71], v[132:135]
    s_mul_i32 s26, s23, 6144
    s_add_u32 m0, s26, 98304
    s_add_u32 s34, s38, 8
    s_sub_u32 s27, s34, 10
    s_cmp_ge_u32 s34, 10
    s_cselect_b32 s34, s27, s34
    s_mul_i32 s34, s35, s34
    buffer_load_dwordx4 v20, s[40:43], s34 offen lds
    ds_read_b64_tr_b16 v[40:41], v11 offset:24
    ds_read_b64_tr_b16 v[42:43], v11 offset:7704
    v_mfma_f32_16x16x32_bf16 v[104:107], v[44:47], v[64:67], v[104:107]
    v_mfma_f32_16x16x32_bf16 v[136:139], v[44:47], v[68:71], v[136:139]
    s_mul_i32 s26, s23, 6144
    s_add_u32 m0, s26, 99328
    s_add_u32 s34, s38, 8
    s_sub_u32 s27, s34, 10
    s_cmp_ge_u32 s34, 10
    s_cselect_b32 s34, s27, s34
    s_mul_i32 s34, s35, s34
    buffer_load_dwordx4 v21, s[40:43], s34 offen lds
    ds_read_b64_tr_b16 v[44:45], v17 offset:0
    ds_read_b64_tr_b16 v[46:47], v17 offset:7680
    v_mfma_f32_16x16x32_bf16 v[144:147], v[48:51], v[72:75], v[144:147]
    s_mul_i32 s26, s23, 6144
    s_add_u32 m0, s26, 100352
    s_add_u32 s34, s38, 8
    s_sub_u32 s27, s34, 10
    s_cmp_ge_u32 s34, 10
    s_cselect_b32 s34, s27, s34
    s_mul_i32 s34, s35, s34
    buffer_load_dwordx4 v22, s[40:43], s34 offen lds
    ds_read_b64_tr_b16 v[48:49], v11 offset:32
    ds_read_b64_tr_b16 v[50:51], v11 offset:7712
    s_waitcnt lgkmcnt(10)
    v_mfma_f32_16x16x32_bf16 v[76:79], v[28:31], v[52:55], v[76:79]
    v_mfma_f32_16x16x32_bf16 v[108:111], v[28:31], v[56:59], v[108:111]
    s_mul_i32 s26, s23, 6144
    s_add_u32 m0, s26, 101376
    s_add_u32 s34, s38, 8
    s_sub_u32 s27, s34, 10
    s_cmp_ge_u32 s34, 10
    s_cselect_b32 s34, s27, s34
    s_mul_i32 s34, s35, s34
    buffer_load_dwordx4 v23, s[40:43], s34 offen lds
    ds_read_b64_tr_b16 v[28:29], v12 offset:0
    ds_read_b64_tr_b16 v[30:31], v12 offset:7680
    s_waitcnt lgkmcnt(10)
    v_mfma_f32_16x16x32_bf16 v[80:83], v[32:35], v[52:55], v[80:83]
    v_mfma_f32_16x16x32_bf16 v[112:115], v[32:35], v[56:59], v[112:115]
    s_mul_i32 s26, s23, 6144
    s_add_u32 m0, s26, 102400
    s_add_u32 s34, s38, 8
    s_sub_u32 s27, s34, 10
    s_cmp_ge_u32 s34, 10
    s_cselect_b32 s34, s27, s34
    s_mul_i32 s34, s35, s34
    buffer_load_dwordx4 v24, s[40:43], s34 offen lds
    ds_read_b64_tr_b16 v[32:33], v12 offset:8
    ds_read_b64_tr_b16 v[34:35], v12 offset:7688
    s_waitcnt lgkmcnt(10)
    v_mfma_f32_16x16x32_bf16 v[84:87], v[36:39], v[52:55], v[84:87]
    v_mfma_f32_16x16x32_bf16 v[116:119], v[36:39], v[56:59], v[116:119]
    s_mul_i32 s26, s23, 6144
    s_add_u32 m0, s26, 103424
    s_add_u32 s34, s38, 8
    s_sub_u32 s27, s34, 10
    s_cmp_ge_u32 s34, 10
    s_cselect_b32 s34, s27, s34
    s_mul_i32 s34, s35, s34
    buffer_load_dwordx4 v25, s[40:43], s34 offen lds
    ds_read_b64_tr_b16 v[36:37], v12 offset:16
    ds_read_b64_tr_b16 v[38:39], v12 offset:7696
    s_waitcnt lgkmcnt(10)
    v_mfma_f32_16x16x32_bf16 v[88:91], v[40:43], v[52:55], v[88:91]
    v_mfma_f32_16x16x32_bf16 v[120:123], v[40:43], v[56:59], v[120:123]
    ds_read_b64_tr_b16 v[40:41], v18 offset:0
    ds_read_b64_tr_b16 v[42:43], v18 offset:7680
    s_waitcnt lgkmcnt(10)
    v_mfma_f32_16x16x32_bf16 v[140:143], v[44:47], v[60:63], v[140:143]
    ds_read_b128 v[64:67], v14 offset:0
    ds_read_b128 v[68:71], v14 offset:2048
    ds_read_b128 v[72:75], v16
    ds_read_b64_tr_b16 v[44:45], v11 offset:15360
    ds_read_b64_tr_b16 v[46:47], v11 offset:23040
    s_waitcnt lgkmcnt(13)
    v_mfma_f32_16x16x32_bf16 v[92:95], v[48:51], v[52:55], v[92:95]
    v_mfma_f32_16x16x32_bf16 v[124:127], v[48:51], v[56:59], v[124:127]
    ds_read_b64_tr_b16 v[48:49], v11 offset:15368
    ds_read_b64_tr_b16 v[50:51], v11 offset:23048
    s_waitcnt lgkmcnt(13)
    v_mfma_f32_16x16x32_bf16 v[96:99], v[28:31], v[52:55], v[96:99]
    v_mfma_f32_16x16x32_bf16 v[128:131], v[28:31], v[56:59], v[128:131]
    ds_read_b64_tr_b16 v[28:29], v11 offset:15376
    ds_read_b64_tr_b16 v[30:31], v11 offset:23056
    s_waitcnt lgkmcnt(13)
    v_mfma_f32_16x16x32_bf16 v[100:103], v[32:35], v[52:55], v[100:103]
    v_mfma_f32_16x16x32_bf16 v[132:135], v[32:35], v[56:59], v[132:135]
    ds_read_b64_tr_b16 v[32:33], v11 offset:15384
    ds_read_b64_tr_b16 v[34:35], v11 offset:23064
    s_waitcnt lgkmcnt(13)
    v_mfma_f32_16x16x32_bf16 v[104:107], v[36:39], v[52:55], v[104:107]
    v_mfma_f32_16x16x32_bf16 v[136:139], v[36:39], v[56:59], v[136:139]
    ds_read_b64_tr_b16 v[36:37], v17 offset:15360
    ds_read_b64_tr_b16 v[38:39], v17 offset:23040
    s_waitcnt lgkmcnt(13)
    v_mfma_f32_16x16x32_bf16 v[144:147], v[40:43], v[60:63], v[144:147]
    ds_read_b64_tr_b16 v[40:41], v11 offset:15392
    ds_read_b64_tr_b16 v[42:43], v11 offset:23072
    s_waitcnt lgkmcnt(10)
    v_mfma_f32_16x16x32_bf16 v[76:79], v[44:47], v[64:67], v[76:79]
    v_mfma_f32_16x16x32_bf16 v[108:111], v[44:47], v[68:71], v[108:111]
    ds_read_b64_tr_b16 v[44:45], v12 offset:15360
    ds_read_b64_tr_b16 v[46:47], v12 offset:23040
    s_waitcnt lgkmcnt(10)
    v_mfma_f32_16x16x32_bf16 v[80:83], v[48:51], v[64:67], v[80:83]
    v_mfma_f32_16x16x32_bf16 v[112:115], v[48:51], v[68:71], v[112:115]
    ds_read_b64_tr_b16 v[48:49], v12 offset:15368
    ds_read_b64_tr_b16 v[50:51], v12 offset:23048
    s_waitcnt lgkmcnt(10)
    v_mfma_f32_16x16x32_bf16 v[84:87], v[28:31], v[64:67], v[84:87]
    v_mfma_f32_16x16x32_bf16 v[116:119], v[28:31], v[68:71], v[116:119]
    ds_read_b64_tr_b16 v[28:29], v12 offset:15376
    ds_read_b64_tr_b16 v[30:31], v12 offset:23056
    s_waitcnt lgkmcnt(10)
    v_mfma_f32_16x16x32_bf16 v[88:91], v[32:35], v[64:67], v[88:91]
    v_mfma_f32_16x16x32_bf16 v[120:123], v[32:35], v[68:71], v[120:123]
    ds_read_b64_tr_b16 v[32:33], v18 offset:15360
    ds_read_b64_tr_b16 v[34:35], v18 offset:23040
    s_waitcnt lgkmcnt(10)
    v_mfma_f32_16x16x32_bf16 v[140:143], v[36:39], v[72:75], v[140:143]
    s_waitcnt lgkmcnt(8)
    v_mfma_f32_16x16x32_bf16 v[92:95], v[40:43], v[64:67], v[92:95]
    v_mfma_f32_16x16x32_bf16 v[124:127], v[40:43], v[68:71], v[124:127]
    s_waitcnt lgkmcnt(6)
    v_mfma_f32_16x16x32_bf16 v[96:99], v[44:47], v[64:67], v[96:99]
    v_mfma_f32_16x16x32_bf16 v[128:131], v[44:47], v[68:71], v[128:131]
    s_waitcnt vmcnt(6) lgkmcnt(0)
    s_barrier
    v_add_u32 v11, 49152, v11
    v_add_u32 v12, 49152, v12
    v_add_u32 v13, 49152, v13
    v_add_u32 v14, 49152, v14
    v_add_u32 v15, 49152, v15
    v_add_u32 v16, 49152, v16
    v_add_u32 v17, 49152, v17
    v_add_u32 v18, 49152, v18
    ds_read_b128 v[52:55], v13 offset:0
    ds_read_b128 v[56:59], v13 offset:2048
    ds_read_b128 v[60:63], v15
    ds_read_b64_tr_b16 v[36:37], v11 offset:0
    ds_read_b64_tr_b16 v[38:39], v11 offset:7680
    ds_read_b64_tr_b16 v[40:41], v11 offset:8
    ds_read_b64_tr_b16 v[42:43], v11 offset:7688
    ds_read_b64_tr_b16 v[44:45], v11 offset:16
    ds_read_b64_tr_b16 v[46:47], v11 offset:7696
    v_mfma_f32_16x16x32_bf16 v[100:103], v[48:51], v[64:67], v[100:103]
    v_mfma_f32_16x16x32_bf16 v[132:135], v[48:51], v[68:71], v[132:135]
    s_mul_i32 s26, s23, 6144
    s_add_u32 m0, s26, 0
    s_add_u32 s34, s38, 9
    s_sub_u32 s27, s34, 10
    s_cmp_ge_u32 s34, 10
    s_cselect_b32 s34, s27, s34
    s_mul_i32 s34, s35, s34
    buffer_load_dwordx4 v20, s[40:43], s34 offen lds
    ds_read_b64_tr_b16 v[48:49], v11 offset:24
    ds_read_b64_tr_b16 v[50:51], v11 offset:7704
    v_mfma_f32_16x16x32_bf16 v[104:107], v[28:31], v[64:67], v[104:107]
    v_mfma_f32_16x16x32_bf16 v[136:139], v[28:31], v[68:71], v[136:139]
    s_mul_i32 s26, s23, 6144
    s_add_u32 m0, s26, 1024
    s_add_u32 s34, s38, 9
    s_sub_u32 s27, s34, 10
    s_cmp_ge_u32 s34, 10
    s_cselect_b32 s34, s27, s34
    s_mul_i32 s34, s35, s34
    buffer_load_dwordx4 v21, s[40:43], s34 offen lds
    ds_read_b64_tr_b16 v[28:29], v17 offset:0
    ds_read_b64_tr_b16 v[30:31], v17 offset:7680
    v_mfma_f32_16x16x32_bf16 v[144:147], v[32:35], v[72:75], v[144:147]
    s_mul_i32 s26, s23, 6144
    s_add_u32 m0, s26, 2048
    s_add_u32 s34, s38, 9
    s_sub_u32 s27, s34, 10
    s_cmp_ge_u32 s34, 10
    s_cselect_b32 s34, s27, s34
    s_mul_i32 s34, s35, s34
    buffer_load_dwordx4 v22, s[40:43], s34 offen lds
    ds_read_b64_tr_b16 v[32:33], v11 offset:32
    ds_read_b64_tr_b16 v[34:35], v11 offset:7712
    s_waitcnt lgkmcnt(10)
    v_mfma_f32_16x16x32_bf16 v[76:79], v[36:39], v[52:55], v[76:79]
    v_mfma_f32_16x16x32_bf16 v[108:111], v[36:39], v[56:59], v[108:111]
    s_mul_i32 s26, s23, 6144
    s_add_u32 m0, s26, 3072
    s_add_u32 s34, s38, 9
    s_sub_u32 s27, s34, 10
    s_cmp_ge_u32 s34, 10
    s_cselect_b32 s34, s27, s34
    s_mul_i32 s34, s35, s34
    buffer_load_dwordx4 v23, s[40:43], s34 offen lds
    ds_read_b64_tr_b16 v[36:37], v12 offset:0
    ds_read_b64_tr_b16 v[38:39], v12 offset:7680
    s_waitcnt lgkmcnt(10)
    v_mfma_f32_16x16x32_bf16 v[80:83], v[40:43], v[52:55], v[80:83]
    v_mfma_f32_16x16x32_bf16 v[112:115], v[40:43], v[56:59], v[112:115]
    s_mul_i32 s26, s23, 6144
    s_add_u32 m0, s26, 4096
    s_add_u32 s34, s38, 9
    s_sub_u32 s27, s34, 10
    s_cmp_ge_u32 s34, 10
    s_cselect_b32 s34, s27, s34
    s_mul_i32 s34, s35, s34
    buffer_load_dwordx4 v24, s[40:43], s34 offen lds
    ds_read_b64_tr_b16 v[40:41], v12 offset:8
    ds_read_b64_tr_b16 v[42:43], v12 offset:7688
    s_waitcnt lgkmcnt(10)
    v_mfma_f32_16x16x32_bf16 v[84:87], v[44:47], v[52:55], v[84:87]
    v_mfma_f32_16x16x32_bf16 v[116:119], v[44:47], v[56:59], v[116:119]
    s_mul_i32 s26, s23, 6144
    s_add_u32 m0, s26, 5120
    s_add_u32 s34, s38, 9
    s_sub_u32 s27, s34, 10
    s_cmp_ge_u32 s34, 10
    s_cselect_b32 s34, s27, s34
    s_mul_i32 s34, s35, s34
    buffer_load_dwordx4 v25, s[40:43], s34 offen lds
    ds_read_b64_tr_b16 v[44:45], v12 offset:16
    ds_read_b64_tr_b16 v[46:47], v12 offset:7696
    s_waitcnt lgkmcnt(10)
    v_mfma_f32_16x16x32_bf16 v[88:91], v[48:51], v[52:55], v[88:91]
    v_mfma_f32_16x16x32_bf16 v[120:123], v[48:51], v[56:59], v[120:123]
    ds_read_b64_tr_b16 v[48:49], v18 offset:0
    ds_read_b64_tr_b16 v[50:51], v18 offset:7680
    s_waitcnt lgkmcnt(10)
    v_mfma_f32_16x16x32_bf16 v[140:143], v[28:31], v[60:63], v[140:143]
    ds_read_b128 v[64:67], v14 offset:0
    ds_read_b128 v[68:71], v14 offset:2048
    ds_read_b128 v[72:75], v16
    ds_read_b64_tr_b16 v[28:29], v11 offset:15360
    ds_read_b64_tr_b16 v[30:31], v11 offset:23040
    s_waitcnt lgkmcnt(13)
    v_mfma_f32_16x16x32_bf16 v[92:95], v[32:35], v[52:55], v[92:95]
    v_mfma_f32_16x16x32_bf16 v[124:127], v[32:35], v[56:59], v[124:127]
    ds_read_b64_tr_b16 v[32:33], v11 offset:15368
    ds_read_b64_tr_b16 v[34:35], v11 offset:23048
    s_waitcnt lgkmcnt(13)
    v_mfma_f32_16x16x32_bf16 v[96:99], v[36:39], v[52:55], v[96:99]
    v_mfma_f32_16x16x32_bf16 v[128:131], v[36:39], v[56:59], v[128:131]
    ds_read_b64_tr_b16 v[36:37], v11 offset:15376
    ds_read_b64_tr_b16 v[38:39], v11 offset:23056
    s_waitcnt lgkmcnt(13)
    v_mfma_f32_16x16x32_bf16 v[100:103], v[40:43], v[52:55], v[100:103]
    v_mfma_f32_16x16x32_bf16 v[132:135], v[40:43], v[56:59], v[132:135]
    ds_read_b64_tr_b16 v[40:41], v11 offset:15384
    ds_read_b64_tr_b16 v[42:43], v11 offset:23064
    s_waitcnt lgkmcnt(13)
    v_mfma_f32_16x16x32_bf16 v[104:107], v[44:47], v[52:55], v[104:107]
    v_mfma_f32_16x16x32_bf16 v[136:139], v[44:47], v[56:59], v[136:139]
    ds_read_b64_tr_b16 v[44:45], v17 offset:15360
    ds_read_b64_tr_b16 v[46:47], v17 offset:23040
    s_waitcnt lgkmcnt(13)
    v_mfma_f32_16x16x32_bf16 v[144:147], v[48:51], v[60:63], v[144:147]
    ds_read_b64_tr_b16 v[48:49], v11 offset:15392
    ds_read_b64_tr_b16 v[50:51], v11 offset:23072
    s_waitcnt lgkmcnt(10)
    v_mfma_f32_16x16x32_bf16 v[76:79], v[28:31], v[64:67], v[76:79]
    v_mfma_f32_16x16x32_bf16 v[108:111], v[28:31], v[68:71], v[108:111]
    ds_read_b64_tr_b16 v[28:29], v12 offset:15360
    ds_read_b64_tr_b16 v[30:31], v12 offset:23040
    s_waitcnt lgkmcnt(10)
    v_mfma_f32_16x16x32_bf16 v[80:83], v[32:35], v[64:67], v[80:83]
    v_mfma_f32_16x16x32_bf16 v[112:115], v[32:35], v[68:71], v[112:115]
    ds_read_b64_tr_b16 v[32:33], v12 offset:15368
    ds_read_b64_tr_b16 v[34:35], v12 offset:23048
    s_waitcnt lgkmcnt(10)
    v_mfma_f32_16x16x32_bf16 v[84:87], v[36:39], v[64:67], v[84:87]
    v_mfma_f32_16x16x32_bf16 v[116:119], v[36:39], v[68:71], v[116:119]
    ds_read_b64_tr_b16 v[36:37], v12 offset:15376
    ds_read_b64_tr_b16 v[38:39], v12 offset:23056
    s_waitcnt lgkmcnt(10)
    v_mfma_f32_16x16x32_bf16 v[88:91], v[40:43], v[64:67], v[88:91]
    v_mfma_f32_16x16x32_bf16 v[120:123], v[40:43], v[68:71], v[120:123]
    ds_read_b64_tr_b16 v[40:41], v18 offset:15360
    ds_read_b64_tr_b16 v[42:43], v18 offset:23040
    s_waitcnt lgkmcnt(10)
    v_mfma_f32_16x16x32_bf16 v[140:143], v[44:47], v[72:75], v[140:143]
    s_waitcnt lgkmcnt(8)
    v_mfma_f32_16x16x32_bf16 v[92:95], v[48:51], v[64:67], v[92:95]
    v_mfma_f32_16x16x32_bf16 v[124:127], v[48:51], v[68:71], v[124:127]
    s_waitcnt lgkmcnt(6)
    v_mfma_f32_16x16x32_bf16 v[96:99], v[28:31], v[64:67], v[96:99]
    v_mfma_f32_16x16x32_bf16 v[128:131], v[28:31], v[68:71], v[128:131]
    s_waitcnt vmcnt(6) lgkmcnt(0)
    s_barrier
    v_add_u32 v11, 49152, v11
    v_add_u32 v12, 49152, v12
    v_add_u32 v13, 49152, v13
    v_add_u32 v14, 49152, v14
    v_add_u32 v15, 49152, v15
    v_add_u32 v16, 49152, v16
    v_add_u32 v17, 49152, v17
    v_add_u32 v18, 49152, v18
    ds_read_b128 v[52:55], v13 offset:0
    ds_read_b128 v[56:59], v13 offset:2048
    ds_read_b128 v[60:63], v15
    ds_read_b64_tr_b16 v[44:45], v11 offset:0
    ds_read_b64_tr_b16 v[46:47], v11 offset:7680
    ds_read_b64_tr_b16 v[48:49], v11 offset:8
    ds_read_b64_tr_b16 v[50:51], v11 offset:7688
    ds_read_b64_tr_b16 v[28:29], v11 offset:16
    ds_read_b64_tr_b16 v[30:31], v11 offset:7696
    v_mfma_f32_16x16x32_bf16 v[100:103], v[32:35], v[64:67], v[100:103]
    v_mfma_f32_16x16x32_bf16 v[132:135], v[32:35], v[68:71], v[132:135]
    ds_read_b64_tr_b16 v[32:33], v11 offset:24
    ds_read_b64_tr_b16 v[34:35], v11 offset:7704
    v_mfma_f32_16x16x32_bf16 v[104:107], v[36:39], v[64:67], v[104:107]
    v_mfma_f32_16x16x32_bf16 v[136:139], v[36:39], v[68:71], v[136:139]
    ds_read_b64_tr_b16 v[36:37], v17 offset:0
    ds_read_b64_tr_b16 v[38:39], v17 offset:7680
    v_mfma_f32_16x16x32_bf16 v[144:147], v[40:43], v[72:75], v[144:147]
    ds_read_b64_tr_b16 v[40:41], v11 offset:32
    ds_read_b64_tr_b16 v[42:43], v11 offset:7712
    s_waitcnt lgkmcnt(10)
    v_mfma_f32_16x16x32_bf16 v[76:79], v[44:47], v[52:55], v[76:79]
    v_mfma_f32_16x16x32_bf16 v[108:111], v[44:47], v[56:59], v[108:111]
    ds_read_b64_tr_b16 v[44:45], v12 offset:0
    ds_read_b64_tr_b16 v[46:47], v12 offset:7680
    s_waitcnt lgkmcnt(10)
    v_mfma_f32_16x16x32_bf16 v[80:83], v[48:51], v[52:55], v[80:83]
    v_mfma_f32_16x16x32_bf16 v[112:115], v[48:51], v[56:59], v[112:115]
    ds_read_b64_tr_b16 v[48:49], v12 offset:8
    ds_read_b64_tr_b16 v[50:51], v12 offset:7688
    s_waitcnt lgkmcnt(10)
    v_mfma_f32_16x16x32_bf16 v[84:87], v[28:31], v[52:55], v[84:87]
    v_mfma_f32_16x16x32_bf16 v[116:119], v[28:31], v[56:59], v[116:119]
    ds_read_b64_tr_b16 v[28:29], v12 offset:16
    ds_read_b64_tr_b16 v[30:31], v12 offset:7696
    s_waitcnt lgkmcnt(10)
    v_mfma_f32_16x16x32_bf16 v[88:91], v[32:35], v[52:55], v[88:91]
    v_mfma_f32_16x16x32_bf16 v[120:123], v[32:35], v[56:59], v[120:123]
    ds_read_b64_tr_b16 v[32:33], v18 offset:0
    ds_read_b64_tr_b16 v[34:35], v18 offset:7680
    s_waitcnt lgkmcnt(10)
    v_mfma_f32_16x16x32_bf16 v[140:143], v[36:39], v[60:63], v[140:143]
    ds_read_b128 v[64:67], v14 offset:0
    ds_read_b128 v[68:71], v14 offset:2048
    ds_read_b128 v[72:75], v16
    ds_read_b64_tr_b16 v[36:37], v11 offset:15360
    ds_read_b64_tr_b16 v[38:39], v11 offset:23040
    s_waitcnt lgkmcnt(13)
    v_mfma_f32_16x16x32_bf16 v[92:95], v[40:43], v[52:55], v[92:95]
    v_mfma_f32_16x16x32_bf16 v[124:127], v[40:43], v[56:59], v[124:127]
    ds_read_b64_tr_b16 v[40:41], v11 offset:15368
    ds_read_b64_tr_b16 v[42:43], v11 offset:23048
    s_waitcnt lgkmcnt(13)
    v_mfma_f32_16x16x32_bf16 v[96:99], v[44:47], v[52:55], v[96:99]
    v_mfma_f32_16x16x32_bf16 v[128:131], v[44:47], v[56:59], v[128:131]
    ds_read_b64_tr_b16 v[44:45], v11 offset:15376
    ds_read_b64_tr_b16 v[46:47], v11 offset:23056
    s_waitcnt lgkmcnt(13)
    v_mfma_f32_16x16x32_bf16 v[100:103], v[48:51], v[52:55], v[100:103]
    v_mfma_f32_16x16x32_bf16 v[132:135], v[48:51], v[56:59], v[132:135]
    ds_read_b64_tr_b16 v[48:49], v11 offset:15384
    ds_read_b64_tr_b16 v[50:51], v11 offset:23064
    s_waitcnt lgkmcnt(13)
    v_mfma_f32_16x16x32_bf16 v[104:107], v[28:31], v[52:55], v[104:107]
    v_mfma_f32_16x16x32_bf16 v[136:139], v[28:31], v[56:59], v[136:139]
    ds_read_b64_tr_b16 v[28:29], v17 offset:15360
    ds_read_b64_tr_b16 v[30:31], v17 offset:23040
    s_waitcnt lgkmcnt(13)
    v_mfma_f32_16x16x32_bf16 v[144:147], v[32:35], v[60:63], v[144:147]
    ds_read_b64_tr_b16 v[32:33], v11 offset:15392
    ds_read_b64_tr_b16 v[34:35], v11 offset:23072
    s_waitcnt lgkmcnt(10)
    v_mfma_f32_16x16x32_bf16 v[76:79], v[36:39], v[64:67], v[76:79]
    v_mfma_f32_16x16x32_bf16 v[108:111], v[36:39], v[68:71], v[108:111]
    ds_read_b64_tr_b16 v[36:37], v12 offset:15360
    ds_read_b64_tr_b16 v[38:39], v12 offset:23040
    s_waitcnt lgkmcnt(10)
    v_mfma_f32_16x16x32_bf16 v[80:83], v[40:43], v[64:67], v[80:83]
    v_mfma_f32_16x16x32_bf16 v[112:115], v[40:43], v[68:71], v[112:115]
    ds_read_b64_tr_b16 v[40:41], v12 offset:15368
    ds_read_b64_tr_b16 v[42:43], v12 offset:23048
    s_waitcnt lgkmcnt(10)
    v_mfma_f32_16x16x32_bf16 v[84:87], v[44:47], v[64:67], v[84:87]
    v_mfma_f32_16x16x32_bf16 v[116:119], v[44:47], v[68:71], v[116:119]
    ds_read_b64_tr_b16 v[44:45], v12 offset:15376
    ds_read_b64_tr_b16 v[46:47], v12 offset:23056
    s_waitcnt lgkmcnt(10)
    v_mfma_f32_16x16x32_bf16 v[88:91], v[48:51], v[64:67], v[88:91]
    v_mfma_f32_16x16x32_bf16 v[120:123], v[48:51], v[68:71], v[120:123]
    ds_read_b64_tr_b16 v[48:49], v18 offset:15360
    ds_read_b64_tr_b16 v[50:51], v18 offset:23040
    s_waitcnt lgkmcnt(10)
    v_mfma_f32_16x16x32_bf16 v[140:143], v[28:31], v[72:75], v[140:143]
    s_waitcnt lgkmcnt(8)
    v_mfma_f32_16x16x32_bf16 v[92:95], v[32:35], v[64:67], v[92:95]
    v_mfma_f32_16x16x32_bf16 v[124:127], v[32:35], v[68:71], v[124:127]
    s_waitcnt lgkmcnt(6)
    v_mfma_f32_16x16x32_bf16 v[96:99], v[36:39], v[64:67], v[96:99]
    v_mfma_f32_16x16x32_bf16 v[128:131], v[36:39], v[68:71], v[128:131]
    s_waitcnt vmcnt(0) lgkmcnt(0)
    s_barrier
    v_subrev_u32 v11, 98304, v11
    v_subrev_u32 v12, 98304, v12
    v_subrev_u32 v13, 98304, v13
    v_subrev_u32 v14, 98304, v14
    v_subrev_u32 v15, 98304, v15
    v_subrev_u32 v16, 98304, v16
    v_subrev_u32 v17, 98304, v17
    v_subrev_u32 v18, 98304, v18
    ds_read_b128 v[52:55], v13 offset:0
    ds_read_b128 v[56:59], v13 offset:2048
    ds_read_b128 v[60:63], v15
    ds_read_b64_tr_b16 v[28:29], v11 offset:0
    ds_read_b64_tr_b16 v[30:31], v11 offset:7680
    ds_read_b64_tr_b16 v[32:33], v11 offset:8
    ds_read_b64_tr_b16 v[34:35], v11 offset:7688
    ds_read_b64_tr_b16 v[36:37], v11 offset:16
    ds_read_b64_tr_b16 v[38:39], v11 offset:7696
    v_mfma_f32_16x16x32_bf16 v[100:103], v[40:43], v[64:67], v[100:103]
    v_mfma_f32_16x16x32_bf16 v[132:135], v[40:43], v[68:71], v[132:135]
    ds_read_b64_tr_b16 v[40:41], v11 offset:24
    ds_read_b64_tr_b16 v[42:43], v11 offset:7704
    v_mfma_f32_16x16x32_bf16 v[104:107], v[44:47], v[64:67], v[104:107]
    v_mfma_f32_16x16x32_bf16 v[136:139], v[44:47], v[68:71], v[136:139]
    ds_read_b64_tr_b16 v[44:45], v17 offset:0
    ds_read_b64_tr_b16 v[46:47], v17 offset:7680
    v_mfma_f32_16x16x32_bf16 v[144:147], v[48:51], v[72:75], v[144:147]
    ds_read_b64_tr_b16 v[48:49], v11 offset:32
    ds_read_b64_tr_b16 v[50:51], v11 offset:7712
    s_waitcnt lgkmcnt(10)
    v_mfma_f32_16x16x32_bf16 v[76:79], v[28:31], v[52:55], v[76:79]
    v_mfma_f32_16x16x32_bf16 v[108:111], v[28:31], v[56:59], v[108:111]
    ds_read_b64_tr_b16 v[28:29], v12 offset:0
    ds_read_b64_tr_b16 v[30:31], v12 offset:7680
    s_waitcnt lgkmcnt(10)
    v_mfma_f32_16x16x32_bf16 v[80:83], v[32:35], v[52:55], v[80:83]
    v_mfma_f32_16x16x32_bf16 v[112:115], v[32:35], v[56:59], v[112:115]
    ds_read_b64_tr_b16 v[32:33], v12 offset:8
    ds_read_b64_tr_b16 v[34:35], v12 offset:7688
    s_waitcnt lgkmcnt(10)
    v_mfma_f32_16x16x32_bf16 v[84:87], v[36:39], v[52:55], v[84:87]
    v_mfma_f32_16x16x32_bf16 v[116:119], v[36:39], v[56:59], v[116:119]
    ds_read_b64_tr_b16 v[36:37], v12 offset:16
    ds_read_b64_tr_b16 v[38:39], v12 offset:7696
    s_waitcnt lgkmcnt(10)
    v_mfma_f32_16x16x32_bf16 v[88:91], v[40:43], v[52:55], v[88:91]
    v_mfma_f32_16x16x32_bf16 v[120:123], v[40:43], v[56:59], v[120:123]
    ds_read_b64_tr_b16 v[40:41], v18 offset:0
    ds_read_b64_tr_b16 v[42:43], v18 offset:7680
    s_waitcnt lgkmcnt(10)
    v_mfma_f32_16x16x32_bf16 v[140:143], v[44:47], v[60:63], v[140:143]
    ds_read_b128 v[64:67], v14 offset:0
    ds_read_b128 v[68:71], v14 offset:2048
    ds_read_b128 v[72:75], v16
    ds_read_b64_tr_b16 v[44:45], v11 offset:15360
    ds_read_b64_tr_b16 v[46:47], v11 offset:23040
    s_waitcnt lgkmcnt(13)
    v_mfma_f32_16x16x32_bf16 v[92:95], v[48:51], v[52:55], v[92:95]
    v_mfma_f32_16x16x32_bf16 v[124:127], v[48:51], v[56:59], v[124:127]
    ds_read_b64_tr_b16 v[48:49], v11 offset:15368
    ds_read_b64_tr_b16 v[50:51], v11 offset:23048
    s_waitcnt lgkmcnt(13)
    v_mfma_f32_16x16x32_bf16 v[96:99], v[28:31], v[52:55], v[96:99]
    v_mfma_f32_16x16x32_bf16 v[128:131], v[28:31], v[56:59], v[128:131]
    ds_read_b64_tr_b16 v[28:29], v11 offset:15376
    ds_read_b64_tr_b16 v[30:31], v11 offset:23056
    s_waitcnt lgkmcnt(13)
    v_mfma_f32_16x16x32_bf16 v[100:103], v[32:35], v[52:55], v[100:103]
    v_mfma_f32_16x16x32_bf16 v[132:135], v[32:35], v[56:59], v[132:135]
    ds_read_b64_tr_b16 v[32:33], v11 offset:15384
    ds_read_b64_tr_b16 v[34:35], v11 offset:23064
    s_waitcnt lgkmcnt(13)
    v_mfma_f32_16x16x32_bf16 v[104:107], v[36:39], v[52:55], v[104:107]
    v_mfma_f32_16x16x32_bf16 v[136:139], v[36:39], v[56:59], v[136:139]
    ds_read_b64_tr_b16 v[36:37], v17 offset:15360
    ds_read_b64_tr_b16 v[38:39], v17 offset:23040
    s_waitcnt lgkmcnt(13)
    v_mfma_f32_16x16x32_bf16 v[144:147], v[40:43], v[60:63], v[144:147]
    ds_read_b64_tr_b16 v[40:41], v11 offset:15392
    ds_read_b64_tr_b16 v[42:43], v11 offset:23072
    s_waitcnt lgkmcnt(10)
    v_mfma_f32_16x16x32_bf16 v[76:79], v[44:47], v[64:67], v[76:79]
    v_mfma_f32_16x16x32_bf16 v[108:111], v[44:47], v[68:71], v[108:111]
    ds_read_b64_tr_b16 v[44:45], v12 offset:15360
    ds_read_b64_tr_b16 v[46:47], v12 offset:23040
    s_waitcnt lgkmcnt(10)
    v_mfma_f32_16x16x32_bf16 v[80:83], v[48:51], v[64:67], v[80:83]
    v_mfma_f32_16x16x32_bf16 v[112:115], v[48:51], v[68:71], v[112:115]
    ds_read_b64_tr_b16 v[48:49], v12 offset:15368
    ds_read_b64_tr_b16 v[50:51], v12 offset:23048
    s_waitcnt lgkmcnt(10)
    v_mfma_f32_16x16x32_bf16 v[84:87], v[28:31], v[64:67], v[84:87]
    v_mfma_f32_16x16x32_bf16 v[116:119], v[28:31], v[68:71], v[116:119]
    ds_read_b64_tr_b16 v[28:29], v12 offset:15376
    ds_read_b64_tr_b16 v[30:31], v12 offset:23056
    s_waitcnt lgkmcnt(10)
    v_mfma_f32_16x16x32_bf16 v[88:91], v[32:35], v[64:67], v[88:91]
    v_mfma_f32_16x16x32_bf16 v[120:123], v[32:35], v[68:71], v[120:123]
    ds_read_b64_tr_b16 v[32:33], v18 offset:15360
    ds_read_b64_tr_b16 v[34:35], v18 offset:23040
    s_waitcnt lgkmcnt(10)
    v_mfma_f32_16x16x32_bf16 v[140:143], v[36:39], v[72:75], v[140:143]
    s_waitcnt lgkmcnt(8)
    v_mfma_f32_16x16x32_bf16 v[92:95], v[40:43], v[64:67], v[92:95]
    v_mfma_f32_16x16x32_bf16 v[124:127], v[40:43], v[68:71], v[124:127]
    s_waitcnt lgkmcnt(6)
    v_mfma_f32_16x16x32_bf16 v[96:99], v[44:47], v[64:67], v[96:99]
    v_mfma_f32_16x16x32_bf16 v[128:131], v[44:47], v[68:71], v[128:131]
    s_waitcnt lgkmcnt(4)
    v_mfma_f32_16x16x32_bf16 v[100:103], v[48:51], v[64:67], v[100:103]
    v_mfma_f32_16x16x32_bf16 v[132:135], v[48:51], v[68:71], v[132:135]
    s_waitcnt lgkmcnt(2)
    v_mfma_f32_16x16x32_bf16 v[104:107], v[28:31], v[64:67], v[104:107]
    v_mfma_f32_16x16x32_bf16 v[136:139], v[28:31], v[68:71], v[136:139]
    s_waitcnt lgkmcnt(0)
    v_mfma_f32_16x16x32_bf16 v[144:147], v[32:35], v[72:75], v[144:147]
    v_mov_b32 v19, 0
    s_cmp_lg_u32 s23, 7
    s_cbranch_scc1 K1_ciB
    s_load_dwordx2 s[44:45], s[0:1], 72
    s_waitcnt lgkmcnt(0)
    s_mov_b32 s48, s44
    s_and_b32 s49, s45, 0xffff
    s_mov_b32 s50, 256
    s_mov_b32 s51, 0x00020000
    buffer_load_dword v19, v19, s[48:51], 0 offen sc1
K1_ciB:
    s_barrier
    v_and_b32 v2, 15, v1
    v_mul_u32_u24 v3, 272, v2
    v_lshl_add_u32 v3, v10, 6, v3
    s_mul_i32 s26, s24, 8704
    s_mul_i32 s27, s25, 39168
    s_add_u32 s27, s27, s26
    v_add_u32 v4, s27, v3
    s_mul_i32 s27, s25, 24
    s_add_u32 s27, s27, s26
    s_add_u32 s27, s27, 78336
    v_add_u32 v5, s27, v3
    v_mov_b32 v38, 0
    v_mov_b32 v39, 0
    v_mov_b32 v40, 0
    v_mov_b32 v41, 0
    v_mov_b32 v42, 0
    v_mov_b32 v43, 0
    v_cvt_pk_bf16_f32 v28, v76, v77
    v_cvt_pk_bf16_f32 v29, v78, v79
    v_cvt_pk_bf16_f32 v30, v80, v81
    v_cvt_pk_bf16_f32 v31, v82, v83
    v_cvt_pk_bf16_f32 v32, v84, v85
    v_cvt_pk_bf16_f32 v33, v86, v87
    v_cvt_pk_bf16_f32 v34, v88, v89
    v_cvt_pk_bf16_f32 v35, v90, v91
    v_cvt_pk_bf16_f32 v36, v92, v93
    v_cvt_pk_bf16_f32 v37, v94, v95
    ds_write_b128 v4, v[28:31] offset:0
    ds_write_b128 v4, v[32:35] offset:16
    ds_write_b128 v4, v[36:39] offset:32
    ds_write_b128 v4, v[40:43] offset:48
    v_cvt_pk_bf16_f32 v44, v96, v97
    v_cvt_pk_bf16_f32 v45, v98, v99
    v_cvt_pk_bf16_f32 v46, v100, v101
    v_cvt_pk_bf16_f32 v47, v102, v103
    v_cvt_pk_bf16_f32 v48, v104, v105
    v_cvt_pk_bf16_f32 v49, v106, v107
    ds_write_b64 v5, v[44:45] offset:0
    ds_write_b64 v5, v[46:47] offset:8
    ds_write_b64 v5, v[48:49] offset:16
    s_nop 1
    v_cvt_pk_bf16_f32 v28, v108, v109
    v_cvt_pk_bf16_f32 v29, v110, v111
    v_cvt_pk_bf16_f32 v30, v112, v113
    v_cvt_pk_bf16_f32 v31, v114, v115
    v_cvt_pk_bf16_f32 v32, v116, v117
    v_cvt_pk_bf16_f32 v33, v118, v119
    v_cvt_pk_bf16_f32 v34, v120, v121
    v_cvt_pk_bf16_f32 v35, v122, v123
    v_cvt_pk_bf16_f32 v36, v124, v125
    v_cvt_pk_bf16_f32 v37, v126, v127
    ds_write_b128 v4, v[28:31] offset:4352
    ds_write_b128 v4, v[32:35] offset:4368
    ds_write_b128 v4, v[36:39] offset:4384
    ds_write_b128 v4, v[40:43] offset:4400
    v_cvt_pk_bf16_f32 v44, v128, v129
    v_cvt_pk_bf16_f32 v45, v130, v131
    v_cvt_pk_bf16_f32 v46, v132, v133
    v_cvt_pk_bf16_f32 v47, v134, v135
    v_cvt_pk_bf16_f32 v48, v136, v137
    v_cvt_pk_bf16_f32 v49, v138, v139
    ds_write_b64 v5, v[44:45] offset:4352
    ds_write_b64 v5, v[46:47] offset:4360
    ds_write_b64 v5, v[48:49] offset:4368
    s_nop 1
    ds_write_b64 v3, v[38:39] offset:34856
    ds_write_b64 v3, v[38:39] offset:34864
    ds_write_b64 v3, v[38:39] offset:34872
    s_add_u32 s26, s23, 0
    s_cmp_ge_u32 s26, 10
    s_cselect_b32 s26, s23, s26
    s_cmp_ge_u32 s26, 5
    s_mov_b32 s28, 34816
    s_cselect_b32 s27, 73944, s28
    s_lshl_b32 s26, s26, 3
    s_add_u32 s26, s26, s27
    v_add_u32 v6, s26, v3
    v_cvt_pk_bf16_f32 v28, v140, v141
    v_cvt_pk_bf16_f32 v29, v142, v143
    ds_write_b64 v6, v[28:29]
    s_nop 1
    s_add_u32 s26, s23, 8
    s_cmp_ge_u32 s26, 10
    s_cselect_b32 s26, s23, s26
    s_cmp_ge_u32 s26, 5
    s_mov_b32 s28, 34816
    s_cselect_b32 s27, 73944, s28
    s_lshl_b32 s26, s26, 3
    s_add_u32 s26, s26, s27
    v_add_u32 v6, s26, v3
    v_cvt_pk_bf16_f32 v28, v144, v145
    v_cvt_pk_bf16_f32 v29, v146, v147
    ds_write_b64 v6, v[28:29]
    s_nop 1
    v_lshlrev_b32 v5, 2, v10
    v_sub_u32 v5, v2, v5
    v_sub_u32 v6, -2, v5
    v_and_b32 v6, 0x80000001, v6
    v_cmp_eq_u32 s[56:57], 0, v6
    v_subrev_u32 v6, 0, v5
    v_and_b32 v6, 0x80000001, v6
    v_cmp_eq_u32 s[64:65], 0, v6
    v_sub_u32 v6, -1, v5
    v_and_b32 v6, 0x80000001, v6
    v_cmp_eq_u32 s[58:59], 0, v6
    v_subrev_u32 v6, 1, v5
    v_and_b32 v6, 0x80000001, v6
    v_cmp_eq_u32 s[66:67], 0, v6
    v_sub_u32 v6, 0, v5
    v_and_b32 v6, 0x80000001, v6
    v_cmp_eq_u32 s[60:61], 0, v6
    v_subrev_u32 v6, 2, v5
    v_and_b32 v6, 0x80000001, v6
    v_cmp_eq_u32 s[68:69], 0, v6
    v_sub_u32 v6, 1, v5
    v_and_b32 v6, 0x80000001, v6
    v_cmp_eq_u32 s[62:63], 0, v6
    v_subrev_u32 v6, 3, v5
    v_and_b32 v6, 0x80000001, v6
    v_cmp_eq_u32 s[70:71], 0, v6
    s_or_b32 s26, s20, s23
    s_cmp_eq_u32 s26, 0
    s_cselect_b64 s[56:57], 0, s[56:57]
    s_cselect_b64 s[58:59], 0, s[58:59]
    s_cselect_b64 s[60:61], 0, s[60:61]
    s_cselect_b64 s[62:63], 0, s[62:63]
    v_mul_u32_u24 v3, 272, v2
    v_lshl_add_u32 v3, v10, 4, v3
    s_mul_i32 s26, s23, 4352
    v_add_u32 v3, s26, v3
    v_add_u32 v4, 34816, v3
    v_lshrrev_b32 v5, 2, v1
    v_mul_u32_u24 v5, 272, v5
    v_and_b32 v6, 3, v1
    v_lshl_add_u32 v5, v6, 3, v5
    v_add_u32 v5, s26, v5
    v_add_u32 v5, 73984, v5
    s_mov_b32 s30, 0x3e64f92e
    s_mov_b32 s31, 0xff000000
    s_lshl_b32 s26, s20, 3
    s_add_u32 s26, s26, s23
    s_mul_i32 s26, s26, 20480
    s_add_u32 s26, s26, 5242880
    s_mul_i32 s27, s21, 80
    v_lshlrev_b32 v6, 2, v10
    v_add_u32 v6, s27, v6
    v_lshlrev_b32 v7, 4, v2
    v_add_u32 v7, s26, v7
    v_add_u32 v8, 0, v6
    v_lshrrev_b32 v9, 5, v8
    v_lshl_add_u32 v232, v9, 10, v7
    v_bfe_u32 v9, v8, 3, 2
    v_lshl_add_u32 v232, v9, 8, v232
    v_bfe_u32 v9, v8, 2, 1
    v_lshl_add_u32 v232, v9, 3, v232
    v_add_u32 v8, 16, v6
    v_lshrrev_b32 v9, 5, v8
    v_lshl_add_u32 v233, v9, 10, v7
    v_bfe_u32 v9, v8, 3, 2
    v_lshl_add_u32 v233, v9, 8, v233
    v_bfe_u32 v9, v8, 2, 1
    v_lshl_add_u32 v233, v9, 3, v233
    v_add_u32 v8, 20, v6
    v_lshrrev_b32 v9, 5, v8
    v_lshl_add_u32 v234, v9, 10, v7
    v_bfe_u32 v9, v8, 3, 2
    v_lshl_add_u32 v234, v9, 8, v234
    v_bfe_u32 v9, v8, 2, 1
    v_lshl_add_u32 v234, v9, 3, v234
    v_add_u32 v8, 36, v6
    v_lshrrev_b32 v9, 5, v8
    v_lshl_add_u32 v235, v9, 10, v7
    v_bfe_u32 v9, v8, 3, 2
    v_lshl_add_u32 v235, v9, 8, v235
    v_bfe_u32 v9, v8, 2, 1
    v_lshl_add_u32 v235, v9, 3, v235
    v_add_u32 v8, 40, v6
    v_lshrrev_b32 v9, 5, v8
    v_lshl_add_u32 v236, v9, 10, v7
    v_bfe_u32 v9, v8, 3, 2
    v_lshl_add_u32 v236, v9, 8, v236
    v_bfe_u32 v9, v8, 2, 1
    v_lshl_add_u32 v236, v9, 3, v236
    v_add_u32 v8, 56, v6
    v_lshrrev_b32 v9, 5, v8
    v_lshl_add_u32 v237, v9, 10, v7
    v_bfe_u32 v9, v8, 3, 2
    v_lshl_add_u32 v237, v9, 8, v237
    v_bfe_u32 v9, v8, 2, 1
    v_lshl_add_u32 v237, v9, 3, v237
    v_add_u32 v8, 60, v6
    v_lshrrev_b32 v9, 5, v8
    v_lshl_add_u32 v238, v9, 10, v7
    v_bfe_u32 v9, v8, 3, 2
    v_lshl_add_u32 v238, v9, 8, v238
    v_bfe_u32 v9, v8, 2, 1
    v_lshl_add_u32 v238, v9, 3, v238
    v_add_u32 v8, 76, v6
    v_lshrrev_b32 v9, 5, v8
    v_lshl_add_u32 v239, v9, 10, v7
    v_bfe_u32 v9, v8, 3, 2
    v_lshl_add_u32 v239, v9, 8, v239
    v_bfe_u32 v9, v8, 2, 1
    v_lshl_add_u32 v239, v9, 3, v239
    s_waitcnt lgkmcnt(0)
    s_barrier
    ds_read_b128 v[76:79], v3 offset:0
    ds_read_b128 v[80:83], v4 offset:0
    ds_read_b128 v[84:87], v4 offset:4352
    ds_read_b64_tr_b16 v[88:89], v5 offset:0
    ds_read_b64_tr_b16 v[90:91], v5 offset:4352
    ds_read_b64_tr_b16 v[92:93], v5 offset:32
    ds_read_b64_tr_b16 v[94:95], v5 offset:4384
    ds_read_b128 v[104:107], v3 offset:64
    ds_read_b128 v[108:111], v4 offset:64
    ds_read_b128 v[112:115], v4 offset:4416
    ds_read_b64_tr_b16 v[116:117], v5 offset:64
    ds_read_b64_tr_b16 v[118:119], v5 offset:4416
    ds_read_b64_tr_b16 v[120:121], v5 offset:96
    ds_read_b64_tr_b16 v[122:123], v5 offset:4448
    s_waitcnt lgkmcnt(0)
    ds_read_b128 v[132:135], v3 offset:128
    ds_read_b128 v[136:139], v4 offset:128
    ds_read_b128 v[140:143], v4 offset:4480
    ds_read_b64_tr_b16 v[144:145], v5 offset:128
    ds_read_b64_tr_b16 v[146:147], v5 offset:4480
    ds_read_b64_tr_b16 v[148:149], v5 offset:160
    ds_read_b64_tr_b16 v[150:151], v5 offset:4512
    ds_read_b128 v[160:163], v3 offset:192
    ds_read_b128 v[164:167], v4 offset:192
    ds_read_b128 v[168:171], v4 offset:4544
    ds_read_b64_tr_b16 v[172:173], v5 offset:192
    ds_read_b64_tr_b16 v[174:175], v5 offset:4544
    ds_read_b64_tr_b16 v[176:177], v5 offset:224
    ds_read_b64_tr_b16 v[178:179], v5 offset:4576
    s_waitcnt lgkmcnt(0)
    v_mfma_f32_16x16x32_bf16 v[96:99], v[80:83], v[76:79], 0
    v_mfma_f32_16x16x32_bf16 v[100:103], v[84:87], v[76:79], 0
    v_mfma_f32_16x16x32_bf16 v[124:127], v[108:111], v[104:107], 0
    v_mfma_f32_16x16x32_bf16 v[128:131], v[112:115], v[104:107], 0
    v_mfma_f32_16x16x32_bf16 v[152:155], v[136:139], v[132:135], 0
    v_mfma_f32_16x16x32_bf16 v[156:159], v[140:143], v[132:135], 0
    v_mfma_f32_16x16x32_bf16 v[180:183], v[164:167], v[160:163], 0
    v_mfma_f32_16x16x32_bf16 v[184:187], v[168:171], v[160:163], 0
    s_nop 7
    v_cvt_pk_bf16_f32 v28, v96, v97
    v_cvt_pk_bf16_f32 v29, v98, v99
    v_cvt_pk_bf16_f32 v30, v100, v101
    v_cvt_pk_bf16_f32 v31, v102, v103
    v_lshlrev_b32 v96, 16, v28
    v_and_b32 v97, 0xffff0000, v28
    v_lshlrev_b32 v98, 16, v29
    v_and_b32 v99, 0xffff0000, v29
    v_lshlrev_b32 v100, 16, v30
    v_and_b32 v101, 0xffff0000, v30
    v_lshlrev_b32 v102, 16, v31
    v_and_b32 v103, 0xffff0000, v31
    v_mul_f32 v96, s30, v96
    v_mul_f32 v97, s30, v97
    v_mul_f32 v98, s30, v98
    v_mul_f32 v99, s30, v99
    v_mul_f32 v100, s30, v100
    v_mul_f32 v101, s30, v101
    v_mul_f32 v102, s30, v102
    v_mul_f32 v103, s30, v103
    v_cvt_pk_bf16_f32 v28, v96, v97
    v_cvt_pk_bf16_f32 v29, v98, v99
    v_cvt_pk_bf16_f32 v30, v100, v101
    v_cvt_pk_bf16_f32 v31, v102, v103
    v_lshlrev_b32 v96, 16, v28
    v_and_b32 v97, 0xffff0000, v28
    v_lshlrev_b32 v98, 16, v29
    v_and_b32 v99, 0xffff0000, v29
    v_lshlrev_b32 v100, 16, v30
    v_and_b32 v101, 0xffff0000, v30
    v_lshlrev_b32 v102, 16, v31
    v_and_b32 v103, 0xffff0000, v31
    v_mov_b32 v32, s31
    v_cndmask_b32 v96, v32, v96, s[56:57]
    v_cndmask_b32 v97, v32, v97, s[58:59]
    v_cndmask_b32 v98, v32, v98, s[60:61]
    v_cndmask_b32 v99, v32, v99, s[62:63]
    v_cndmask_b32 v100, v32, v100, s[64:65]
    v_cndmask_b32 v101, v32, v101, s[66:67]
    v_cndmask_b32 v102, v32, v102, s[68:69]
    v_cndmask_b32 v103, v32, v103, s[70:71]
    v_max3_f32 v33, v96, v97, v98
    v_max3_f32 v33, v33, v99, v100
    v_max3_f32 v33, v33, v101, v102
    v_max_f32 v33, v33, v103
    v_mov_b32 v34, v33
    s_nop 1
    v_permlane16_swap_b32 v33, v34
    s_nop 1
    v_max_f32 v33, v33, v34
    v_mov_b32 v34, v33
    s_nop 1
    v_permlane32_swap_b32 v33, v34
    s_nop 1
    v_max_f32 v33, v33, v34
    v_mul_f32 v33, s37, v33
    v_fma_f32 v96, v96, s36, v33
    v_fma_f32 v97, v97, s36, v33
    v_fma_f32 v98, v98, s36, v33
    v_fma_f32 v99, v99, s36, v33
    v_fma_f32 v100, v100, s36, v33
    v_fma_f32 v101, v101, s36, v33
    v_fma_f32 v102, v102, s36, v33
    v_fma_f32 v103, v103, s36, v33
    v_exp_f32 v96, v96
    v_exp_f32 v97, v97
    v_exp_f32 v98, v98
    v_exp_f32 v99, v99
    v_exp_f32 v100, v100
    v_exp_f32 v101, v101
    v_exp_f32 v102, v102
    v_exp_f32 v103, v103
    s_nop 0
    v_add_f32 v33, v96, v97
    v_add_f32 v34, v98, v99
    v_add_f32 v33, v33, v100
    v_add_f32 v34, v34, v101
    v_add_f32 v33, v33, v102
    v_add_f32 v34, v34, v103
    v_add_f32 v33, v33, v34
    v_mov_b32 v34, v33
    s_nop 1
    v_permlane16_swap_b32 v33, v34
    s_nop 1
    v_add_f32 v33, v33, v34
    v_mov_b32 v34, v33
    s_nop 1
    v_permlane32_swap_b32 v33, v34
    s_nop 1
    v_add_f32 v33, v33, v34
    v_rcp_f32 v33, v33
    s_nop 0
    v_mul_f32 v96, v96, v33
    v_mul_f32 v97, v97, v33
    v_mul_f32 v98, v98, v33
    v_mul_f32 v99, v99, v33
    v_mul_f32 v100, v100, v33
    v_mul_f32 v101, v101, v33
    v_mul_f32 v102, v102, v33
    v_mul_f32 v103, v103, v33
    v_cvt_pk_bf16_f32 v76, v96, v97
    v_cvt_pk_bf16_f32 v77, v98, v99
    v_cvt_pk_bf16_f32 v78, v100, v101
    v_cvt_pk_bf16_f32 v79, v102, v103
    s_nop 1
    v_mfma_f32_16x16x32_bf16 v[96:99], v[88:91], v[76:79], 0
    v_mfma_f32_16x16x32_bf16 v[100:103], v[92:95], v[76:79], 0
    v_cvt_pk_bf16_f32 v28, v124, v125
    v_cvt_pk_bf16_f32 v29, v126, v127
    v_cvt_pk_bf16_f32 v30, v128, v129
    v_cvt_pk_bf16_f32 v31, v130, v131
    v_lshlrev_b32 v124, 16, v28
    v_and_b32 v125, 0xffff0000, v28
    v_lshlrev_b32 v126, 16, v29
    v_and_b32 v127, 0xffff0000, v29
    v_lshlrev_b32 v128, 16, v30
    v_and_b32 v129, 0xffff0000, v30
    v_lshlrev_b32 v130, 16, v31
    v_and_b32 v131, 0xffff0000, v31
    v_mul_f32 v124, s30, v124
    v_mul_f32 v125, s30, v125
    v_mul_f32 v126, s30, v126
    v_mul_f32 v127, s30, v127
    v_mul_f32 v128, s30, v128
    v_mul_f32 v129, s30, v129
    v_mul_f32 v130, s30, v130
    v_mul_f32 v131, s30, v131
    v_cvt_pk_bf16_f32 v28, v124, v125
    v_cvt_pk_bf16_f32 v29, v126, v127
    v_cvt_pk_bf16_f32 v30, v128, v129
    v_cvt_pk_bf16_f32 v31, v130, v131
    v_lshlrev_b32 v124, 16, v28
    v_and_b32 v125, 0xffff0000, v28
    v_lshlrev_b32 v126, 16, v29
    v_and_b32 v127, 0xffff0000, v29
    v_lshlrev_b32 v128, 16, v30
    v_and_b32 v129, 0xffff0000, v30
    v_lshlrev_b32 v130, 16, v31
    v_and_b32 v131, 0xffff0000, v31
    v_mov_b32 v32, s31
    v_cndmask_b32 v124, v32, v124, s[56:57]
    v_cndmask_b32 v125, v32, v125, s[58:59]
    v_cndmask_b32 v126, v32, v126, s[60:61]
    v_cndmask_b32 v127, v32, v127, s[62:63]
    v_cndmask_b32 v128, v32, v128, s[64:65]
    v_cndmask_b32 v129, v32, v129, s[66:67]
    v_cndmask_b32 v130, v32, v130, s[68:69]
    v_cndmask_b32 v131, v32, v131, s[70:71]
    v_max3_f32 v33, v124, v125, v126
    v_max3_f32 v33, v33, v127, v128
    v_max3_f32 v33, v33, v129, v130
    v_max_f32 v33, v33, v131
    v_mov_b32 v34, v33
    s_nop 1
    v_permlane16_swap_b32 v33, v34
    s_nop 1
    v_max_f32 v33, v33, v34
    v_mov_b32 v34, v33
    s_nop 1
    v_permlane32_swap_b32 v33, v34
    s_nop 1
    v_max_f32 v33, v33, v34
    v_mul_f32 v33, s37, v33
    v_fma_f32 v124, v124, s36, v33
    v_fma_f32 v125, v125, s36, v33
    v_fma_f32 v126, v126, s36, v33
    v_fma_f32 v127, v127, s36, v33
    v_fma_f32 v128, v128, s36, v33
    v_fma_f32 v129, v129, s36, v33
    v_fma_f32 v130, v130, s36, v33
    v_fma_f32 v131, v131, s36, v33
    v_exp_f32 v124, v124
    v_exp_f32 v125, v125
    v_exp_f32 v126, v126
    v_exp_f32 v127, v127
    v_exp_f32 v128, v128
    v_exp_f32 v129, v129
    v_exp_f32 v130, v130
    v_exp_f32 v131, v131
    s_nop 0
    v_add_f32 v33, v124, v125
    v_add_f32 v34, v126, v127
    v_add_f32 v33, v33, v128
    v_add_f32 v34, v34, v129
    v_add_f32 v33, v33, v130
    v_add_f32 v34, v34, v131
    v_add_f32 v33, v33, v34
    v_mov_b32 v34, v33
    s_nop 1
    v_permlane16_swap_b32 v33, v34
    s_nop 1
    v_add_f32 v33, v33, v34
    v_mov_b32 v34, v33
    s_nop 1
    v_permlane32_swap_b32 v33, v34
    s_nop 1
    v_add_f32 v33, v33, v34
    v_rcp_f32 v33, v33
    s_nop 0
    v_mul_f32 v124, v124, v33
    v_mul_f32 v125, v125, v33
    v_mul_f32 v126, v126, v33
    v_mul_f32 v127, v127, v33
    v_mul_f32 v128, v128, v33
    v_mul_f32 v129, v129, v33
    v_mul_f32 v130, v130, v33
    v_mul_f32 v131, v131, v33
    v_cvt_pk_bf16_f32 v104, v124, v125
    v_cvt_pk_bf16_f32 v105, v126, v127
    v_cvt_pk_bf16_f32 v106, v128, v129
    v_cvt_pk_bf16_f32 v107, v130, v131
    s_nop 1
    v_mfma_f32_16x16x32_bf16 v[124:127], v[116:119], v[104:107], 0
    v_mfma_f32_16x16x32_bf16 v[128:131], v[120:123], v[104:107], 0
    v_cvt_pk_bf16_f32 v28, v152, v153
    v_cvt_pk_bf16_f32 v29, v154, v155
    v_cvt_pk_bf16_f32 v30, v156, v157
    v_cvt_pk_bf16_f32 v31, v158, v159
    v_lshlrev_b32 v152, 16, v28
    v_and_b32 v153, 0xffff0000, v28
    v_lshlrev_b32 v154, 16, v29
    v_and_b32 v155, 0xffff0000, v29
    v_lshlrev_b32 v156, 16, v30
    v_and_b32 v157, 0xffff0000, v30
    v_lshlrev_b32 v158, 16, v31
    v_and_b32 v159, 0xffff0000, v31
    v_mul_f32 v152, s30, v152
    v_mul_f32 v153, s30, v153
    v_mul_f32 v154, s30, v154
    v_mul_f32 v155, s30, v155
    v_mul_f32 v156, s30, v156
    v_mul_f32 v157, s30, v157
    v_mul_f32 v158, s30, v158
    v_mul_f32 v159, s30, v159
    v_cvt_pk_bf16_f32 v28, v152, v153
    v_cvt_pk_bf16_f32 v29, v154, v155
    v_cvt_pk_bf16_f32 v30, v156, v157
    v_cvt_pk_bf16_f32 v31, v158, v159
    v_lshlrev_b32 v152, 16, v28
    v_and_b32 v153, 0xffff0000, v28
    v_lshlrev_b32 v154, 16, v29
    v_and_b32 v155, 0xffff0000, v29
    v_lshlrev_b32 v156, 16, v30
    v_and_b32 v157, 0xffff0000, v30
    v_lshlrev_b32 v158, 16, v31
    v_and_b32 v159, 0xffff0000, v31
    v_mov_b32 v32, s31
    v_cndmask_b32 v152, v32, v152, s[56:57]
    v_cndmask_b32 v153, v32, v153, s[58:59]
    v_cndmask_b32 v154, v32, v154, s[60:61]
    v_cndmask_b32 v155, v32, v155, s[62:63]
    v_cndmask_b32 v156, v32, v156, s[64:65]
    v_cndmask_b32 v157, v32, v157, s[66:67]
    v_cndmask_b32 v158, v32, v158, s[68:69]
    v_cndmask_b32 v159, v32, v159, s[70:71]
    v_max3_f32 v33, v152, v153, v154
    v_max3_f32 v33, v33, v155, v156
    v_max3_f32 v33, v33, v157, v158
    v_max_f32 v33, v33, v159
    v_mov_b32 v34, v33
    s_nop 1
    v_permlane16_swap_b32 v33, v34
    s_nop 1
    v_max_f32 v33, v33, v34
    v_mov_b32 v34, v33
    s_nop 1
    v_permlane32_swap_b32 v33, v34
    s_nop 1
    v_max_f32 v33, v33, v34
    v_mul_f32 v33, s37, v33
    v_fma_f32 v152, v152, s36, v33
    v_fma_f32 v153, v153, s36, v33
    v_fma_f32 v154, v154, s36, v33
    v_fma_f32 v155, v155, s36, v33
    v_fma_f32 v156, v156, s36, v33
    v_fma_f32 v157, v157, s36, v33
    v_fma_f32 v158, v158, s36, v33
    v_fma_f32 v159, v159, s36, v33
    v_exp_f32 v152, v152
    v_exp_f32 v153, v153
    v_exp_f32 v154, v154
    v_exp_f32 v155, v155
    v_exp_f32 v156, v156
    v_exp_f32 v157, v157
    v_exp_f32 v158, v158
    v_exp_f32 v159, v159
    s_nop 0
    v_add_f32 v33, v152, v153
    v_add_f32 v34, v154, v155
    v_add_f32 v33, v33, v156
    v_add_f32 v34, v34, v157
    v_add_f32 v33, v33, v158
    v_add_f32 v34, v34, v159
    v_add_f32 v33, v33, v34
    v_mov_b32 v34, v33
    s_nop 1
    v_permlane16_swap_b32 v33, v34
    s_nop 1
    v_add_f32 v33, v33, v34
    v_mov_b32 v34, v33
    s_nop 1
    v_permlane32_swap_b32 v33, v34
    s_nop 1
    v_add_f32 v33, v33, v34
    v_rcp_f32 v33, v33
    s_nop 0
    v_mul_f32 v152, v152, v33
    v_mul_f32 v153, v153, v33
    v_mul_f32 v154, v154, v33
    v_mul_f32 v155, v155, v33
    v_mul_f32 v156, v156, v33
    v_mul_f32 v157, v157, v33
    v_mul_f32 v158, v158, v33
    v_mul_f32 v159, v159, v33
    v_cvt_pk_bf16_f32 v132, v152, v153
    v_cvt_pk_bf16_f32 v133, v154, v155
    v_cvt_pk_bf16_f32 v134, v156, v157
    v_cvt_pk_bf16_f32 v135, v158, v159
    s_nop 1
    v_mfma_f32_16x16x32_bf16 v[152:155], v[144:147], v[132:135], 0
    v_mfma_f32_16x16x32_bf16 v[156:159], v[148:151], v[132:135], 0
    v_cvt_pk_bf16_f32 v28, v180, v181
    v_cvt_pk_bf16_f32 v29, v182, v183
    v_cvt_pk_bf16_f32 v30, v184, v185
    v_cvt_pk_bf16_f32 v31, v186, v187
    v_lshlrev_b32 v180, 16, v28
    v_and_b32 v181, 0xffff0000, v28
    v_lshlrev_b32 v182, 16, v29
    v_and_b32 v183, 0xffff0000, v29
    v_lshlrev_b32 v184, 16, v30
    v_and_b32 v185, 0xffff0000, v30
    v_lshlrev_b32 v186, 16, v31
    v_and_b32 v187, 0xffff0000, v31
    v_mul_f32 v180, s30, v180
    v_mul_f32 v181, s30, v181
    v_mul_f32 v182, s30, v182
    v_mul_f32 v183, s30, v183
    v_mul_f32 v184, s30, v184
    v_mul_f32 v185, s30, v185
    v_mul_f32 v186, s30, v186
    v_mul_f32 v187, s30, v187
    v_cvt_pk_bf16_f32 v28, v180, v181
    v_cvt_pk_bf16_f32 v29, v182, v183
    v_cvt_pk_bf16_f32 v30, v184, v185
    v_cvt_pk_bf16_f32 v31, v186, v187
    v_lshlrev_b32 v180, 16, v28
    v_and_b32 v181, 0xffff0000, v28
    v_lshlrev_b32 v182, 16, v29
    v_and_b32 v183, 0xffff0000, v29
    v_lshlrev_b32 v184, 16, v30
    v_and_b32 v185, 0xffff0000, v30
    v_lshlrev_b32 v186, 16, v31
    v_and_b32 v187, 0xffff0000, v31
    v_mov_b32 v32, s31
    v_cndmask_b32 v180, v32, v180, s[56:57]
    v_cndmask_b32 v181, v32, v181, s[58:59]
    v_cndmask_b32 v182, v32, v182, s[60:61]
    v_cndmask_b32 v183, v32, v183, s[62:63]
    v_cndmask_b32 v184, v32, v184, s[64:65]
    v_cndmask_b32 v185, v32, v185, s[66:67]
    v_cndmask_b32 v186, v32, v186, s[68:69]
    v_cndmask_b32 v187, v32, v187, s[70:71]
    v_max3_f32 v33, v180, v181, v182
    v_max3_f32 v33, v33, v183, v184
    v_max3_f32 v33, v33, v185, v186
    v_max_f32 v33, v33, v187
    v_mov_b32 v34, v33
    s_nop 1
    v_permlane16_swap_b32 v33, v34
    s_nop 1
    v_max_f32 v33, v33, v34
    v_mov_b32 v34, v33
    s_nop 1
    v_permlane32_swap_b32 v33, v34
    s_nop 1
    v_max_f32 v33, v33, v34
    v_mul_f32 v33, s37, v33
    v_fma_f32 v180, v180, s36, v33
    v_fma_f32 v181, v181, s36, v33
    v_fma_f32 v182, v182, s36, v33
    v_fma_f32 v183, v183, s36, v33
    v_fma_f32 v184, v184, s36, v33
    v_fma_f32 v185, v185, s36, v33
    v_fma_f32 v186, v186, s36, v33
    v_fma_f32 v187, v187, s36, v33
    v_exp_f32 v180, v180
    v_exp_f32 v181, v181
    v_exp_f32 v182, v182
    v_exp_f32 v183, v183
    v_exp_f32 v184, v184
    v_exp_f32 v185, v185
    v_exp_f32 v186, v186
    v_exp_f32 v187, v187
    s_nop 0
    v_add_f32 v33, v180, v181
    v_add_f32 v34, v182, v183
    v_add_f32 v33, v33, v184
    v_add_f32 v34, v34, v185
    v_add_f32 v33, v33, v186
    v_add_f32 v34, v34, v187
    v_add_f32 v33, v33, v34
    v_mov_b32 v34, v33
    s_nop 1
    v_permlane16_swap_b32 v33, v34
    s_nop 1
    v_add_f32 v33, v33, v34
    v_mov_b32 v34, v33
    s_nop 1
    v_permlane32_swap_b32 v33, v34
    s_nop 1
    v_add_f32 v33, v33, v34
    v_rcp_f32 v33, v33
    s_nop 0
    v_mul_f32 v180, v180, v33
    v_mul_f32 v181, v181, v33
    v_mul_f32 v182, v182, v33
    v_mul_f32 v183, v183, v33
    v_mul_f32 v184, v184, v33
    v_mul_f32 v185, v185, v33
    v_mul_f32 v186, v186, v33
    v_mul_f32 v187, v187, v33
    v_cvt_pk_bf16_f32 v160, v180, v181
    v_cvt_pk_bf16_f32 v161, v182, v183
    v_cvt_pk_bf16_f32 v162, v184, v185
    v_cvt_pk_bf16_f32 v163, v186, v187
    s_nop 1
    v_mfma_f32_16x16x32_bf16 v[180:183], v[172:175], v[160:163], 0
    v_mfma_f32_16x16x32_bf16 v[184:187], v[176:179], v[160:163], 0
    s_nop 7
    v_cvt_pk_bf16_f32 v76, v96, v97
    v_cvt_pk_bf16_f32 v77, v98, v99
    v_cvt_pk_bf16_f32 v78, v100, v101
    v_cvt_pk_bf16_f32 v79, v102, v103
    buffer_store_dwordx2 v[76:77], v232, s[12:15], 0 offen sc1
    v_cvt_pk_bf16_f32 v104, v124, v125
    v_cvt_pk_bf16_f32 v105, v126, v127
    v_cvt_pk_bf16_f32 v106, v128, v129
    v_cvt_pk_bf16_f32 v107, v130, v131
    buffer_store_dwordx2 v[104:105], v234, s[12:15], 0 offen sc1
    v_cvt_pk_bf16_f32 v132, v152, v153
    v_cvt_pk_bf16_f32 v133, v154, v155
    v_cvt_pk_bf16_f32 v134, v156, v157
    v_cvt_pk_bf16_f32 v135, v158, v159
    buffer_store_dwordx2 v[132:133], v236, s[12:15], 0 offen sc1
    v_cvt_pk_bf16_f32 v160, v180, v181
    v_cvt_pk_bf16_f32 v161, v182, v183
    v_cvt_pk_bf16_f32 v162, v184, v185
    v_cvt_pk_bf16_f32 v163, v186, v187
    buffer_store_dwordx2 v[160:161], v238, s[12:15], 0 offen sc1
    s_mov_b64 exec, 0xffff
    buffer_store_dwordx2 v[78:79], v233, s[12:15], 0 offen sc1
    buffer_store_dwordx2 v[106:107], v235, s[12:15], 0 offen sc1
    buffer_store_dwordx2 v[134:135], v237, s[12:15], 0 offen sc1
    buffer_store_dwordx2 v[162:163], v239, s[12:15], 0 offen sc1
    s_mov_b64 exec, -1
    s_cmp_lg_u32 s23, 7
    s_cbranch_scc1 K1_sB_c
    s_waitcnt vmcnt(0)
    v_readfirstlane_b32 s26, v19
    s_nop 3
    s_cmp_ge_u32 s26, 256
    s_cbranch_scc1 K1_sB_c
    s_load_dwordx2 s[44:45], s[0:1], 72
    s_waitcnt lgkmcnt(0)
    s_mov_b32 s48, s44
    s_and_b32 s49, s45, 0xffff
    s_mov_b32 s50, 256
    s_mov_b32 s51, 0x00020000
    v_mov_b32 v2, 0
    s_mov_b32 s28, 0
K1_sB_l:
    buffer_load_dword v3, v2, s[48:51], 0 offen sc1
    s_waitcnt vmcnt(0)
    v_readfirstlane_b32 s26, v3
    s_nop 3
    s_cmp_ge_u32 s26, 256
    s_cbranch_scc1 K1_sB_c
    s_add_u32 s28, s28, 1
    s_cmp_lt_u32 s28, 0x40000
    s_cbranch_scc0 K1_sB_c
    s_sleep 2
    s_branch K1_sB_l
K1_sB_c:
    s_waitcnt vmcnt(0) lgkmcnt(0)
    s_barrier
    s_cmp_lg_u32 s23, 0
    s_cbranch_scc1 K1_sB
    s_add_u32 s27, s20, 8
    s_cmp_eq_u32 s22, 0
    s_cselect_b32 s26, s21, s27
    s_cselect_b32 s27, s20, s21
    s_lshl_b32 s26, s26, 7
    s_lshl_b32 s27, s27, 2
    s_add_u32 s26, s26, s27
    s_add_u32 s26, s26, 14684160
    v_mov_b32 v2, s26
    v_mov_b32 v3, 1
    s_mov_b64 exec, 1
    buffer_store_dword v3, v2, s[12:15], 0 offen sc1
    s_mov_b64 exec, -1
K1_sB:
K1_tail:
    s_load_dwordx2 s[40:41], s[0:1], 24
    s_load_dwordx2 s[42:43], s[0:1], 48
    s_load_dwordx4 s[44:47], s[0:1], 64
    s_load_dwordx2 s[48:49], s[0:1], 80
    s_and_b32 s62, s2, 7
    s_lshr_b32 s31, s2, 3
    s_lshl_b32 s24, s62, 2
    s_and_b32 s29, s31, 3
    s_add_u32 s24, s24, s29
    s_lshr_b32 s25, s31, 2
    s_and_b32 s60, s2, 31
    s_lshr_b32 s61, s2, 5
    v_lshrrev_b32 v2, 6, v0
    v_and_b32 v1, 63, v0
    v_readfirstlane_b32 s26, v2
    v_lshrrev_b32 v10, 4, v1
    v_mul_u32_u24 v2, 6554, v0
    v_lshrrev_b32 v2, 16, v2
    v_mul_u32_u24 v3, 10, v2
    v_sub_u32 v3, v0, v3
    v_mul_u32_u24 v4, 192, v2
    v_lshl_add_u32 v4, v3, 4, v4
    v_mul_u32_u24 v5, 80, v2
    v_lshl_add_u32 v5, v3, 3, v5
    v_add_u32 v5, 158720, v5
    s_mul_i32 s30, s60, 6144
    s_add_u32 s30, s30, 8388608
    v_add_u32 v4, s30, v4
    s_and_b32 s27, s26, 3
    s_lshr_b32 s28, s26, 2
    s_waitcnt lgkmcnt(0)
    s_mov_b32 s12, s48
    s_and_b32 s13, s49, 0xffff
    s_mov_b32 s14, 33554432
    s_mov_b32 s15, 0x00020000
    s_mul_i32 s31, s25, 160
    s_mov_b32 s32, 6554
    v_add_u32 v24, 0, v1
    v_mul_u32_u24 v25, s32, v24
    v_lshrrev_b32 v25, 16, v25
    v_mul_u32_u24 v26, 10, v25
    v_sub_u32 v26, v24, v26
    v_lshlrev_b32 v26, 4, v26
    v_add_u32 v26, s31, v26
    v_bfe_u32 v27, v25, 4, 1
    v_bfe_u32 v28, v25, 2, 2
    v_and_b32 v29, 3, v25
    v_lshl_add_u32 v29, v27, 2, v29
    v_lshl_add_u32 v30, v28, 3, v29
    v_mul_u32_u24 v30, 1280, v30
    v_add_u32 v18, v30, v26
    v_add_u32 v24, 64, v1
    v_mul_u32_u24 v25, s32, v24
    v_lshrrev_b32 v25, 16, v25
    v_mul_u32_u24 v26, 10, v25
    v_sub_u32 v26, v24, v26
    v_lshlrev_b32 v26, 4, v26
    v_add_u32 v26, s31, v26
    v_bfe_u32 v27, v25, 4, 1
    v_bfe_u32 v28, v25, 2, 2
    v_and_b32 v29, 3, v25
    v_lshl_add_u32 v29, v27, 2, v29
    v_lshl_add_u32 v30, v28, 3, v29
    v_mul_u32_u24 v30, 1280, v30
    v_add_u32 v19, v30, v26
    v_add_u32 v24, 128, v1
    v_mul_u32_u24 v25, s32, v24
    v_lshrrev_b32 v25, 16, v25
    v_mul_u32_u24 v26, 10, v25
    v_sub_u32 v26, v24, v26
    v_lshlrev_b32 v26, 4, v26
    v_add_u32 v26, s31, v26
    v_bfe_u32 v27, v25, 4, 1
    v_bfe_u32 v28, v25, 2, 2
    v_and_b32 v29, 3, v25
    v_lshl_add_u32 v29, v27, 2, v29
    v_lshl_add_u32 v30, v28, 3, v29
    v_mul_u32_u24 v30, 1280, v30
    v_add_u32 v20, v30, v26
    v_add_u32 v24, 192, v1
    v_mul_u32_u24 v25, s32, v24
    v_lshrrev_b32 v25, 16, v25
    v_mul_u32_u24 v26, 10, v25
    v_sub_u32 v26, v24, v26
    v_lshlrev_b32 v26, 4, v26
    v_add_u32 v26, s31, v26
    v_bfe_u32 v27, v25, 4, 1
    v_bfe_u32 v28, v25, 2, 2
    v_and_b32 v29, 3, v25
    v_lshl_add_u32 v29, v27, 2, v29
    v_lshl_add_u32 v30, v28, 3, v29
    v_mul_u32_u24 v30, 1280, v30
    v_add_u32 v21, v30, v26
    v_add_u32 v24, 256, v1
    v_mul_u32_u24 v25, s32, v24
    v_lshrrev_b32 v25, 16, v25
    v_mul_u32_u24 v26, 10, v25
    v_sub_u32 v26, v24, v26
    v_lshlrev_b32 v26, 4, v26
    v_add_u32 v26, s31, v26
    v_bfe_u32 v27, v25, 4, 1
    v_bfe_u32 v28, v25, 2, 2
    v_and_b32 v29, 3, v25
    v_lshl_add_u32 v29, v27, 2, v29
    v_lshl_add_u32 v30, v28, 3, v29
    v_mul_u32_u24 v30, 1280, v30
    v_add_u32 v22, v30, v26
    v_lshlrev_b32 v18, 4, v1
    v_add_u32 v19, 2048, v18
    s_mov_b32 s52, s40
    s_and_b32 s53, s41, 0xffff
    s_mov_b32 s54, 819200
    s_mov_b32 s55, 0x00020000
    s_mov_b32 s56, s42
    s_and_b32 s57, s43, 0xffff
    s_mov_b32 s58, 819200
    s_mov_b32 s59, 0x00020000
    s_mov_b32 s16, s44
    s_and_b32 s17, s45, 0xffff
    s_mov_b32 s18, 2621440
    s_mov_b32 s19, 0x00020000
    s_mov_b32 s20, s46
    s_and_b32 s21, s47, 0xffff
    s_mov_b32 s22, 256
    s_mov_b32 s23, 0x00020000
    s_cmp_ge_u32 s26, 7
    s_cbranch_scc1 K4_w1
    s_mul_i32 s31, s29, 5
    s_add_u32 s30, s26, 0
    s_add_u32 s30, s30, s31
    s_sub_u32 s31, s30, 20
    s_cmp_ge_u32 s30, 20
    s_cselect_b32 s30, s31, s30
    s_add_u32 s30, s30, 0
    s_add_u32 s38, s25, 8
    s_mul_i32 s38, s38, 20
    s_add_u32 s38, s38, s30
    s_mul_i32 s38, s38, 5120
    s_add_u32 s38, s38, 29360128
    s_add_u32 s30, s30, 0
    s_mul_i32 s31, s30, 5120
    s_mov_b32 m0, s31
    s_nop 0
    buffer_load_dwordx4 v18, s[12:15], s38 offen offset:0 sc1 lds
    buffer_load_dwordx4 v18, s[12:15], s38 offen offset:1024 sc1 lds
    buffer_load_dwordx4 v18, s[12:15], s38 offen offset:2048 sc1 lds
    buffer_load_dwordx4 v18, s[12:15], s38 offen offset:3072 sc1 lds
    s_add_u32 m0, s31, 2048
    s_nop 0
    buffer_load_dwordx4 v19, s[12:15], s38 offen offset:2048 sc1 lds
K4_w1:
    s_cmp_ge_u32 s26, 7
    s_cbranch_scc1 K4_w2
    s_mul_i32 s31, s29, 5
    s_add_u32 s30, s26, 7
    s_add_u32 s30, s30, s31
    s_sub_u32 s31, s30, 20
    s_cmp_ge_u32 s30, 20
    s_cselect_b32 s30, s31, s30
    s_add_u32 s30, s30, 0
    s_add_u32 s38, s25, 8
    s_mul_i32 s38, s38, 20
    s_add_u32 s38, s38, s30
    s_mul_i32 s38, s38, 5120
    s_add_u32 s38, s38, 29360128
    s_add_u32 s30, s30, 0
    s_mul_i32 s31, s30, 5120
    s_mov_b32 m0, s31
    s_nop 0
    buffer_load_dwordx4 v18, s[12:15], s38 offen offset:0 sc1 lds
    buffer_load_dwordx4 v18, s[12:15], s38 offen offset:1024 sc1 lds
    buffer_load_dwordx4 v18, s[12:15], s38 offen offset:2048 sc1 lds
    buffer_load_dwordx4 v18, s[12:15], s38 offen offset:3072 sc1 lds
    s_add_u32 m0, s31, 2048
    s_nop 0
    buffer_load_dwordx4 v19, s[12:15], s38 offen offset:2048 sc1 lds
K4_w2:
    s_cmp_ge_u32 s26, 6
    s_cbranch_scc1 K4_w3
    s_mul_i32 s31, s29, 5
    s_add_u32 s30, s26, 14
    s_add_u32 s30, s30, s31
    s_sub_u32 s31, s30, 20
    s_cmp_ge_u32 s30, 20
    s_cselect_b32 s30, s31, s30
    s_add_u32 s30, s30, 0
    s_add_u32 s38, s25, 8
    s_mul_i32 s38, s38, 20
    s_add_u32 s38, s38, s30
    s_mul_i32 s38, s38, 5120
    s_add_u32 s38, s38, 29360128
    s_add_u32 s30, s30, 0
    s_mul_i32 s31, s30, 5120
    s_mov_b32 m0, s31
    s_nop 0
    buffer_load_dwordx4 v18, s[12:15], s38 offen offset:0 sc1 lds
    buffer_load_dwordx4 v18, s[12:15], s38 offen offset:1024 sc1 lds
    buffer_load_dwordx4 v18, s[12:15], s38 offen offset:2048 sc1 lds
    buffer_load_dwordx4 v18, s[12:15], s38 offen offset:3072 sc1 lds
    s_add_u32 m0, s31, 2048
    s_nop 0
    buffer_load_dwordx4 v19, s[12:15], s38 offen offset:2048 sc1 lds
K4_w3:
    s_cmp_ge_u32 s26, 7
    s_cbranch_scc1 K4_w4
    s_mul_i32 s31, s29, 2
    s_add_u32 s30, s26, 0
    s_add_u32 s30, s30, s31
    s_sub_u32 s31, s30, 11
    s_cmp_ge_u32 s30, 11
    s_cselect_b32 s30, s31, s30
    s_add_u32 s30, s30, 0
    s_add_u32 s38, s25, 0
    s_mul_i32 s38, s38, 20
    s_add_u32 s38, s38, s30
    s_mul_i32 s38, s38, 5120
    s_add_u32 s38, s38, 29360128
    s_add_u32 s30, s30, 20
    s_mul_i32 s31, s30, 5120
    s_mov_b32 m0, s31
    s_nop 0
    buffer_load_dwordx4 v18, s[12:15], s38 offen offset:0 sc1 lds
    buffer_load_dwordx4 v18, s[12:15], s38 offen offset:1024 sc1 lds
    buffer_load_dwordx4 v18, s[12:15], s38 offen offset:2048 sc1 lds
    buffer_load_dwordx4 v18, s[12:15], s38 offen offset:3072 sc1 lds
    s_add_u32 m0, s31, 2048
    s_nop 0
    buffer_load_dwordx4 v19, s[12:15], s38 offen offset:2048 sc1 lds
K4_w4:
    s_cmp_ge_u32 s26, 4
    s_cbranch_scc1 K4_w5
    s_mul_i32 s31, s29, 2
    s_add_u32 s30, s26, 7
    s_add_u32 s30, s30, s31
    s_sub_u32 s31, s30, 11
    s_cmp_ge_u32 s30, 11
    s_cselect_b32 s30, s31, s30
    s_add_u32 s30, s30, 0
    s_add_u32 s38, s25, 0
    s_mul_i32 s38, s38, 20
    s_add_u32 s38, s38, s30
    s_mul_i32 s38, s38, 5120
    s_add_u32 s38, s38, 29360128
    s_add_u32 s30, s30, 20
    s_mul_i32 s31, s30, 5120
    s_mov_b32 m0, s31
    s_nop 0
    buffer_load_dwordx4 v18, s[12:15], s38 offen offset:0 sc1 lds
    buffer_load_dwordx4 v18, s[12:15], s38 offen offset:1024 sc1 lds
    buffer_load_dwordx4 v18, s[12:15], s38 offen offset:2048 sc1 lds
    buffer_load_dwordx4 v18, s[12:15], s38 offen offset:3072 sc1 lds
    s_add_u32 m0, s31, 2048
    s_nop 0
    buffer_load_dwordx4 v19, s[12:15], s38 offen offset:2048 sc1 lds
K4_w5:
    s_cmp_lg_u32 s26, 7
    s_cbranch_scc1 K4_pp
    s_lshr_b32 s30, s60, 2
    s_lshl_b32 s30, s30, 7
    s_lshr_b32 s31, s24, 1
    s_add_u32 s31, s31, 8
    s_lshl_b32 s31, s31, 7
    v_and_b32 v24, 15, v1
    v_lshlrev_b32 v24, 2, v24
    v_add_u32 v24, s30, v24
    v_and_b32 v26, 7, v1
    v_lshlrev_b32 v26, 2, v26
    v_add_u32 v26, s31, v26
    v_cmp_gt_u32 vcc, 32, v1
    s_nop 1
    v_cndmask_b32 v24, v26, v24, vcc
    v_add_u32 v24, 14684160, v24
    s_mov_b32 s32, 0
K4_pl:
    buffer_load_dword v25, v24, s[12:15], 0 offen sc1
    s_waitcnt vmcnt(0)
    v_cmp_ne_u32 vcc, 1, v25
    s_nop 3
    s_cmp_eq_u64 vcc, 0
    s_cbranch_scc1 K4_pp
    s_add_u32 s32, s32, 1
    s_cmp_lt_u32 s32, 0x40000
    s_cbranch_scc0 K4_pp
    s_sleep 2
    s_branch K4_pl
K4_pp:
    s_barrier
    v_cmp_gt_u32 vcc, 210, v0
    s_and_saveexec_b64 s[32:33], vcc
    s_cbranch_execz K4_a
    s_mov_b32 s34, 0
    buffer_load_dwordx4 v[88:91], v4, s[12:15], s34 offen sc1
    s_mov_b32 s34, 196608
    buffer_load_dwordx4 v[92:95], v4, s[12:15], s34 offen sc1
    s_mov_b32 s34, 393216
    buffer_load_dwordx4 v[96:99], v4, s[12:15], s34 offen sc1
    s_mov_b32 s34, 589824
    buffer_load_dwordx4 v[100:103], v4, s[12:15], s34 offen sc1
    s_mov_b32 s34, 786432
    buffer_load_dwordx4 v[104:107], v4, s[12:15], s34 offen sc1
    s_mov_b32 s34, 983040
    buffer_load_dwordx4 v[108:111], v4, s[12:15], s34 offen sc1
    s_mov_b32 s34, 1179648
    buffer_load_dwordx4 v[112:115], v4, s[12:15], s34 offen sc1
    s_mov_b32 s34, 1376256
    buffer_load_dwordx4 v[116:119], v4, s[12:15], s34 offen sc1
    s_mov_b32 s34, 1572864
    buffer_load_dwordx4 v[120:123], v4, s[12:15], s34 offen sc1
    s_mov_b32 s34, 1769472
    buffer_load_dwordx4 v[124:127], v4, s[12:15], s34 offen sc1
    s_mov_b32 s34, 1966080
    buffer_load_dwordx4 v[128:131], v4, s[12:15], s34 offen sc1
    s_mov_b32 s34, 2162688
    buffer_load_dwordx4 v[132:135], v4, s[12:15], s34 offen sc1
    s_mov_b32 s34, 2359296
    buffer_load_dwordx4 v[136:139], v4, s[12:15], s34 offen sc1
    s_mov_b32 s34, 2555904
    buffer_load_dwordx4 v[140:143], v4, s[12:15], s34 offen sc1
    s_mov_b32 s34, 2752512
    buffer_load_dwordx4 v[144:147], v4, s[12:15], s34 offen sc1
    s_mov_b32 s34, 2949120
    buffer_load_dwordx4 v[148:151], v4, s[12:15], s34 offen sc1
K4_a:
    s_mov_b64 exec, s[32:33]
    v_mov_b32 v156, 0
    v_mov_b32 v157, 0
    v_mov_b32 v158, 0
    v_mov_b32 v159, 0
    v_mov_b32 v164, 0
    v_mov_b32 v165, 0
    v_mov_b32 v166, 0
    v_mov_b32 v167, 0
    s_lshl_b32 s30, s61, 4
    s_lshl_b32 s31, s26, 1
    s_add_u32 s30, s30, s31
    s_lshl_b32 s31, s30, 5
    s_add_u32 s31, s31, s60
    s_mul_i32 s31, s31, 1280
    s_add_u32 s31, s31, 0
    v_lshlrev_b32 v6, 4, v1
    v_add_u32 v7, s31, v6
    s_mov_b32 s34, 0
    buffer_load_dwordx4 v[152:155], v7, s[12:15], s34 offen sc1
    s_mov_b32 s34, 40960
    buffer_load_dwordx4 v[160:163], v7, s[12:15], s34 offen sc1
    s_mov_b64 exec, 0xffff
    s_mov_b32 s34, 0
    buffer_load_dwordx4 v[156:159], v7, s[12:15], s34 offen offset:1024 sc1
    s_mov_b32 s34, 40960
    buffer_load_dwordx4 v[164:167], v7, s[12:15], s34 offen offset:1024 sc1
    s_mov_b64 exec, -1
    s_mul_i32 s31, s30, 20480
    s_add_u32 s31, s31, 25165824
    s_mul_i32 s34, s60, 20
    v_and_b32 v7, 15, v1
    v_lshlrev_b32 v7, 4, v7
    v_add_u32 v7, s31, v7
    v_lshlrev_b32 v8, 2, v10
    v_add_u32 v8, s34, v8
    v_add_u32 v9, 0, v8
    v_lshrrev_b32 v2, 5, v9
    v_lshl_add_u32 v16, v2, 10, v7
    v_bfe_u32 v2, v9, 3, 2
    v_lshl_add_u32 v16, v2, 8, v16
    v_bfe_u32 v2, v9, 2, 1
    v_lshl_add_u32 v16, v2, 3, v16
    v_add_u32 v9, 16, v8
    v_lshrrev_b32 v2, 5, v9
    v_lshl_add_u32 v17, v2, 10, v7
    v_bfe_u32 v2, v9, 3, 2
    v_lshl_add_u32 v17, v2, 8, v17
    v_bfe_u32 v2, v9, 2, 1
    v_lshl_add_u32 v17, v2, 3, v17
    s_lshl_b32 s30, s24, 2
    s_add_u32 s30, s30, s27
    s_mul_i32 s31, s30, 20
    s_mul_i32 s32, s28, 10
    s_add_u32 s31, s31, s32
    s_lshl_b32 s31, s31, 10
    v_add_u32 v12, s31, v6
    s_mov_b32 s39, 5242880
    buffer_load_dwordx4 v[48:51], v12, s[12:15], s39 offen sc1
    s_mov_b32 s39, 5243904
    buffer_load_dwordx4 v[52:55], v12, s[12:15], s39 offen sc1
    s_mov_b32 s39, 5244928
    buffer_load_dwordx4 v[56:59], v12, s[12:15], s39 offen sc1
    s_mov_b32 s39, 5245952
    buffer_load_dwordx4 v[60:63], v12, s[12:15], s39 offen sc1
    s_mov_b32 s39, 5246976
    buffer_load_dwordx4 v[64:67], v12, s[12:15], s39 offen sc1
    s_mov_b32 s39, 5248000
    buffer_load_dwordx4 v[68:71], v12, s[12:15], s39 offen sc1
    s_mov_b32 s39, 5249024
    buffer_load_dwordx4 v[72:75], v12, s[12:15], s39 offen sc1
    s_mov_b32 s39, 5250048
    buffer_load_dwordx4 v[76:79], v12, s[12:15], s39 offen sc1
    s_mov_b32 s39, 5251072
    buffer_load_dwordx4 v[80:83], v12, s[12:15], s39 offen sc1
    s_mov_b32 s39, 5252096
    buffer_load_dwordx4 v[84:87], v12, s[12:15], s39 offen sc1
    v_mov_b32 v2, 0
    v_mov_b32 v3, 0
    v_lshlrev_b32 v9, 3, v1
    v_add_u32 v9, 160400, v9
    ds_write_b64 v9, v[2:3]
    v_and_b32 v7, 15, v1
    v_mul_u32_u24 v8, 80, v7
    v_lshl_add_u32 v2, v10, 4, v8
    v_add_u32 v2, 158720, v2
    v_add_u32 v8, 16, v7
    v_min_u32 v8, 20, v8
    v_mul_u32_u24 v8, 80, v8
    v_lshl_add_u32 v3, v10, 4, v8
    v_add_u32 v3, 158720, v3
    v_cmp_gt_u32 vcc, 210, v0
    s_and_saveexec_b64 s[32:33], vcc
    s_cbranch_execz K4_b
    s_waitcnt vmcnt(14)
    v_add_f32 v88, v88, v92
    v_add_f32 v89, v89, v93
    v_add_f32 v90, v90, v94
    v_add_f32 v91, v91, v95
    v_add_f32 v88, v88, v96
    v_add_f32 v89, v89, v97
    v_add_f32 v90, v90, v98
    v_add_f32 v91, v91, v99
    v_add_f32 v88, v88, v100
    v_add_f32 v89, v89, v101
    v_add_f32 v90, v90, v102
    v_add_f32 v91, v91, v103
    v_add_f32 v88, v88, v104
    v_add_f32 v89, v89, v105
    v_add_f32 v90, v90, v106
    v_add_f32 v91, v91, v107
    v_add_f32 v88, v88, v108
    v_add_f32 v89, v89, v109
    v_add_f32 v90, v90, v110
    v_add_f32 v91, v91, v111
    v_add_f32 v88, v88, v112
    v_add_f32 v89, v89, v113
    v_add_f32 v90, v90, v114
    v_add_f32 v91, v91, v115
    v_add_f32 v88, v88, v116
    v_add_f32 v89, v89, v117
    v_add_f32 v90, v90, v118
    v_add_f32 v91, v91, v119
    v_add_f32 v88, v88, v120
    v_add_f32 v89, v89, v121
    v_add_f32 v90, v90, v122
    v_add_f32 v91, v91, v123
    v_add_f32 v88, v88, v124
    v_add_f32 v89, v89, v125
    v_add_f32 v90, v90, v126
    v_add_f32 v91, v91, v127
    v_add_f32 v88, v88, v128
    v_add_f32 v89, v89, v129
    v_add_f32 v90, v90, v130
    v_add_f32 v91, v91, v131
    v_add_f32 v88, v88, v132
    v_add_f32 v89, v89, v133
    v_add_f32 v90, v90, v134
    v_add_f32 v91, v91, v135
    v_add_f32 v88, v88, v136
    v_add_f32 v89, v89, v137
    v_add_f32 v90, v90, v138
    v_add_f32 v91, v91, v139
    v_add_f32 v88, v88, v140
    v_add_f32 v89, v89, v141
    v_add_f32 v90, v90, v142
    v_add_f32 v91, v91, v143
    v_add_f32 v88, v88, v144
    v_add_f32 v89, v89, v145
    v_add_f32 v90, v90, v146
    v_add_f32 v91, v91, v147
    v_add_f32 v88, v88, v148
    v_add_f32 v89, v89, v149
    v_add_f32 v90, v90, v150
    v_add_f32 v91, v91, v151
    v_cvt_pk_bf16_f32 v88, v88, v89
    v_cvt_pk_bf16_f32 v89, v90, v91
    ds_write_b64 v5, v[88:89]
K4_b:
    s_mov_b64 exec, s[32:33]
    s_waitcnt lgkmcnt(0)
    s_barrier
    ds_read_b128 v[88:91], v2 offset:0
    ds_read_b128 v[92:95], v2 offset:64
    ds_read_b128 v[96:99], v3 offset:0
    ds_read_b128 v[100:103], v3 offset:64
    s_mov_b32 s37, 0x358637bd
    s_waitcnt vmcnt(10)
    s_waitcnt lgkmcnt(0)
    v_mfma_f32_16x16x32_bf16 v[168:171], v[88:91], v[152:155], 0
    v_mfma_f32_16x16x32_bf16 v[172:175], v[96:99], v[152:155], 0
    v_mfma_f32_16x16x32_bf16 v[176:179], v[88:91], v[160:163], 0
    v_mfma_f32_16x16x32_bf16 v[180:183], v[96:99], v[160:163], 0
    v_mfma_f32_16x16x32_bf16 v[168:171], v[92:95], v[156:159], v[168:171]
    v_mfma_f32_16x16x32_bf16 v[172:175], v[100:103], v[156:159], v[172:175]
    v_mfma_f32_16x16x32_bf16 v[176:179], v[92:95], v[164:167], v[176:179]
    v_mfma_f32_16x16x32_bf16 v[180:183], v[100:103], v[164:167], v[180:183]
    s_nop 7
    v_cmp_gt_u32 vcc, 16, v1
    v_mov_b32 v104, v172
    v_mov_b32 v105, v172
    v_mov_b32 v106, v180
    v_mov_b32 v107, v180
    s_nop 1
    v_permlane16_swap_b32 v104, v105
    v_permlane16_swap_b32 v106, v107
    s_nop 1
    v_cndmask_b32 v104, v172, v105, vcc
    v_cvt_pk_bf16_f32 v104, v104, v104
    v_lshlrev_b32 v104, 16, v104
    v_add_f32 v104, s37, v104
    v_cvt_pk_bf16_f32 v104, v104, v104
    v_lshlrev_b32 v104, 16, v104
    v_rcp_f32 v104, v104
    v_cvt_pk_bf16_f32 v152, v168, v169
    v_cvt_pk_bf16_f32 v153, v170, v171
    v_cvt_pk_bf16_f32 v154, v172, v173
    v_cvt_pk_bf16_f32 v155, v174, v175
    v_lshlrev_b32 v168, 16, v152
    v_and_b32 v169, 0xffff0000, v152
    v_lshlrev_b32 v170, 16, v153
    v_and_b32 v171, 0xffff0000, v153
    v_lshlrev_b32 v172, 16, v154
    v_and_b32 v173, 0xffff0000, v154
    v_lshlrev_b32 v174, 16, v155
    v_and_b32 v175, 0xffff0000, v155
    v_mul_f32 v168, v168, v104
    v_mul_f32 v169, v169, v104
    v_mul_f32 v170, v170, v104
    v_mul_f32 v171, v171, v104
    v_mul_f32 v172, v172, v104
    v_mul_f32 v173, v173, v104
    v_mul_f32 v174, v174, v104
    v_mul_f32 v175, v175, v104
    v_cvt_pk_bf16_f32 v168, v168, v169
    v_cvt_pk_bf16_f32 v169, v170, v171
    v_cvt_pk_bf16_f32 v170, v172, v173
    v_cvt_pk_bf16_f32 v171, v174, v175
    s_mov_b32 s34, 0
    buffer_store_dwordx2 v[168:169], v16, s[12:15], s34 offen sc1
    v_cndmask_b32 v106, v180, v107, vcc
    v_cvt_pk_bf16_f32 v106, v106, v106
    v_lshlrev_b32 v106, 16, v106
    v_add_f32 v106, s37, v106
    v_cvt_pk_bf16_f32 v106, v106, v106
    v_lshlrev_b32 v106, 16, v106
    v_rcp_f32 v106, v106
    v_cvt_pk_bf16_f32 v152, v176, v177
    v_cvt_pk_bf16_f32 v153, v178, v179
    v_cvt_pk_bf16_f32 v154, v180, v181
    v_cvt_pk_bf16_f32 v155, v182, v183
    v_lshlrev_b32 v176, 16, v152
    v_and_b32 v177, 0xffff0000, v152
    v_lshlrev_b32 v178, 16, v153
    v_and_b32 v179, 0xffff0000, v153
    v_lshlrev_b32 v180, 16, v154
    v_and_b32 v181, 0xffff0000, v154
    v_lshlrev_b32 v182, 16, v155
    v_and_b32 v183, 0xffff0000, v155
    v_mul_f32 v176, v176, v106
    v_mul_f32 v177, v177, v106
    v_mul_f32 v178, v178, v106
    v_mul_f32 v179, v179, v106
    v_mul_f32 v180, v180, v106
    v_mul_f32 v181, v181, v106
    v_mul_f32 v182, v182, v106
    v_mul_f32 v183, v183, v106
    v_cvt_pk_bf16_f32 v176, v176, v177
    v_cvt_pk_bf16_f32 v177, v178, v179
    v_cvt_pk_bf16_f32 v178, v180, v181
    v_cvt_pk_bf16_f32 v179, v182, v183
    s_mov_b32 s34, 20480
    buffer_store_dwordx2 v[176:177], v16, s[12:15], s34 offen sc1
    s_mov_b64 exec, 0xffff
    s_mov_b32 s34, 0
    buffer_store_dwordx2 v[170:171], v17, s[12:15], s34 offen sc1
    s_mov_b32 s34, 20480
    buffer_store_dwordx2 v[178:179], v17, s[12:15], s34 offen sc1
    s_mov_b64 exec, -1
    s_waitcnt vmcnt(0)
    s_barrier
    s_cmp_lg_u32 s26, 0
    s_cbranch_scc1 K4_sig
    s_lshl_b32 s30, s2, 2
    s_add_u32 s30, s30, 0xE00000
    v_mov_b32 v2, s30
    v_mov_b32 v3, 1
    s_mov_b64 exec, 1
    buffer_store_dword v3, v2, s[12:15], 0 offen sc1
    s_mov_b64 exec, -1
K4_sig:
    v_and_b32 v2, 3, v1
    v_lshrrev_b32 v4, 2, v1
    v_mul_u32_u24 v4, 160, v4
    v_lshl_add_u32 v11, v2, 3, v4
    s_waitcnt vmcnt(0)
    s_mul_i32 s30, s28, 10
    s_add_u32 s30, s30, 0
    s_mul_i32 s30, s30, 5120
    v_add_u32 v2, s30, v11
    ds_read_b64_tr_b16 v[24:25], v2 offset:0
    ds_read_b64_tr_b16 v[26:27], v2 offset:2560
    ds_read_b64_tr_b16 v[28:29], v2 offset:32
    ds_read_b64_tr_b16 v[30:31], v2 offset:2592
    ds_read_b64_tr_b16 v[32:33], v2 offset:64
    ds_read_b64_tr_b16 v[34:35], v2 offset:2624
    ds_read_b64_tr_b16 v[36:37], v2 offset:96
    ds_read_b64_tr_b16 v[38:39], v2 offset:2656
    ds_read_b64_tr_b16 v[40:41], v2 offset:128
    ds_read_b64_tr_b16 v[42:43], v2 offset:2688
    s_mul_i32 s30, s28, 10
    s_add_u32 s30, s30, 1
    s_mul_i32 s30, s30, 5120
    v_add_u32 v3, s30, v11
    ds_read_b64_tr_b16 v[44:45], v3 offset:0
    ds_read_b64_tr_b16 v[46:47], v3 offset:2560
    s_waitcnt lgkmcnt(10)
    v_mfma_f32_16x16x32_bf16 v[128:131], v[24:27], v[48:51], 0
    ds_read_b64_tr_b16 v[24:25], v3 offset:32
    ds_read_b64_tr_b16 v[26:27], v3 offset:2592
    s_waitcnt lgkmcnt(10)
    v_mfma_f32_16x16x32_bf16 v[132:135], v[28:31], v[48:51], 0
    ds_read_b64_tr_b16 v[28:29], v3 offset:64
    ds_read_b64_tr_b16 v[30:31], v3 offset:2624
    s_waitcnt lgkmcnt(10)
    v_mfma_f32_16x16x32_bf16 v[136:139], v[32:35], v[48:51], 0
    ds_read_b64_tr_b16 v[32:33], v3 offset:96
    ds_read_b64_tr_b16 v[34:35], v3 offset:2656
    s_waitcnt lgkmcnt(10)
    v_mfma_f32_16x16x32_bf16 v[140:143], v[36:39], v[48:51], 0
    ds_read_b64_tr_b16 v[36:37], v3 offset:128
    ds_read_b64_tr_b16 v[38:39], v3 offset:2688
    s_waitcnt lgkmcnt(10)
    v_mfma_f32_16x16x32_bf16 v[144:147], v[40:43], v[48:51], 0
    s_mul_i32 s30, s28, 10
    s_add_u32 s30, s30, 2
    s_mul_i32 s30, s30, 5120
    v_add_u32 v2, s30, v11
    ds_read_b64_tr_b16 v[40:41], v2 offset:0
    ds_read_b64_tr_b16 v[42:43], v2 offset:2560
    s_waitcnt lgkmcnt(10)
    v_mfma_f32_16x16x32_bf16 v[128:131], v[44:47], v[52:55], v[128:131]
    ds_read_b64_tr_b16 v[44:45], v2 offset:32
    ds_read_b64_tr_b16 v[46:47], v2 offset:2592
    s_waitcnt lgkmcnt(10)
    v_mfma_f32_16x16x32_bf16 v[132:135], v[24:27], v[52:55], v[132:135]
    ds_read_b64_tr_b16 v[24:25], v2 offset:64
    ds_read_b64_tr_b16 v[26:27], v2 offset:2624
    s_waitcnt lgkmcnt(10)
    v_mfma_f32_16x16x32_bf16 v[136:139], v[28:31], v[52:55], v[136:139]
    ds_read_b64_tr_b16 v[28:29], v2 offset:96
    ds_read_b64_tr_b16 v[30:31], v2 offset:2656
    s_waitcnt lgkmcnt(10)
    v_mfma_f32_16x16x32_bf16 v[140:143], v[32:35], v[52:55], v[140:143]
    ds_read_b64_tr_b16 v[32:33], v2 offset:128
    ds_read_b64_tr_b16 v[34:35], v2 offset:2688
    s_waitcnt lgkmcnt(10)
    v_mfma_f32_16x16x32_bf16 v[144:147], v[36:39], v[52:55], v[144:147]
    s_mul_i32 s30, s28, 10
    s_add_u32 s30, s30, 3
    s_mul_i32 s30, s30, 5120
    v_add_u32 v3, s30, v11
    ds_read_b64_tr_b16 v[36:37], v3 offset:0
    ds_read_b64_tr_b16 v[38:39], v3 offset:2560
    s_waitcnt lgkmcnt(10)
    v_mfma_f32_16x16x32_bf16 v[128:131], v[40:43], v[56:59], v[128:131]
    ds_read_b64_tr_b16 v[40:41], v3 offset:32
    ds_read_b64_tr_b16 v[42:43], v3 offset:2592
    s_waitcnt lgkmcnt(10)
    v_mfma_f32_16x16x32_bf16 v[132:135], v[44:47], v[56:59], v[132:135]
    ds_read_b64_tr_b16 v[44:45], v3 offset:64
    ds_read_b64_tr_b16 v[46:47], v3 offset:2624
    s_waitcnt lgkmcnt(10)
    v_mfma_f32_16x16x32_bf16 v[136:139], v[24:27], v[56:59], v[136:139]
    ds_read_b64_tr_b16 v[24:25], v3 offset:96
    ds_read_b64_tr_b16 v[26:27], v3 offset:2656
    s_waitcnt lgkmcnt(10)
    v_mfma_f32_16x16x32_bf16 v[140:143], v[28:31], v[56:59], v[140:143]
    ds_read_b64_tr_b16 v[28:29], v3 offset:128
    ds_read_b64_tr_b16 v[30:31], v3 offset:2688
    s_waitcnt lgkmcnt(10)
    v_mfma_f32_16x16x32_bf16 v[144:147], v[32:35], v[56:59], v[144:147]
    s_mul_i32 s30, s28, 10
    s_add_u32 s30, s30, 4
    s_mul_i32 s30, s30, 5120
    v_add_u32 v2, s30, v11
    ds_read_b64_tr_b16 v[32:33], v2 offset:0
    ds_read_b64_tr_b16 v[34:35], v2 offset:2560
    s_waitcnt lgkmcnt(10)
    v_mfma_f32_16x16x32_bf16 v[128:131], v[36:39], v[60:63], v[128:131]
    ds_read_b64_tr_b16 v[36:37], v2 offset:32
    ds_read_b64_tr_b16 v[38:39], v2 offset:2592
    s_waitcnt lgkmcnt(10)
    v_mfma_f32_16x16x32_bf16 v[132:135], v[40:43], v[60:63], v[132:135]
    ds_read_b64_tr_b16 v[40:41], v2 offset:64
    ds_read_b64_tr_b16 v[42:43], v2 offset:2624
    s_waitcnt lgkmcnt(10)
    v_mfma_f32_16x16x32_bf16 v[136:139], v[44:47], v[60:63], v[136:139]
    ds_read_b64_tr_b16 v[44:45], v2 offset:96
    ds_read_b64_tr_b16 v[46:47], v2 offset:2656
    s_waitcnt lgkmcnt(10)
    v_mfma_f32_16x16x32_bf16 v[140:143], v[24:27], v[60:63], v[140:143]
    ds_read_b64_tr_b16 v[24:25], v2 offset:128
    ds_read_b64_tr_b16 v[26:27], v2 offset:2688
    s_waitcnt lgkmcnt(10)
    v_mfma_f32_16x16x32_bf16 v[144:147], v[28:31], v[60:63], v[144:147]
    s_mul_i32 s30, s28, 10
    s_add_u32 s30, s30, 5
    s_mul_i32 s30, s30, 5120
    v_add_u32 v3, s30, v11
    ds_read_b64_tr_b16 v[28:29], v3 offset:0
    ds_read_b64_tr_b16 v[30:31], v3 offset:2560
    s_waitcnt lgkmcnt(10)
    v_mfma_f32_16x16x32_bf16 v[128:131], v[32:35], v[64:67], v[128:131]
    ds_read_b64_tr_b16 v[32:33], v3 offset:32
    ds_read_b64_tr_b16 v[34:35], v3 offset:2592
    s_waitcnt lgkmcnt(10)
    v_mfma_f32_16x16x32_bf16 v[132:135], v[36:39], v[64:67], v[132:135]
    ds_read_b64_tr_b16 v[36:37], v3 offset:64
    ds_read_b64_tr_b16 v[38:39], v3 offset:2624
    s_waitcnt lgkmcnt(10)
    v_mfma_f32_16x16x32_bf16 v[136:139], v[40:43], v[64:67], v[136:139]
    ds_read_b64_tr_b16 v[40:41], v3 offset:96
    ds_read_b64_tr_b16 v[42:43], v3 offset:2656
    s_waitcnt lgkmcnt(10)
    v_mfma_f32_16x16x32_bf16 v[140:143], v[44:47], v[64:67], v[140:143]
    ds_read_b64_tr_b16 v[44:45], v3 offset:128
    ds_read_b64_tr_b16 v[46:47], v3 offset:2688
    s_waitcnt lgkmcnt(10)
    v_mfma_f32_16x16x32_bf16 v[144:147], v[24:27], v[64:67], v[144:147]
    s_mul_i32 s30, s28, 10
    s_add_u32 s30, s30, 6
    s_mul_i32 s30, s30, 5120
    v_add_u32 v2, s30, v11
    ds_read_b64_tr_b16 v[24:25], v2 offset:0
    ds_read_b64_tr_b16 v[26:27], v2 offset:2560
    s_waitcnt lgkmcnt(10)
    v_mfma_f32_16x16x32_bf16 v[128:131], v[28:31], v[68:71], v[128:131]
    ds_read_b64_tr_b16 v[28:29], v2 offset:32
    ds_read_b64_tr_b16 v[30:31], v2 offset:2592
    s_waitcnt lgkmcnt(10)
    v_mfma_f32_16x16x32_bf16 v[132:135], v[32:35], v[68:71], v[132:135]
    ds_read_b64_tr_b16 v[32:33], v2 offset:64
    ds_read_b64_tr_b16 v[34:35], v2 offset:2624
    s_waitcnt lgkmcnt(10)
    v_mfma_f32_16x16x32_bf16 v[136:139], v[36:39], v[68:71], v[136:139]
    ds_read_b64_tr_b16 v[36:37], v2 offset:96
    ds_read_b64_tr_b16 v[38:39], v2 offset:2656
    s_waitcnt lgkmcnt(10)
    v_mfma_f32_16x16x32_bf16 v[140:143], v[40:43], v[68:71], v[140:143]
    ds_read_b64_tr_b16 v[40:41], v2 offset:128
    ds_read_b64_tr_b16 v[42:43], v2 offset:2688
    s_waitcnt lgkmcnt(10)
    v_mfma_f32_16x16x32_bf16 v[144:147], v[44:47], v[68:71], v[144:147]
    s_mul_i32 s30, s28, 10
    s_add_u32 s30, s30, 7
    s_mul_i32 s30, s30, 5120
    v_add_u32 v3, s30, v11
    ds_read_b64_tr_b16 v[44:45], v3 offset:0
    ds_read_b64_tr_b16 v[46:47], v3 offset:2560
    s_waitcnt lgkmcnt(10)
    v_mfma_f32_16x16x32_bf16 v[128:131], v[24:27], v[72:75], v[128:131]
    ds_read_b64_tr_b16 v[24:25], v3 offset:32
    ds_read_b64_tr_b16 v[26:27], v3 offset:2592
    s_waitcnt lgkmcnt(10)
    v_mfma_f32_16x16x32_bf16 v[132:135], v[28:31], v[72:75], v[132:135]
    ds_read_b64_tr_b16 v[28:29], v3 offset:64
    ds_read_b64_tr_b16 v[30:31], v3 offset:2624
    s_waitcnt lgkmcnt(10)
    v_mfma_f32_16x16x32_bf16 v[136:139], v[32:35], v[72:75], v[136:139]
    ds_read_b64_tr_b16 v[32:33], v3 offset:96
    ds_read_b64_tr_b16 v[34:35], v3 offset:2656
    s_waitcnt lgkmcnt(10)
    v_mfma_f32_16x16x32_bf16 v[140:143], v[36:39], v[72:75], v[140:143]
    ds_read_b64_tr_b16 v[36:37], v3 offset:128
    ds_read_b64_tr_b16 v[38:39], v3 offset:2688
    s_waitcnt lgkmcnt(10)
    v_mfma_f32_16x16x32_bf16 v[144:147], v[40:43], v[72:75], v[144:147]
    s_mul_i32 s30, s28, 10
    s_add_u32 s30, s30, 8
    s_mul_i32 s30, s30, 5120
    v_add_u32 v2, s30, v11
    ds_read_b64_tr_b16 v[40:41], v2 offset:0
    ds_read_b64_tr_b16 v[42:43], v2 offset:2560
    s_waitcnt lgkmcnt(10)
    v_mfma_f32_16x16x32_bf16 v[128:131], v[44:47], v[76:79], v[128:131]
    ds_read_b64_tr_b16 v[44:45], v2 offset:32
    ds_read_b64_tr_b16 v[46:47], v2 offset:2592
    s_waitcnt lgkmcnt(10)
    v_mfma_f32_16x16x32_bf16 v[132:135], v[24:27], v[76:79], v[132:135]
    ds_read_b64_tr_b16 v[24:25], v2 offset:64
    ds_read_b64_tr_b16 v[26:27], v2 offset:2624
    s_waitcnt lgkmcnt(10)
    v_mfma_f32_16x16x32_bf16 v[136:139], v[28:31], v[76:79], v[136:139]
    ds_read_b64_tr_b16 v[28:29], v2 offset:96
    ds_read_b64_tr_b16 v[30:31], v2 offset:2656
    s_waitcnt lgkmcnt(10)
    v_mfma_f32_16x16x32_bf16 v[140:143], v[32:35], v[76:79], v[140:143]
    ds_read_b64_tr_b16 v[32:33], v2 offset:128
    ds_read_b64_tr_b16 v[34:35], v2 offset:2688
    s_waitcnt lgkmcnt(10)
    v_mfma_f32_16x16x32_bf16 v[144:147], v[36:39], v[76:79], v[144:147]
    s_mul_i32 s30, s28, 10
    s_add_u32 s30, s30, 9
    s_mul_i32 s30, s30, 5120
    v_add_u32 v3, s30, v11
    ds_read_b64_tr_b16 v[36:37], v3 offset:0
    ds_read_b64_tr_b16 v[38:39], v3 offset:2560
    s_waitcnt lgkmcnt(10)
    v_mfma_f32_16x16x32_bf16 v[128:131], v[40:43], v[80:83], v[128:131]
    ds_read_b64_tr_b16 v[40:41], v3 offset:32
    ds_read_b64_tr_b16 v[42:43], v3 offset:2592
    s_waitcnt lgkmcnt(10)
    v_mfma_f32_16x16x32_bf16 v[132:135], v[44:47], v[80:83], v[132:135]
    ds_read_b64_tr_b16 v[44:45], v3 offset:64
    ds_read_b64_tr_b16 v[46:47], v3 offset:2624
    s_waitcnt lgkmcnt(10)
    v_mfma_f32_16x16x32_bf16 v[136:139], v[24:27], v[80:83], v[136:139]
    ds_read_b64_tr_b16 v[24:25], v3 offset:96
    ds_read_b64_tr_b16 v[26:27], v3 offset:2656
    s_waitcnt lgkmcnt(10)
    v_mfma_f32_16x16x32_bf16 v[140:143], v[28:31], v[80:83], v[140:143]
    ds_read_b64_tr_b16 v[28:29], v3 offset:128
    ds_read_b64_tr_b16 v[30:31], v3 offset:2688
    s_waitcnt lgkmcnt(10)
    v_mfma_f32_16x16x32_bf16 v[144:147], v[32:35], v[80:83], v[144:147]
    s_waitcnt lgkmcnt(8)
    v_mfma_f32_16x16x32_bf16 v[128:131], v[36:39], v[84:87], v[128:131]
    s_waitcnt lgkmcnt(6)
    v_mfma_f32_16x16x32_bf16 v[132:135], v[40:43], v[84:87], v[132:135]
    s_waitcnt lgkmcnt(4)
    v_mfma_f32_16x16x32_bf16 v[136:139], v[44:47], v[84:87], v[136:139]
    s_waitcnt lgkmcnt(2)
    v_mfma_f32_16x16x32_bf16 v[140:143], v[24:27], v[84:87], v[140:143]
    s_waitcnt lgkmcnt(0)
    v_mfma_f32_16x16x32_bf16 v[144:147], v[28:31], v[84:87], v[144:147]
    s_waitcnt lgkmcnt(0)
    s_barrier
    s_cmp_ge_u32 s26, 7
    s_cbranch_scc1 K4_w6
    s_mul_i32 s31, s29, 2
    s_add_u32 s30, s26, 0
    s_add_u32 s30, s30, s31
    s_sub_u32 s31, s30, 9
    s_cmp_ge_u32 s30, 9
    s_cselect_b32 s30, s31, s30
    s_add_u32 s30, s30, 11
    s_add_u32 s38, s25, 0
    s_mul_i32 s38, s38, 20
    s_add_u32 s38, s38, s30
    s_mul_i32 s38, s38, 5120
    s_add_u32 s38, s38, 29360128
    s_sub_u32 s30, s30, 11
    s_mul_i32 s31, s30, 5120
    s_mov_b32 m0, s31
    s_nop 0
    buffer_load_dwordx4 v18, s[12:15], s38 offen offset:0 sc1 lds
    buffer_load_dwordx4 v18, s[12:15], s38 offen offset:1024 sc1 lds
    buffer_load_dwordx4 v18, s[12:15], s38 offen offset:2048 sc1 lds
    buffer_load_dwordx4 v18, s[12:15], s38 offen offset:3072 sc1 lds
    s_add_u32 m0, s31, 2048
    s_nop 0
    buffer_load_dwordx4 v19, s[12:15], s38 offen offset:2048 sc1 lds
K4_w6:
    s_cmp_ge_u32 s26, 2
    s_cbranch_scc1 K4_w7
    s_mul_i32 s31, s29, 2
    s_add_u32 s30, s26, 7
    s_add_u32 s30, s30, s31
    s_sub_u32 s31, s30, 9
    s_cmp_ge_u32 s30, 9
    s_cselect_b32 s30, s31, s30
    s_add_u32 s30, s30, 11
    s_add_u32 s38, s25, 0
    s_mul_i32 s38, s38, 20
    s_add_u32 s38, s38, s30
    s_mul_i32 s38, s38, 5120
    s_add_u32 s38, s38, 29360128
    s_sub_u32 s30, s30, 11
    s_mul_i32 s31, s30, 5120
    s_mov_b32 m0, s31
    s_nop 0
    buffer_load_dwordx4 v18, s[12:15], s38 offen offset:0 sc1 lds
    buffer_load_dwordx4 v18, s[12:15], s38 offen offset:1024 sc1 lds
    buffer_load_dwordx4 v18, s[12:15], s38 offen offset:2048 sc1 lds
    buffer_load_dwordx4 v18, s[12:15], s38 offen offset:3072 sc1 lds
    s_add_u32 m0, s31, 2048
    s_nop 0
    buffer_load_dwordx4 v19, s[12:15], s38 offen offset:2048 sc1 lds
K4_w7:
    s_cmp_lg_u32 s26, 7
    s_cbranch_scc1 K4_pd
    s_lshl_b32 s30, s62, 7
    s_add_u32 s30, s30, 0xE00000
    v_and_b32 v6, 31, v1
    v_lshlrev_b32 v6, 2, v6
    v_add_u32 v6, s30, v6
    s_mov_b32 s31, 0
K4_poll:
    buffer_load_dword v7, v6, s[12:15], 0 offen sc1
    s_waitcnt vmcnt(0)
    v_cmp_ne_u32 vcc, 1, v7
    s_nop 3
    s_cmp_eq_u64 vcc, 0
    s_cbranch_scc1 K4_pd
    s_add_u32 s31, s31, 1
    s_cmp_lt_u32 s31, 0x40000
    s_cbranch_scc0 K4_pd
    s_sleep 2
    s_branch K4_poll
K4_pd:
    s_barrier
    s_mov_b32 s39, 25165824
    buffer_load_dwordx4 v[88:91], v12, s[12:15], s39 offen sc1
    s_mov_b32 s39, 25166848
    buffer_load_dwordx4 v[92:95], v12, s[12:15], s39 offen sc1
    s_mov_b32 s39, 25167872
    buffer_load_dwordx4 v[96:99], v12, s[12:15], s39 offen sc1
    s_mov_b32 s39, 25168896
    buffer_load_dwordx4 v[100:103], v12, s[12:15], s39 offen sc1
    s_mov_b32 s39, 25169920
    buffer_load_dwordx4 v[104:107], v12, s[12:15], s39 offen sc1
    s_mov_b32 s39, 25170944
    buffer_load_dwordx4 v[108:111], v12, s[12:15], s39 offen sc1
    s_mov_b32 s39, 25171968
    buffer_load_dwordx4 v[112:115], v12, s[12:15], s39 offen sc1
    s_mov_b32 s39, 25172992
    buffer_load_dwordx4 v[116:119], v12, s[12:15], s39 offen sc1
    s_mov_b32 s39, 25174016
    buffer_load_dwordx4 v[120:123], v12, s[12:15], s39 offen sc1
    s_mov_b32 s39, 25175040
    buffer_load_dwordx4 v[124:127], v12, s[12:15], s39 offen sc1
    s_lshl_b32 s30, s24, 6
    s_lshl_b32 s31, s27, 4
    s_add_u32 s30, s30, s31
    v_and_b32 v2, 15, v1
    v_add_u32 v2, s30, v2
    v_mov_b32 v15, v2
    v_lshlrev_b32 v2, 2, v2
    v_add_u32 v2, 13631488, v2
    buffer_load_dword v14, v2, s[12:15], 0 offen sc1
    s_waitcnt vmcnt(0)
    s_barrier
    s_mul_i32 s30, s28, 10
    s_add_u32 s30, s30, 0
    s_add_u32 s31, s30, 20
    s_sub_u32 s32, s30, 11
    s_cmp_lt_u32 s30, 11
    s_cselect_b32 s30, s31, s32
    s_mul_i32 s30, s30, 5120
    v_add_u32 v2, s30, v11
    ds_read_b64_tr_b16 v[24:25], v2 offset:0
    ds_read_b64_tr_b16 v[26:27], v2 offset:2560
    ds_read_b64_tr_b16 v[28:29], v2 offset:32
    ds_read_b64_tr_b16 v[30:31], v2 offset:2592
    ds_read_b64_tr_b16 v[32:33], v2 offset:64
    ds_read_b64_tr_b16 v[34:35], v2 offset:2624
    ds_read_b64_tr_b16 v[36:37], v2 offset:96
    ds_read_b64_tr_b16 v[38:39], v2 offset:2656
    ds_read_b64_tr_b16 v[40:41], v2 offset:128
    ds_read_b64_tr_b16 v[42:43], v2 offset:2688
    s_mul_i32 s30, s28, 10
    s_add_u32 s30, s30, 1
    s_add_u32 s31, s30, 20
    s_sub_u32 s32, s30, 11
    s_cmp_lt_u32 s30, 11
    s_cselect_b32 s30, s31, s32
    s_mul_i32 s30, s30, 5120
    v_add_u32 v3, s30, v11
    ds_read_b64_tr_b16 v[44:45], v3 offset:0
    ds_read_b64_tr_b16 v[46:47], v3 offset:2560
    s_waitcnt lgkmcnt(10)
    v_mfma_f32_16x16x32_bf16 v[168:171], v[24:27], v[88:91], 0
    ds_read_b64_tr_b16 v[24:25], v3 offset:32
    ds_read_b64_tr_b16 v[26:27], v3 offset:2592
    s_waitcnt lgkmcnt(10)
    v_mfma_f32_16x16x32_bf16 v[172:175], v[28:31], v[88:91], 0
    ds_read_b64_tr_b16 v[28:29], v3 offset:64
    ds_read_b64_tr_b16 v[30:31], v3 offset:2624
    s_waitcnt lgkmcnt(10)
    v_mfma_f32_16x16x32_bf16 v[176:179], v[32:35], v[88:91], 0
    ds_read_b64_tr_b16 v[32:33], v3 offset:96
    ds_read_b64_tr_b16 v[34:35], v3 offset:2656
    s_waitcnt lgkmcnt(10)
    v_mfma_f32_16x16x32_bf16 v[180:183], v[36:39], v[88:91], 0
    ds_read_b64_tr_b16 v[36:37], v3 offset:128
    ds_read_b64_tr_b16 v[38:39], v3 offset:2688
    s_waitcnt lgkmcnt(10)
    v_mfma_f32_16x16x32_bf16 v[184:187], v[40:43], v[88:91], 0
    s_mul_i32 s30, s28, 10
    s_add_u32 s30, s30, 2
    s_add_u32 s31, s30, 20
    s_sub_u32 s32, s30, 11
    s_cmp_lt_u32 s30, 11
    s_cselect_b32 s30, s31, s32
    s_mul_i32 s30, s30, 5120
    v_add_u32 v2, s30, v11
    ds_read_b64_tr_b16 v[40:41], v2 offset:0
    ds_read_b64_tr_b16 v[42:43], v2 offset:2560
    s_waitcnt lgkmcnt(10)
    v_mfma_f32_16x16x32_bf16 v[168:171], v[44:47], v[92:95], v[168:171]
    ds_read_b64_tr_b16 v[44:45], v2 offset:32
    ds_read_b64_tr_b16 v[46:47], v2 offset:2592
    s_waitcnt lgkmcnt(10)
    v_mfma_f32_16x16x32_bf16 v[172:175], v[24:27], v[92:95], v[172:175]
    ds_read_b64_tr_b16 v[24:25], v2 offset:64
    ds_read_b64_tr_b16 v[26:27], v2 offset:2624
    s_waitcnt lgkmcnt(10)
    v_mfma_f32_16x16x32_bf16 v[176:179], v[28:31], v[92:95], v[176:179]
    ds_read_b64_tr_b16 v[28:29], v2 offset:96
    ds_read_b64_tr_b16 v[30:31], v2 offset:2656
    s_waitcnt lgkmcnt(10)
    v_mfma_f32_16x16x32_bf16 v[180:183], v[32:35], v[92:95], v[180:183]
    ds_read_b64_tr_b16 v[32:33], v2 offset:128
    ds_read_b64_tr_b16 v[34:35], v2 offset:2688
    s_waitcnt lgkmcnt(10)
    v_mfma_f32_16x16x32_bf16 v[184:187], v[36:39], v[92:95], v[184:187]
    s_mul_i32 s30, s28, 10
    s_add_u32 s30, s30, 3
    s_add_u32 s31, s30, 20
    s_sub_u32 s32, s30, 11
    s_cmp_lt_u32 s30, 11
    s_cselect_b32 s30, s31, s32
    s_mul_i32 s30, s30, 5120
    v_add_u32 v3, s30, v11
    ds_read_b64_tr_b16 v[36:37], v3 offset:0
    ds_read_b64_tr_b16 v[38:39], v3 offset:2560
    s_waitcnt lgkmcnt(10)
    v_mfma_f32_16x16x32_bf16 v[168:171], v[40:43], v[96:99], v[168:171]
    ds_read_b64_tr_b16 v[40:41], v3 offset:32
    ds_read_b64_tr_b16 v[42:43], v3 offset:2592
    s_waitcnt lgkmcnt(10)
    v_mfma_f32_16x16x32_bf16 v[172:175], v[44:47], v[96:99], v[172:175]
    ds_read_b64_tr_b16 v[44:45], v3 offset:64
    ds_read_b64_tr_b16 v[46:47], v3 offset:2624
    s_waitcnt lgkmcnt(10)
    v_mfma_f32_16x16x32_bf16 v[176:179], v[24:27], v[96:99], v[176:179]
    ds_read_b64_tr_b16 v[24:25], v3 offset:96
    ds_read_b64_tr_b16 v[26:27], v3 offset:2656
    s_waitcnt lgkmcnt(10)
    v_mfma_f32_16x16x32_bf16 v[180:183], v[28:31], v[96:99], v[180:183]
    ds_read_b64_tr_b16 v[28:29], v3 offset:128
    ds_read_b64_tr_b16 v[30:31], v3 offset:2688
    s_waitcnt lgkmcnt(10)
    v_mfma_f32_16x16x32_bf16 v[184:187], v[32:35], v[96:99], v[184:187]
    s_mul_i32 s30, s28, 10
    s_add_u32 s30, s30, 4
    s_add_u32 s31, s30, 20
    s_sub_u32 s32, s30, 11
    s_cmp_lt_u32 s30, 11
    s_cselect_b32 s30, s31, s32
    s_mul_i32 s30, s30, 5120
    v_add_u32 v2, s30, v11
    ds_read_b64_tr_b16 v[32:33], v2 offset:0
    ds_read_b64_tr_b16 v[34:35], v2 offset:2560
    s_waitcnt lgkmcnt(10)
    v_mfma_f32_16x16x32_bf16 v[168:171], v[36:39], v[100:103], v[168:171]
    ds_read_b64_tr_b16 v[36:37], v2 offset:32
    ds_read_b64_tr_b16 v[38:39], v2 offset:2592
    s_waitcnt lgkmcnt(10)
    v_mfma_f32_16x16x32_bf16 v[172:175], v[40:43], v[100:103], v[172:175]
    ds_read_b64_tr_b16 v[40:41], v2 offset:64
    ds_read_b64_tr_b16 v[42:43], v2 offset:2624
    s_waitcnt lgkmcnt(10)
    v_mfma_f32_16x16x32_bf16 v[176:179], v[44:47], v[100:103], v[176:179]
    ds_read_b64_tr_b16 v[44:45], v2 offset:96
    ds_read_b64_tr_b16 v[46:47], v2 offset:2656
    s_waitcnt lgkmcnt(10)
    v_mfma_f32_16x16x32_bf16 v[180:183], v[24:27], v[100:103], v[180:183]
    ds_read_b64_tr_b16 v[24:25], v2 offset:128
    ds_read_b64_tr_b16 v[26:27], v2 offset:2688
    s_waitcnt lgkmcnt(10)
    v_mfma_f32_16x16x32_bf16 v[184:187], v[28:31], v[100:103], v[184:187]
    s_mul_i32 s30, s28, 10
    s_add_u32 s30, s30, 5
    s_add_u32 s31, s30, 20
    s_sub_u32 s32, s30, 11
    s_cmp_lt_u32 s30, 11
    s_cselect_b32 s30, s31, s32
    s_mul_i32 s30, s30, 5120
    v_add_u32 v3, s30, v11
    ds_read_b64_tr_b16 v[28:29], v3 offset:0
    ds_read_b64_tr_b16 v[30:31], v3 offset:2560
    s_waitcnt lgkmcnt(10)
    v_mfma_f32_16x16x32_bf16 v[168:171], v[32:35], v[104:107], v[168:171]
    ds_read_b64_tr_b16 v[32:33], v3 offset:32
    ds_read_b64_tr_b16 v[34:35], v3 offset:2592
    s_waitcnt lgkmcnt(10)
    v_mfma_f32_16x16x32_bf16 v[172:175], v[36:39], v[104:107], v[172:175]
    ds_read_b64_tr_b16 v[36:37], v3 offset:64
    ds_read_b64_tr_b16 v[38:39], v3 offset:2624
    s_waitcnt lgkmcnt(10)
    v_mfma_f32_16x16x32_bf16 v[176:179], v[40:43], v[104:107], v[176:179]
    ds_read_b64_tr_b16 v[40:41], v3 offset:96
    ds_read_b64_tr_b16 v[42:43], v3 offset:2656
    s_waitcnt lgkmcnt(10)
    v_mfma_f32_16x16x32_bf16 v[180:183], v[44:47], v[104:107], v[180:183]
    ds_read_b64_tr_b16 v[44:45], v3 offset:128
    ds_read_b64_tr_b16 v[46:47], v3 offset:2688
    s_waitcnt lgkmcnt(10)
    v_mfma_f32_16x16x32_bf16 v[184:187], v[24:27], v[104:107], v[184:187]
    s_mul_i32 s30, s28, 10
    s_add_u32 s30, s30, 6
    s_add_u32 s31, s30, 20
    s_sub_u32 s32, s30, 11
    s_cmp_lt_u32 s30, 11
    s_cselect_b32 s30, s31, s32
    s_mul_i32 s30, s30, 5120
    v_add_u32 v2, s30, v11
    ds_read_b64_tr_b16 v[24:25], v2 offset:0
    ds_read_b64_tr_b16 v[26:27], v2 offset:2560
    s_waitcnt lgkmcnt(10)
    v_mfma_f32_16x16x32_bf16 v[168:171], v[28:31], v[108:111], v[168:171]
    ds_read_b64_tr_b16 v[28:29], v2 offset:32
    ds_read_b64_tr_b16 v[30:31], v2 offset:2592
    s_waitcnt lgkmcnt(10)
    v_mfma_f32_16x16x32_bf16 v[172:175], v[32:35], v[108:111], v[172:175]
    ds_read_b64_tr_b16 v[32:33], v2 offset:64
    ds_read_b64_tr_b16 v[34:35], v2 offset:2624
    s_waitcnt lgkmcnt(10)
    v_mfma_f32_16x16x32_bf16 v[176:179], v[36:39], v[108:111], v[176:179]
    ds_read_b64_tr_b16 v[36:37], v2 offset:96
    ds_read_b64_tr_b16 v[38:39], v2 offset:2656
    s_waitcnt lgkmcnt(10)
    v_mfma_f32_16x16x32_bf16 v[180:183], v[40:43], v[108:111], v[180:183]
    ds_read_b64_tr_b16 v[40:41], v2 offset:128
    ds_read_b64_tr_b16 v[42:43], v2 offset:2688
    s_waitcnt lgkmcnt(10)
    v_mfma_f32_16x16x32_bf16 v[184:187], v[44:47], v[108:111], v[184:187]
    s_mul_i32 s30, s28, 10
    s_add_u32 s30, s30, 7
    s_add_u32 s31, s30, 20
    s_sub_u32 s32, s30, 11
    s_cmp_lt_u32 s30, 11
    s_cselect_b32 s30, s31, s32
    s_mul_i32 s30, s30, 5120
    v_add_u32 v3, s30, v11
    ds_read_b64_tr_b16 v[44:45], v3 offset:0
    ds_read_b64_tr_b16 v[46:47], v3 offset:2560
    s_waitcnt lgkmcnt(10)
    v_mfma_f32_16x16x32_bf16 v[168:171], v[24:27], v[112:115], v[168:171]
    ds_read_b64_tr_b16 v[24:25], v3 offset:32
    ds_read_b64_tr_b16 v[26:27], v3 offset:2592
    s_waitcnt lgkmcnt(10)
    v_mfma_f32_16x16x32_bf16 v[172:175], v[28:31], v[112:115], v[172:175]
    ds_read_b64_tr_b16 v[28:29], v3 offset:64
    ds_read_b64_tr_b16 v[30:31], v3 offset:2624
    s_waitcnt lgkmcnt(10)
    v_mfma_f32_16x16x32_bf16 v[176:179], v[32:35], v[112:115], v[176:179]
    ds_read_b64_tr_b16 v[32:33], v3 offset:96
    ds_read_b64_tr_b16 v[34:35], v3 offset:2656
    s_waitcnt lgkmcnt(10)
    v_mfma_f32_16x16x32_bf16 v[180:183], v[36:39], v[112:115], v[180:183]
    ds_read_b64_tr_b16 v[36:37], v3 offset:128
    ds_read_b64_tr_b16 v[38:39], v3 offset:2688
    s_waitcnt lgkmcnt(10)
    v_mfma_f32_16x16x32_bf16 v[184:187], v[40:43], v[112:115], v[184:187]
    s_mul_i32 s30, s28, 10
    s_add_u32 s30, s30, 8
    s_add_u32 s31, s30, 20
    s_sub_u32 s32, s30, 11
    s_cmp_lt_u32 s30, 11
    s_cselect_b32 s30, s31, s32
    s_mul_i32 s30, s30, 5120
    v_add_u32 v2, s30, v11
    ds_read_b64_tr_b16 v[40:41], v2 offset:0
    ds_read_b64_tr_b16 v[42:43], v2 offset:2560
    s_waitcnt lgkmcnt(10)
    v_mfma_f32_16x16x32_bf16 v[168:171], v[44:47], v[116:119], v[168:171]
    ds_read_b64_tr_b16 v[44:45], v2 offset:32
    ds_read_b64_tr_b16 v[46:47], v2 offset:2592
    s_waitcnt lgkmcnt(10)
    v_mfma_f32_16x16x32_bf16 v[172:175], v[24:27], v[116:119], v[172:175]
    ds_read_b64_tr_b16 v[24:25], v2 offset:64
    ds_read_b64_tr_b16 v[26:27], v2 offset:2624
    s_waitcnt lgkmcnt(10)
    v_mfma_f32_16x16x32_bf16 v[176:179], v[28:31], v[116:119], v[176:179]
    ds_read_b64_tr_b16 v[28:29], v2 offset:96
    ds_read_b64_tr_b16 v[30:31], v2 offset:2656
    s_waitcnt lgkmcnt(10)
    v_mfma_f32_16x16x32_bf16 v[180:183], v[32:35], v[116:119], v[180:183]
    ds_read_b64_tr_b16 v[32:33], v2 offset:128
    ds_read_b64_tr_b16 v[34:35], v2 offset:2688
    s_waitcnt lgkmcnt(10)
    v_mfma_f32_16x16x32_bf16 v[184:187], v[36:39], v[116:119], v[184:187]
    s_mul_i32 s30, s28, 10
    s_add_u32 s30, s30, 9
    s_add_u32 s31, s30, 20
    s_sub_u32 s32, s30, 11
    s_cmp_lt_u32 s30, 11
    s_cselect_b32 s30, s31, s32
    s_mul_i32 s30, s30, 5120
    v_add_u32 v3, s30, v11
    ds_read_b64_tr_b16 v[36:37], v3 offset:0
    ds_read_b64_tr_b16 v[38:39], v3 offset:2560
    s_waitcnt lgkmcnt(10)
    v_mfma_f32_16x16x32_bf16 v[168:171], v[40:43], v[120:123], v[168:171]
    ds_read_b64_tr_b16 v[40:41], v3 offset:32
    ds_read_b64_tr_b16 v[42:43], v3 offset:2592
    s_waitcnt lgkmcnt(10)
    v_mfma_f32_16x16x32_bf16 v[172:175], v[44:47], v[120:123], v[172:175]
    ds_read_b64_tr_b16 v[44:45], v3 offset:64
    ds_read_b64_tr_b16 v[46:47], v3 offset:2624
    s_waitcnt lgkmcnt(10)
    v_mfma_f32_16x16x32_bf16 v[176:179], v[24:27], v[120:123], v[176:179]
    ds_read_b64_tr_b16 v[24:25], v3 offset:96
    ds_read_b64_tr_b16 v[26:27], v3 offset:2656
    s_waitcnt lgkmcnt(10)
    v_mfma_f32_16x16x32_bf16 v[180:183], v[28:31], v[120:123], v[180:183]
    ds_read_b64_tr_b16 v[28:29], v3 offset:128
    ds_read_b64_tr_b16 v[30:31], v3 offset:2688
    s_waitcnt lgkmcnt(10)
    v_mfma_f32_16x16x32_bf16 v[184:187], v[32:35], v[120:123], v[184:187]
    s_waitcnt lgkmcnt(8)
    v_mfma_f32_16x16x32_bf16 v[168:171], v[36:39], v[124:127], v[168:171]
    s_waitcnt lgkmcnt(6)
    v_mfma_f32_16x16x32_bf16 v[172:175], v[40:43], v[124:127], v[172:175]
    s_waitcnt lgkmcnt(4)
    v_mfma_f32_16x16x32_bf16 v[176:179], v[44:47], v[124:127], v[176:179]
    s_waitcnt lgkmcnt(2)
    v_mfma_f32_16x16x32_bf16 v[180:183], v[24:27], v[124:127], v[180:183]
    s_waitcnt lgkmcnt(0)
    v_mfma_f32_16x16x32_bf16 v[184:187], v[28:31], v[124:127], v[184:187]
    s_waitcnt lgkmcnt(0)
    s_barrier
    s_nop 7
    v_lshlrev_b32 v2, 4, v1
    s_mul_i32 s30, s26, 6144
    v_add_u32 v3, s30, v2
    s_xor_b32 s31, s26, 4
    s_mul_i32 s31, s31, 6144
    v_add_u32 v4, s31, v2
    v_mul_u32_u24 v5, 1280, v15
    v_lshl_add_u32 v5, v10, 3, v5
    s_mul_i32 s33, s25, 160
    v_add_u32 v5, s33, v5
    v_sub_f32 v7, 1.0, v14
    v_cvt_pk_bf16_f32 v7, v7, v7
    v_lshlrev_b32 v7, 16, v7
    s_cmp_eq_u32 s28, 0
    s_cbranch_scc0 K4_x1
    ds_write_b128 v3, v[180:183] offset:0
    ds_write_b128 v3, v[140:143] offset:1024
    ds_write_b128 v3, v[184:187] offset:2048
    ds_write_b128 v3, v[144:147] offset:3072
    s_waitcnt lgkmcnt(0)
    s_barrier
    ds_read_b128 v[48:51], v4 offset:0
    ds_read_b128 v[52:55], v4 offset:1024
    ds_read_b128 v[56:59], v4 offset:2048
    ds_read_b128 v[60:63], v4 offset:3072
    ds_read_b128 v[64:67], v4 offset:4096
    ds_read_b128 v[68:71], v4 offset:5120
    s_waitcnt lgkmcnt(0)
    v_add_f32 v168, v168, v48
    v_add_f32 v128, v128, v52
    v_add_f32 v169, v169, v49
    v_add_f32 v129, v129, v53
    v_add_f32 v170, v170, v50
    v_add_f32 v130, v130, v54
    v_add_f32 v171, v171, v51
    v_add_f32 v131, v131, v55
    v_cvt_pk_bf16_f32 v48, v168, v169
    v_cvt_pk_bf16_f32 v49, v170, v171
    v_cvt_pk_bf16_f32 v50, v128, v129
    v_cvt_pk_bf16_f32 v51, v130, v131
    v_lshlrev_b32 v168, 16, v48
    v_and_b32 v169, 0xffff0000, v48
    v_lshlrev_b32 v128, 16, v50
    v_and_b32 v129, 0xffff0000, v50
    v_lshlrev_b32 v170, 16, v49
    v_and_b32 v171, 0xffff0000, v49
    v_lshlrev_b32 v130, 16, v51
    v_and_b32 v131, 0xffff0000, v51
    v_mul_f32 v168, v168, v14
    v_mul_f32 v128, v128, v7
    v_mul_f32 v169, v169, v14
    v_mul_f32 v129, v129, v7
    v_mul_f32 v170, v170, v14
    v_mul_f32 v130, v130, v7
    v_mul_f32 v171, v171, v14
    v_mul_f32 v131, v131, v7
    v_cvt_pk_bf16_f32 v48, v168, v169
    v_cvt_pk_bf16_f32 v49, v170, v171
    v_cvt_pk_bf16_f32 v50, v128, v129
    v_cvt_pk_bf16_f32 v51, v130, v131
    v_lshlrev_b32 v168, 16, v48
    v_and_b32 v169, 0xffff0000, v48
    v_lshlrev_b32 v128, 16, v50
    v_and_b32 v129, 0xffff0000, v50
    v_lshlrev_b32 v170, 16, v49
    v_and_b32 v171, 0xffff0000, v49
    v_lshlrev_b32 v130, 16, v51
    v_and_b32 v131, 0xffff0000, v51
    v_add_f32 v168, v168, v128
    v_add_f32 v169, v169, v129
    v_add_f32 v170, v170, v130
    v_add_f32 v171, v171, v131
    v_cvt_pk_bf16_f32 v52, v168, v169
    v_cvt_pk_bf16_f32 v53, v170, v171
    buffer_store_dwordx2 v[52:53], v5, s[16:19], 0 offen offset:0
    v_add_f32 v172, v172, v56
    v_add_f32 v132, v132, v60
    v_add_f32 v173, v173, v57
    v_add_f32 v133, v133, v61
    v_add_f32 v174, v174, v58
    v_add_f32 v134, v134, v62
    v_add_f32 v175, v175, v59
    v_add_f32 v135, v135, v63
    v_cvt_pk_bf16_f32 v56, v172, v173
    v_cvt_pk_bf16_f32 v57, v174, v175
    v_cvt_pk_bf16_f32 v58, v132, v133
    v_cvt_pk_bf16_f32 v59, v134, v135
    v_lshlrev_b32 v172, 16, v56
    v_and_b32 v173, 0xffff0000, v56
    v_lshlrev_b32 v132, 16, v58
    v_and_b32 v133, 0xffff0000, v58
    v_lshlrev_b32 v174, 16, v57
    v_and_b32 v175, 0xffff0000, v57
    v_lshlrev_b32 v134, 16, v59
    v_and_b32 v135, 0xffff0000, v59
    v_mul_f32 v172, v172, v14
    v_mul_f32 v132, v132, v7
    v_mul_f32 v173, v173, v14
    v_mul_f32 v133, v133, v7
    v_mul_f32 v174, v174, v14
    v_mul_f32 v134, v134, v7
    v_mul_f32 v175, v175, v14
    v_mul_f32 v135, v135, v7
    v_cvt_pk_bf16_f32 v56, v172, v173
    v_cvt_pk_bf16_f32 v57, v174, v175
    v_cvt_pk_bf16_f32 v58, v132, v133
    v_cvt_pk_bf16_f32 v59, v134, v135
    v_lshlrev_b32 v172, 16, v56
    v_and_b32 v173, 0xffff0000, v56
    v_lshlrev_b32 v132, 16, v58
    v_and_b32 v133, 0xffff0000, v58
    v_lshlrev_b32 v174, 16, v57
    v_and_b32 v175, 0xffff0000, v57
    v_lshlrev_b32 v134, 16, v59
    v_and_b32 v135, 0xffff0000, v59
    v_add_f32 v172, v172, v132
    v_add_f32 v173, v173, v133
    v_add_f32 v174, v174, v134
    v_add_f32 v175, v175, v135
    v_cvt_pk_bf16_f32 v60, v172, v173
    v_cvt_pk_bf16_f32 v61, v174, v175
    buffer_store_dwordx2 v[60:61], v5, s[16:19], 0 offen offset:32
    v_add_f32 v176, v176, v64
    v_add_f32 v136, v136, v68
    v_add_f32 v177, v177, v65
    v_add_f32 v137, v137, v69
    v_add_f32 v178, v178, v66
    v_add_f32 v138, v138, v70
    v_add_f32 v179, v179, v67
    v_add_f32 v139, v139, v71
    v_cvt_pk_bf16_f32 v64, v176, v177
    v_cvt_pk_bf16_f32 v65, v178, v179
    v_cvt_pk_bf16_f32 v66, v136, v137
    v_cvt_pk_bf16_f32 v67, v138, v139
    v_lshlrev_b32 v176, 16, v64
    v_and_b32 v177, 0xffff0000, v64
    v_lshlrev_b32 v136, 16, v66
    v_and_b32 v137, 0xffff0000, v66
    v_lshlrev_b32 v178, 16, v65
    v_and_b32 v179, 0xffff0000, v65
    v_lshlrev_b32 v138, 16, v67
    v_and_b32 v139, 0xffff0000, v67
    v_mul_f32 v176, v176, v14
    v_mul_f32 v136, v136, v7
    v_mul_f32 v177, v177, v14
    v_mul_f32 v137, v137, v7
    v_mul_f32 v178, v178, v14
    v_mul_f32 v138, v138, v7
    v_mul_f32 v179, v179, v14
    v_mul_f32 v139, v139, v7
    v_cvt_pk_bf16_f32 v64, v176, v177
    v_cvt_pk_bf16_f32 v65, v178, v179
    v_cvt_pk_bf16_f32 v66, v136, v137
    v_cvt_pk_bf16_f32 v67, v138, v139
    v_lshlrev_b32 v176, 16, v64
    v_and_b32 v177, 0xffff0000, v64
    v_lshlrev_b32 v136, 16, v66
    v_and_b32 v137, 0xffff0000, v66
    v_lshlrev_b32 v178, 16, v65
    v_and_b32 v179, 0xffff0000, v65
    v_lshlrev_b32 v138, 16, v67
    v_and_b32 v139, 0xffff0000, v67
    v_add_f32 v176, v176, v136
    v_add_f32 v177, v177, v137
    v_add_f32 v178, v178, v138
    v_add_f32 v179, v179, v139
    v_cvt_pk_bf16_f32 v68, v176, v177
    v_cvt_pk_bf16_f32 v69, v178, v179
    buffer_store_dwordx2 v[68:69], v5, s[16:19], 0 offen offset:64
    s_branch K4_fin
K4_x1:
    ds_write_b128 v3, v[168:171] offset:0
    ds_write_b128 v3, v[128:131] offset:1024
    ds_write_b128 v3, v[172:175] offset:2048
    ds_write_b128 v3, v[132:135] offset:3072
    ds_write_b128 v3, v[176:179] offset:4096
    ds_write_b128 v3, v[136:139] offset:5120
    s_waitcnt lgkmcnt(0)
    s_barrier
    ds_read_b128 v[48:51], v4 offset:0
    ds_read_b128 v[52:55], v4 offset:1024
    ds_read_b128 v[56:59], v4 offset:2048
    ds_read_b128 v[60:63], v4 offset:3072
    s_waitcnt lgkmcnt(0)
    v_add_f32 v180, v180, v48
    v_add_f32 v140, v140, v52
    v_add_f32 v181, v181, v49
    v_add_f32 v141, v141, v53
    v_add_f32 v182, v182, v50
    v_add_f32 v142, v142, v54
    v_add_f32 v183, v183, v51
    v_add_f32 v143, v143, v55
    v_cvt_pk_bf16_f32 v48, v180, v181
    v_cvt_pk_bf16_f32 v49, v182, v183
    v_cvt_pk_bf16_f32 v50, v140, v141
    v_cvt_pk_bf16_f32 v51, v142, v143
    v_lshlrev_b32 v180, 16, v48
    v_and_b32 v181, 0xffff0000, v48
    v_lshlrev_b32 v140, 16, v50
    v_and_b32 v141, 0xffff0000, v50
    v_lshlrev_b32 v182, 16, v49
    v_and_b32 v183, 0xffff0000, v49
    v_lshlrev_b32 v142, 16, v51
    v_and_b32 v143, 0xffff0000, v51
    v_mul_f32 v180, v180, v14
    v_mul_f32 v140, v140, v7
    v_mul_f32 v181, v181, v14
    v_mul_f32 v141, v141, v7
    v_mul_f32 v182, v182, v14
    v_mul_f32 v142, v142, v7
    v_mul_f32 v183, v183, v14
    v_mul_f32 v143, v143, v7
    v_cvt_pk_bf16_f32 v48, v180, v181
    v_cvt_pk_bf16_f32 v49, v182, v183
    v_cvt_pk_bf16_f32 v50, v140, v141
    v_cvt_pk_bf16_f32 v51, v142, v143
    v_lshlrev_b32 v180, 16, v48
    v_and_b32 v181, 0xffff0000, v48
    v_lshlrev_b32 v140, 16, v50
    v_and_b32 v141, 0xffff0000, v50
    v_lshlrev_b32 v182, 16, v49
    v_and_b32 v183, 0xffff0000, v49
    v_lshlrev_b32 v142, 16, v51
    v_and_b32 v143, 0xffff0000, v51
    v_add_f32 v180, v180, v140
    v_add_f32 v181, v181, v141
    v_add_f32 v182, v182, v142
    v_add_f32 v183, v183, v143
    v_cvt_pk_bf16_f32 v52, v180, v181
    v_cvt_pk_bf16_f32 v53, v182, v183
    buffer_store_dwordx2 v[52:53], v5, s[16:19], 0 offen offset:96
    v_add_f32 v184, v184, v56
    v_add_f32 v144, v144, v60
    v_add_f32 v185, v185, v57
    v_add_f32 v145, v145, v61
    v_add_f32 v186, v186, v58
    v_add_f32 v146, v146, v62
    v_add_f32 v187, v187, v59
    v_add_f32 v147, v147, v63
    v_cvt_pk_bf16_f32 v56, v184, v185
    v_cvt_pk_bf16_f32 v57, v186, v187
    v_cvt_pk_bf16_f32 v58, v144, v145
    v_cvt_pk_bf16_f32 v59, v146, v147
    v_lshlrev_b32 v184, 16, v56
    v_and_b32 v185, 0xffff0000, v56
    v_lshlrev_b32 v144, 16, v58
    v_and_b32 v145, 0xffff0000, v58
    v_lshlrev_b32 v186, 16, v57
    v_and_b32 v187, 0xffff0000, v57
    v_lshlrev_b32 v146, 16, v59
    v_and_b32 v147, 0xffff0000, v59
    v_mul_f32 v184, v184, v14
    v_mul_f32 v144, v144, v7
    v_mul_f32 v185, v185, v14
    v_mul_f32 v145, v145, v7
    v_mul_f32 v186, v186, v14
    v_mul_f32 v146, v146, v7
    v_mul_f32 v187, v187, v14
    v_mul_f32 v147, v147, v7
    v_cvt_pk_bf16_f32 v56, v184, v185
    v_cvt_pk_bf16_f32 v57, v186, v187
    v_cvt_pk_bf16_f32 v58, v144, v145
    v_cvt_pk_bf16_f32 v59, v146, v147
    v_lshlrev_b32 v184, 16, v56
    v_and_b32 v185, 0xffff0000, v56
    v_lshlrev_b32 v144, 16, v58
    v_and_b32 v145, 0xffff0000, v58
    v_lshlrev_b32 v186, 16, v57
    v_and_b32 v187, 0xffff0000, v57
    v_lshlrev_b32 v146, 16, v59
    v_and_b32 v147, 0xffff0000, v59
    v_add_f32 v184, v184, v144
    v_add_f32 v185, v185, v145
    v_add_f32 v186, v186, v146
    v_add_f32 v187, v187, v147
    v_cvt_pk_bf16_f32 v60, v184, v185
    v_cvt_pk_bf16_f32 v61, v186, v187
    buffer_store_dwordx2 v[60:61], v5, s[16:19], 0 offen offset:128
K4_fin:
K1_done:
    s_endpgm
.section .rodata,"a"
.p2align 6
.amdhsa_kernel gated_mix__linear_kernel_hedgehog__sliding_local_dilated__prompt_kernel
  .amdhsa_next_free_vgpr 240
  .amdhsa_next_free_sgpr 102
  .amdhsa_accum_offset 240
  .amdhsa_group_segment_fixed_size 0
  .amdhsa_kernarg_size 88
  .amdhsa_user_sgpr_count 2
  .amdhsa_user_sgpr_kernarg_segment_ptr 1
  .amdhsa_system_sgpr_workgroup_id_x 1
.end_amdhsa_kernel
```
